```python
import torch

def _softmax(x, axis=-1):
    return torch.softmax(x, dim=axis)
def _gelu(x):
    return torch.nn.functional.gelu(x, approximate="tanh")
def _silu(x):
    return torch.nn.functional.silu(x)
def _sigmoid(x):
    return torch.sigmoid(x)
def _layernorm(x, axis=-1, eps=1e-5):
    m = x.mean(dim=axis, keepdim=True)
    v = x.var(dim=axis, keepdim=True, unbiased=False)
    return (x - m) / torch.sqrt(v + eps)
def _scatter_add(tgt, idx, src, axis=0):
    return tgt.clone().index_add_(axis, idx, src)
def _segment_sum(src, seg, n):
    out = torch.zeros((n,) + src.shape[1:], dtype=src.dtype)
    return out.index_add_(0, seg, src)
def _pad(x, pw):
    flat = tuple(v for pair in reversed(pw) for v in pair)
    return torch.nn.functional.pad(x, flat)

kernel_name = 'sequential_preLN__ssm_conv_h3__mixer_channel_mlp__prompt'

def setup_inputs():

    _w = (lambda a: (lambda t: t.to(torch.bfloat16) if t.is_floating_point() else t)(torch.as_tensor(a)))
    def _A_setup():
        B, S, D = 1, 2048, 512
        ks = 4
        return {
            "q": _w((lambda *s: torch.randn(*s, dtype=torch.bfloat16) * 0.05)(B, S, D)),
            "k": _w((lambda *s: torch.randn(*s, dtype=torch.bfloat16) * 0.2)(B, S, D)),
            "v": _w((lambda *s: torch.randn(*s, dtype=torch.bfloat16) * 0.2)(B, S, D)),
            "shift_k": _w((lambda *s: torch.randn(*s, dtype=torch.bfloat16) * 0.2)(D, ks) * 0.5),
            "ssm_k": _w((lambda *s: torch.randn(*s, dtype=torch.bfloat16) * 0.8)(D, S) * (1.0 / S ** 0.5)),
            "ssm_D": _w((lambda *s: torch.randn(*s, dtype=torch.bfloat16) * 0.2)(D)),
        }
    _A_in = _A_setup()

    def _B_setup():
        B, S, D, F = 1, 2048, 512, 1792
        return {
            "x": _w((lambda *s: torch.randn(*s, dtype=torch.bfloat16) * 0.05)(B, S, D)),
            "w1": _w((lambda *s: torch.randn(*s, dtype=torch.bfloat16) * 0.8)(D, F) * (D ** -0.5)),
            "b1": _w((lambda *s: torch.randn(*s, dtype=torch.bfloat16) * 0.4)(F)),
            "w2": _w((lambda *s: torch.randn(*s, dtype=torch.bfloat16) * 0.05)(F, D) * (F ** -0.5)),
            "b2": _w((lambda *s: torch.randn(*s, dtype=torch.bfloat16) * 0.05)(D)),
        }
    _B_in = _B_setup()

    return {
        "A_q": _A_in["q"],
        "A_k": _A_in["k"],
        "A_v": _A_in["v"],
        "A_shift_k": _A_in["shift_k"],
        "A_ssm_k": _A_in["ssm_k"],
        "A_ssm_D": _A_in["ssm_D"],
        "B_x": _B_in["x"],
        "B_w1": _B_in["w1"],
        "B_b1": _B_in["b1"],
        "B_w2": _B_in["w2"],
        "B_b2": _B_in["b2"],
    }

def reference(A_q, A_k, A_v, A_shift_k, A_ssm_k, A_ssm_D, B_x, B_w1, B_b1, B_w2, B_b2):
    def _A_ref(q, k, v, shift_k, ssm_k, ssm_D):
        B, S, D = q.shape
        ks = shift_k.shape[-1]
        k_pad = _pad(k, ((0, 0), (ks - 1, 0), (0, 0)))
        k_shift = torch.zeros_like(k)
        for t in range(ks):
            k_shift = k_shift + k_pad[:, t:t + S, :] * shift_k[:, ks - 1 - t][None, None, :]
        kv = k_shift * v
        L = 2 * S
        kv_pad = _pad(kv, ((0, 0), (0, S), (0, 0)))
        kf_pad = _pad(ssm_k, ((0, 0), (0, S)))
        kv_f = (lambda x, axes=(-2,-1): torch.fft.rfft2(x.float(), dim=axes))(kv_pad[:, None, :, :], axes=(1, 2))
        kf_f = (lambda x, axes=(-2,-1): torch.fft.rfft2(x.float(), dim=axes))(kf_pad[:, None, :], axes=(1, 2))
        kf_f = (lambda x, *d: x.permute(*d))(kf_f, 1, 2, 0)
        y_f = kv_f * kf_f[None, :, :, :]
        y = (lambda x, s, axes=(-2,-1): torch.fft.irfft2(x, s=s, dim=axes).to(torch.bfloat16))(y_f, (1, L), axes=(1, 2))[:, 0, :S, :]
        y = y + kv * ssm_D[None, None, :]
        return q * y

    def _B_ref(x, w1, b1, w2, b2):
        y = _layernorm(x, axis=-1)
        h = _gelu(torch.einsum("bsd,df->bsf", y, w1) + b1)
        return torch.einsum("bsf,fd->bsd", h, w2) + b2

    x = A_q
    h = x + _A_ref(_layernorm(x, axis=-1), A_k, A_v, A_shift_k, A_ssm_k, A_ssm_D)
    h2 = h + _B_ref(_layernorm(h, axis=-1), B_w1, B_b1, B_w2, B_b2)
    return h2
```

```asm
; @launch grid=(256,1,1) block=(256,1,1) lds=163840
.amdgcn_target "amdgcn-amd-amdhsa--gfx950"
.text
.globl sequential_preLN__ssm_conv_h3__mixer_channel_mlp__prompt_kernel
.p2align 8
.type sequential_preLN__ssm_conv_h3__mixer_channel_mlp__prompt_kernel,@function
sequential_preLN__ssm_conv_h3__mixer_channel_mlp__prompt_kernel:

code_lo:
  s_cmp_ge_u32 s2, 256
  s_cbranch_scc1 k_exit
  s_load_dwordx2 s[8:9], s[0:1], 8
  s_load_dwordx2 s[28:29], s[0:1], 24
  s_load_dwordx2 s[12:13], s[0:1], 16
  s_load_dwordx2 s[52:53], s[0:1], 96
  s_load_dwordx2 s[20:21], s[0:1], 104
  s_load_dwordx2 s[24:25], s[0:1], 32
  s_load_dwordx2 s[32:33], s[0:1], 56
  s_load_dwordx2 s[16:17], s[0:1], 0
  s_load_dwordx2 s[36:37], s[0:1], 72
  s_load_dwordx2 s[40:41], s[0:1], 64
  s_load_dwordx2 s[44:45], s[0:1], 80
  s_load_dwordx2 s[48:49], s[0:1], 88
  s_load_dwordx2 s[56:57], s[0:1], 40
  s_memrealtime s[64:65]
  v_lshrrev_b32 v4, 6, v0
  v_and_b32 v1, 63, v0
  v_readfirstlane_b32 s3, v4
  s_mov_b32 s10, 2097152
  s_mov_b32 s11, 0x20000
  s_mov_b32 s30, 4096
  s_mov_b32 s31, 0x20000
  s_mov_b32 s14, 2097152
  s_mov_b32 s15, 0x20000
  s_and_b32 s4, s2, 7
  s_lshr_b32 s5, s2, 3
  s_lshr_b32 s6, s3, 1
  s_lshl_b32 s60, s5, 1
  s_add_u32 s6, s6, s60
  s_and_b32 s7, s3, 1
  s_lshl_b32 s60, s4, 1
  s_add_u32 s7, s7, s60
  v_and_b32 v4, 7, v1
  v_lshrrev_b32 v5, 3, v1
  s_lshl_b32 s62, s6, 15
  s_lshl_b32 s61, s7, 6
  s_add_u32 s60, s62, s61
  v_lshlrev_b32 v6, 12, v5
  v_lshl_add_u32 v6, v4, 3, v6
  v_add_u32 v6, s60, v6
  v_subrev_u32 v7, 0xc00, v6
  s_lshl_b32 s60, s7, 8
  v_lshlrev_b32 v8, 5, v4
  v_add_u32 v8, s60, v8
  v_lshlrev_b32 v2, 4, v1
  s_mov_b32 s22, 18874368
  s_mov_b32 s23, 0x20000
  s_mov_b32 s26, 2097152
  s_mov_b32 s27, 0x20000
  s_mov_b32 s54, 256
  s_mov_b32 s55, 0x20000
  s_mov_b32 s34, 1835008
  s_mov_b32 s35, 0x20000
  s_mov_b32 s18, 2097152
  s_mov_b32 s19, 0x20000
  s_mov_b32 s38, 1835008
  s_mov_b32 s39, 0x20000
  s_mov_b32 s42, 3584
  s_mov_b32 s43, 0x20000
  s_mov_b32 s46, 1024
  s_mov_b32 s47, 0x20000
  s_mov_b32 s50, 2097152
  s_mov_b32 s51, 0x20000
  s_lshl_b32 s58, s4, 4
  s_lshr_b32 s61, s5, 1
  s_add_u32 s58, s58, s61
  s_lshl_b32 s69, s58, 2
  s_add_u32 s69, s69, s3
  s_lshl_b32 s61, s69, 1
  s_and_b32 s61, s61, 0xfffc
  s_waitcnt lgkmcnt(0)
  buffer_load_dwordx2 v[16:17], v7, s[8:11], 0 offen offset:0 nt
  buffer_load_dwordx2 v[18:19], v7, s[8:11], 0 offen offset:1024 nt
  buffer_load_dwordx2 v[20:21], v7, s[8:11], 0 offen offset:2048 nt
  buffer_load_dwordx2 v[22:23], v6, s[8:11], 0 offen offset:0 nt
  buffer_load_dwordx2 v[24:25], v6, s[8:11], 0 offen offset:1024 nt
  buffer_load_dwordx2 v[26:27], v6, s[8:11], 0 offen offset:2048 nt
  buffer_load_dwordx2 v[28:29], v6, s[8:11], 0 offen offset:3072 nt
  buffer_load_dwordx4 v[30:33], v8, s[28:31], 0 offen offset:0
  buffer_load_dwordx4 v[34:37], v8, s[28:31], 0 offen offset:16
  buffer_load_dwordx2 v[38:39], v6, s[12:15], 0 offen offset:0 nt
  buffer_load_dwordx2 v[40:41], v6, s[12:15], 0 offen offset:1024 nt
  buffer_load_dwordx2 v[42:43], v6, s[12:15], 0 offen offset:2048 nt
  buffer_load_dwordx2 v[44:45], v6, s[12:15], 0 offen offset:3072 nt
  s_load_dword s59, s[56:57], s61
  s_lshl_b32 s63, s4, 11
  s_add_u32 s63, s63, 6291456
  s_and_b32 s61, s5, 3
  s_lshl_b32 s61, s61, 2
  s_add_u32 s61, s61, s3
  s_lshl_b32 s61, s61, 6
  s_add_u32 s61, s61, s63
  s_load_dword s57, s[20:21], s61
  v_mov_b32 v66, 0
  v_mov_b32 v67, 0
  v_mov_b32 v68, 0
  v_mov_b32 v69, 0
  s_lshl_b32 s69, s69, 12
  s_mul_i32 s68, s3, 4352
  s_add_u32 s68, s68, 114688
  s_and_b32 s60, s5, 1
  s_lshl_b32 s61, s4, 5
  s_add_u32 s61, s61, s5
  s_lshl_b32 s61, s61, 2
  s_add_u32 s61, s61, s3
  s_lshl_b32 s61, s61, 11
  v_and_b32 v11, 15, v1
  v_lshl_add_u32 v9, v11, 7, s61
  s_lshl_b32 s66, s60, 19
  s_sub_u32 s67, 0x180000, s66
  s_lshl_b32 s61, s58, 6
  s_add_u32 s61, s61, 4194304
  s_add_u32 s66, s66, s61
  s_add_u32 s67, s67, s61
  v_lshrrev_b32 v3, 2, v0
  v_lshlrev_b32 v3, 13, v3
  v_and_b32 v10, 3, v1
  v_lshl_add_u32 v3, v10, 4, v3
  v_mov_b32 v46, -1
  v_mov_b32 v47, -1
  v_mov_b32 v48, -1
  v_mov_b32 v49, -1
  s_lshl_b32 s62, s4, 5
  s_add_u32 s62, s62, s5
  s_lshl_b32 s62, s62, 1
  s_add_u32 s62, s62, s3
  s_lshl_b32 s62, s62, 12
  s_add_u32 s62, s62, 4194304
  s_lshl_b32 s61, s2, 2
  s_add_u32 s61, s61, s3
  s_mul_i32 s61, s61, 1792
  v_min_u32 v62, 13, v11
  v_lshl_add_u32 v62, v62, 7, s61
  s_getpc_b64 s[8:9]
p_pc:
  s_sub_u32 s8, s8, p_pc-code_lo
  s_subb_u32 s9, s9, 0
  s_mov_b32 s10, code_end-code_lo
  s_mov_b32 s11, 0x20000
  s_lshl_b32 s61, s5, 2
  s_add_u32 s61, s61, s3
  s_lshl_b32 s61, s61, 8
  v_and_b32 v10, 1, v1
  v_lshl_add_u32 v63, v10, 7, s61
  s_mul_i32 s61, s4, 11
  s_lshr_b32 s61, s61, 5
  s_mul_i32 s61, s61, 3
  s_sub_u32 s94, s4, s61
  s_lshl_b32 s97, s94, 2
  s_lshl_b32 s94, s94, 15
  s_add_u32 s60, s94, 32768
  s_sub_u32 s61, s60, 98304
  s_min_u32 s95, s60, s61
  s_add_u32 s60, s94, 65536
  s_sub_u32 s61, s60, 98304
  s_min_u32 s96, s60, s61
  s_and_b32 s60, s5, 15
  s_mul_i32 s60, s60, 224
  v_lshl_add_u32 v54, v11, 4, s60
  s_barrier
  s_or_b32 s61, s3, s5
  s_cbranch_scc1 p_nozero
  buffer_store_dwordx4 v[66:69], v2, s[20:23], s63 offen offset:1024 sc1
p_nozero:
  buffer_load_dword v51, v63, s[8:11], 0 offen
  s_cmp_ge_u32 s3, 2
  s_cbranch_scc1 p_rb
  buffer_store_dwordx4 v[46:49], v2, s[20:23], s62 offen offset:0 sc1
  buffer_store_dwordx4 v[46:49], v2, s[20:23], s62 offen offset:1024 sc1
  buffer_store_dwordx4 v[46:49], v2, s[20:23], s62 offen offset:2048 sc1
  buffer_store_dwordx4 v[46:49], v2, s[20:23], s62 offen offset:3072 sc1
  s_branch p_rj
p_rb:
  s_lshr_b32 s12, s5, 3
  s_lshl_b32 s12, s12, 6
  s_and_b32 s13, s5, 3
  s_lshl_b32 s13, s13, 1
  s_add_u32 s12, s12, s13
  s_add_u32 s12, s12, s3
  s_sub_u32 s12, s12, 2
  s_mul_i32 s12, s12, 7168
  s_bfe_u32 s13, s5, 0x10002
  s_add_u32 s13, s13, s4
  v_min_u32 v50, 55, v1
  v_lshlrev_b32 v50, 7, v50
  buffer_load_dword v46, v2, s[44:47], 0 offen
  buffer_load_dword v47, v2, s[44:47], 0 offen
  buffer_load_dword v48, v2, s[44:47], 0 offen
  buffer_load_dword v49, v2, s[44:47], 0 offen
p_rj:
  buffer_load_dword v60, v54, s[40:43], 0 offen
  buffer_load_dword v55, v2, s[44:47], 0 offen
  v_mul_u32_u24 v15, 0x1249, v1
  v_add_u32 v15, 0x1249, v15
  v_lshrrev_b32 v15, 16, v15
  v_mul_u32_u24 v10, 14, v15
  v_sub_u32 v10, v1, v10
  v_add_u32 v12, s97, v10
  v_subrev_u32 v13, 12, v12
  v_min_u32 v12, v12, v13
  v_cmp_gt_u32 vcc, 12, v10
  s_nop 1
  v_cndmask_b32 v10, v10, v12, vcc
  v_mul_u32_u24 v15, 3584, v15
  v_lshl_add_u32 v15, v10, 4, v15
  v_lshrrev_b32 v10, 3, v1
  v_add_u32 v10, 1, v10
  v_lshrrev_b32 v10, 3, v10
  v_lshl_add_u32 v15, v10, 30, v15
  s_mul_i32 s61, s3, 458752
  s_add_u32 s28, s60, s61
  s_mul_i32 s29, s3, 28672
  s_mov_b32 s31, s4
  v_lshrrev_b32 v10, 4, v1
  v_mul_u32_u24 v12, 272, v10
  v_lshl_add_u32 v12, v11, 4, v12
  v_add_u32 v12, s68, v12
  v_mul_u32_u24 v13, 272, v4
  v_add_u32 v13, s68, v13
  v_lshl_add_u32 v13, v5, 3, v13
  v_and_b32 v10, 1, v10
  v_mul_u32_u24 v10, 17408, v10
  v_lshl_add_u32 v10, v11, 4, v10
  v_add_u32 v158, s68, v10
  v_lshrrev_b32 v10, 2, v1
  v_and_b32 v11, 3, v1
  v_lshlrev_b32 v10, 12, v10
  v_lshl_add_u32 v157, v11, 4, v10
  s_lshl_b32 s14, s4, 18
  s_lshr_b32 s15, s69, 6
  s_and_b32 s15, s15, 0xfc0
  s_add_u32 s15, s15, s14
  s_lshl_b32 s61, s6, 12
  s_add_u32 s14, s14, s61
  s_and_b32 s61, s3, 1
  s_lshl_b32 s61, s61, 11
  s_add_u32 s14, s14, s61
  s_and_b32 s61, s3, 1
  s_lshl_b32 s61, s61, 9
  s_lshl_b32 s10, s5, 3
  s_add_u32 s10, s10, s61
  s_add_u32 s10, s10, s63
  s_mov_b32 s6, 0xffff0000
  s_mov_b32 s7, 0x3f803f80
  s_getreg_b32 s58, hwreg(HW_REG_XCC_ID)
  s_and_b32 s58, s58, 7
  s_sub_u32 s64, s64, 300
  s_subb_u32 s65, s65, 0
  s_andn2_b32 s64, s64, 7
  s_or_b32 s64, s64, s58
  v_mov_b32 v56, s64
  v_mov_b32 v57, s65
  s_lshr_b32 s11, s5, 4
  s_lshl_b32 s11, s11, 9
  s_add_u32 s11, s11, s63
  v_and_b32 v14, 31, v1
  v_lshlrev_b32 v14, 3, v14
  v_and_b32 v11, 15, v1
  v_lshlrev_b32 v11, 2, v11
  s_lshl_b32 s61, s3, 8
  v_add_u32 v11, s61, v11
  s_cmp_eq_u32 s61, 0
  s_cselect_b32 s97, 1, 0
  s_waitcnt vmcnt(19)
  v_lshlrev_b32 v70, 16, v16
  v_and_b32 v71, s6, v16
  v_lshlrev_b32 v72, 16, v17
  v_and_b32 v73, s6, v17
  s_waitcnt vmcnt(18)
  v_lshlrev_b32 v74, 16, v18
  v_and_b32 v75, s6, v18
  v_lshlrev_b32 v76, 16, v19
  v_and_b32 v77, s6, v19
  s_waitcnt vmcnt(17)
  v_lshlrev_b32 v78, 16, v20
  v_and_b32 v79, s6, v20
  v_lshlrev_b32 v80, 16, v21
  v_and_b32 v81, s6, v21
  s_waitcnt vmcnt(16)
  v_lshlrev_b32 v82, 16, v22
  v_and_b32 v83, s6, v22
  v_lshlrev_b32 v84, 16, v23
  v_and_b32 v85, s6, v23
  s_waitcnt vmcnt(15)
  v_lshlrev_b32 v86, 16, v24
  v_and_b32 v87, s6, v24
  v_lshlrev_b32 v88, 16, v25
  v_and_b32 v89, s6, v25
  s_waitcnt vmcnt(14)
  v_lshlrev_b32 v90, 16, v26
  v_and_b32 v91, s6, v26
  v_lshlrev_b32 v92, 16, v27
  v_and_b32 v93, s6, v27
  s_waitcnt vmcnt(13)
  v_lshlrev_b32 v94, 16, v28
  v_and_b32 v95, s6, v28
  v_lshlrev_b32 v96, 16, v29
  v_and_b32 v97, s6, v29
  s_add_u32 m0, s68, 17664
  s_nop 0
  buffer_load_dwordx4 v2, s[24:27], s69 offen offset:0 nt lds
  buffer_load_dwordx4 v2, s[24:27], s69 offen offset:1024 nt lds
  buffer_load_dwordx4 v2, s[24:27], s69 offen offset:2048 nt lds
  buffer_load_dwordx4 v2, s[24:27], s69 offen offset:3072 nt lds
  s_memrealtime s[64:65]
  s_waitcnt vmcnt(16)
  v_lshlrev_b32 v98, 16, v30
  v_and_b32 v102, s6, v30
  v_lshlrev_b32 v106, 16, v31
  v_and_b32 v110, s6, v31
  v_lshlrev_b32 v99, 16, v32
  v_and_b32 v103, s6, v32
  v_lshlrev_b32 v107, 16, v33
  v_and_b32 v111, s6, v33
  s_waitcnt vmcnt(15)
  v_lshlrev_b32 v100, 16, v34
  v_and_b32 v104, s6, v34
  v_lshlrev_b32 v108, 16, v35
  v_and_b32 v112, s6, v35
  v_lshlrev_b32 v101, 16, v36
  v_and_b32 v105, s6, v36
  v_lshlrev_b32 v109, 16, v37
  v_and_b32 v113, s6, v37
  v_pk_mul_f32 v[130:131], v[82:83], v[98:99]
  v_pk_mul_f32 v[132:133], v[84:85], v[100:101]
  v_pk_mul_f32 v[134:135], v[86:87], v[98:99]
  v_pk_mul_f32 v[136:137], v[88:89], v[100:101]
  v_pk_mul_f32 v[138:139], v[90:91], v[98:99]
  v_pk_mul_f32 v[140:141], v[92:93], v[100:101]
  v_pk_mul_f32 v[142:143], v[94:95], v[98:99]
  v_pk_mul_f32 v[144:145], v[96:97], v[100:101]
  v_pk_fma_f32 v[130:131], v[78:79], v[102:103], v[130:131]
  v_pk_fma_f32 v[132:133], v[80:81], v[104:105], v[132:133]
  v_pk_fma_f32 v[134:135], v[82:83], v[102:103], v[134:135]
  v_pk_fma_f32 v[136:137], v[84:85], v[104:105], v[136:137]
  v_pk_fma_f32 v[138:139], v[86:87], v[102:103], v[138:139]
  v_pk_fma_f32 v[140:141], v[88:89], v[104:105], v[140:141]
  v_pk_fma_f32 v[142:143], v[90:91], v[102:103], v[142:143]
  v_pk_fma_f32 v[144:145], v[92:93], v[104:105], v[144:145]
  v_pk_fma_f32 v[130:131], v[74:75], v[106:107], v[130:131]
  v_pk_fma_f32 v[132:133], v[76:77], v[108:109], v[132:133]
  v_pk_fma_f32 v[134:135], v[78:79], v[106:107], v[134:135]
  v_pk_fma_f32 v[136:137], v[80:81], v[108:109], v[136:137]
  v_pk_fma_f32 v[138:139], v[82:83], v[106:107], v[138:139]
  v_pk_fma_f32 v[140:141], v[84:85], v[108:109], v[140:141]
  v_pk_fma_f32 v[142:143], v[86:87], v[106:107], v[142:143]
  v_pk_fma_f32 v[144:145], v[88:89], v[108:109], v[144:145]
  v_pk_fma_f32 v[130:131], v[70:71], v[110:111], v[130:131]
  v_pk_fma_f32 v[132:133], v[72:73], v[112:113], v[132:133]
  v_pk_fma_f32 v[134:135], v[74:75], v[110:111], v[134:135]
  v_pk_fma_f32 v[136:137], v[76:77], v[112:113], v[136:137]
  v_pk_fma_f32 v[138:139], v[78:79], v[110:111], v[138:139]
  v_pk_fma_f32 v[140:141], v[80:81], v[112:113], v[140:141]
  v_pk_fma_f32 v[142:143], v[82:83], v[110:111], v[142:143]
  v_pk_fma_f32 v[144:145], v[84:85], v[112:113], v[144:145]
  s_waitcnt vmcnt(14)
  v_lshlrev_b32 v114, 16, v38
  v_and_b32 v115, s6, v38
  v_lshlrev_b32 v116, 16, v39
  v_and_b32 v117, s6, v39
  s_waitcnt vmcnt(13)
  v_lshlrev_b32 v118, 16, v40
  v_and_b32 v119, s6, v40
  v_lshlrev_b32 v120, 16, v41
  v_and_b32 v121, s6, v41
  s_waitcnt vmcnt(12)
  v_lshlrev_b32 v122, 16, v42
  v_and_b32 v123, s6, v42
  v_lshlrev_b32 v124, 16, v43
  v_and_b32 v125, s6, v43
  s_waitcnt vmcnt(11)
  v_lshlrev_b32 v126, 16, v44
  v_and_b32 v127, s6, v44
  v_lshlrev_b32 v128, 16, v45
  v_and_b32 v129, s6, v45
  v_pk_mul_f32 v[130:131], v[130:131], v[114:115]
  v_pk_mul_f32 v[132:133], v[132:133], v[116:117]
  v_pk_mul_f32 v[134:135], v[134:135], v[118:119]
  v_pk_mul_f32 v[136:137], v[136:137], v[120:121]
  v_pk_mul_f32 v[138:139], v[138:139], v[122:123]
  v_pk_mul_f32 v[140:141], v[140:141], v[124:125]
  v_pk_mul_f32 v[142:143], v[142:143], v[126:127]
  v_pk_mul_f32 v[144:145], v[144:145], v[128:129]
  v_cvt_pk_bf16_f32 v146, v130, v134
  v_cvt_pk_bf16_f32 v147, v138, v142
  ds_write_b64 v13, v[146:147] offset:0
  v_cvt_pk_bf16_f32 v148, v131, v135
  v_cvt_pk_bf16_f32 v149, v139, v143
  ds_write_b64 v13, v[148:149] offset:64
  v_cvt_pk_bf16_f32 v150, v132, v136
  v_cvt_pk_bf16_f32 v151, v140, v144
  ds_write_b64 v13, v[150:151] offset:128
  v_cvt_pk_bf16_f32 v152, v133, v137
  v_cvt_pk_bf16_f32 v153, v141, v145
  ds_write_b64 v13, v[152:153] offset:192
  s_add_u32 s62, s14, 4096
  s_cmp_ge_u32 s3, 2
  s_waitcnt lgkmcnt(0)
  s_barrier
  s_cbranch_scc1 p_nou
  ds_read_b128 v[70:73], v12 offset:0
  ds_read_b128 v[74:77], v12 offset:1088
  ds_read_b128 v[78:81], v12 offset:8704
  ds_read_b128 v[82:85], v12 offset:9792
  s_waitcnt lgkmcnt(3)
  buffer_store_dwordx4 v[70:73], v2, s[20:23], s14 offen offset:0 sc1
  s_waitcnt lgkmcnt(2)
  buffer_store_dwordx4 v[74:77], v2, s[20:23], s14 offen offset:1024 sc1
  s_waitcnt lgkmcnt(1)
  buffer_store_dwordx4 v[78:81], v2, s[20:23], s62 offen offset:0 sc1
  s_waitcnt lgkmcnt(0)
  buffer_store_dwordx4 v[82:85], v2, s[20:23], s62 offen offset:1024 sc1
p_nou:
  s_barrier
  ds_write_b128 v158, v[66:69]
  s_mul_i32 s30, s31, 3584
  s_add_u32 m0, s30, s29
  s_lshl4_add_u32 s30, s30, s28
  buffer_load_dwordx4 v15, s[32:35], s30 offen offset:0 lds
  s_add_u32 s30, s30, 13440
  buffer_load_dwordx4 v15, s[32:35], s30 offen offset:896 lds
  s_add_u32 s30, s30, 13440
  buffer_load_dwordx4 v15, s[32:35], s30 offen offset:1792 lds
  s_add_u32 s30, s30, 13440
  s_mov_b32 exec_hi, 0x00ffffff
  buffer_load_dwordx4 v15, s[32:35], s30 offen offset:2688 lds
  s_mov_b32 exec_hi, -1
  v_and_b32 v8, 3, v1
  v_bfe_u32 v9, v1, 2, 2
  v_lshrrev_b32 v10, 4, v1
  v_lshlrev_b32 v10, 6, v10
  v_lshlrev_b32 v4, 5, v8
  v_lshl_add_u32 v4, v9, 3, v4
  v_sub_u32 v4, v4, v10
  s_add_u32 s63, s68, 224
  v_add_u32 v4, s63, v4
  v_sub_u32 v5, v8, v9
  v_lshl_add_u32 v5, v5, 3, v10
  s_add_u32 s63, s68, 17664
  v_add_u32 v5, s63, v5
  s_lshl_b32 s63, s3, 1
  s_add_u32 s63, s63, 149504
  v_lshlrev_b32 v6, 3, v1
  v_add_u32 v6, s63, v6
  s_add_u32 s63, s68, 256
  v_lshlrev_b32 v7, 1, v1
  v_add_u32 v7, s63, v7
  s_and_b32 s63, s3, 1
  s_lshl_b32 s63, s63, 4
  s_lshr_b32 s59, s59, s63
  s_lshl_b32 s59, s59, 16
  s_and_b32 s56, s4, 3
  v_lshrrev_b32 v10, 3, v1
  v_and_b32 v12, 7, v1
  v_lshlrev_b32 v8, 12, v10
  v_lshl_add_u32 v8, v12, 4, v8
  s_and_b32 s61, s56, 1
  v_lshrrev_b32 v10, 5, v1
  v_xor_b32 v12, s61, v10
  v_mul_u32_u24 v12, 114688, v12
  v_lshlrev_b32 v10, 14, v10
  v_sub_u32 v10, v12, v10
  v_add_u32 v10, 98304, v10
  v_add_u32 v9, v10, v8
  s_mul_i32 s60, s3, 458752
  s_and_b32 s61, s5, 7
  s_lshl_b32 s61, s61, 7
  s_add_u32 s60, s60, s61
  s_xor_b32 s61, s56, 0
  s_mul_i32 s61, s61, 114688
  s_add_u32 s24, s60, s61
  s_xor_b32 s61, s56, 1
  s_mul_i32 s61, s61, 114688
  s_add_u32 s25, s60, s61
  s_xor_b32 s61, s56, 2
  s_mul_i32 s61, s61, 114688
  s_add_u32 s26, s60, s61
  s_xor_b32 s61, s56, 3
  s_mul_i32 s61, s61, 114688
  s_add_u32 s27, s60, s61
  v_mov_b32 v26, v62
  s_lshl_b32 s60, s4, 5
  s_add_u32 s60, s60, s5
  s_lshl_b32 s61, s60, 13
  s_lshl_b32 s63, s3, 8
  s_add_u32 s61, s61, s63
  v_and_b32 v10, 3, v1
  v_lshrrev_b32 v12, 2, v1
  v_lshl_add_u32 v24, v10, 11, s61
  v_lshl_add_u32 v24, v12, 3, v24
  s_lshl_b32 s61, s5, 2
  s_add_u32 s61, s61, s3
  s_mul_i32 s61, s61, 14336
  v_and_b32 v10, 15, v1
  v_min_u32 v10, 13, v10
  v_lshl_add_u32 v29, v10, 10, s61
  v_add_u32 v29, 384, v29
  s_lshl_b32 s61, s4, 11
  s_add_u32 s61, s61, 6292480
  v_and_b32 v10, 7, v1
  v_lshl_add_u32 v25, v10, 7, s61
  s_andn2_b32 s64, s64, 7
  s_or_b32 s64, s64, s58
  v_mov_b32 v64, s64
  v_mov_b32 v65, s65
  s_cmp_ge_u32 s3, 2
  s_cbranch_scc1 p_nom1
  s_mov_b64 exec, 1
  s_waitcnt vmcnt(4)
  buffer_store_dwordx2 v[64:65], v66, s[20:23], s10 offen
  s_mov_b64 exec, -1
p_nom1:
  buffer_load_dwordx2 v[16:17], v14, s[20:23], s11 offen sc1
  s_waitcnt vmcnt(5)
  ds_read_b64_tr_b16 v[192:193], v5 offset:32
  ds_read_b64_tr_b16 v[194:195], v5 offset:0
  ds_read_b64_tr_b16 v[196:197], v5 offset:288
  ds_read_b64_tr_b16 v[198:199], v5 offset:256
  ds_read_b64_tr_b16 v[200:201], v5 offset:544
  ds_read_b64_tr_b16 v[202:203], v5 offset:512
  ds_read_b64_tr_b16 v[204:205], v5 offset:800
  ds_read_b64_tr_b16 v[206:207], v5 offset:768
  ds_read_b64_tr_b16 v[208:209], v5 offset:1056
  ds_read_b64_tr_b16 v[210:211], v5 offset:1024
  ds_read_b64_tr_b16 v[212:213], v5 offset:1312
  ds_read_b64_tr_b16 v[214:215], v5 offset:1280
  s_waitcnt lgkmcnt(8)
  ds_read_b64_tr_b16 v[216:217], v5 offset:1568
  ds_read_b64_tr_b16 v[218:219], v5 offset:1536
  ds_read_b64_tr_b16 v[220:221], v5 offset:1824
  ds_read_b64_tr_b16 v[222:223], v5 offset:1792
  ds_read_b64_tr_b16 a[224:225], v5 offset:2080
  ds_read_b64_tr_b16 a[226:227], v5 offset:2048
  s_waitcnt lgkmcnt(8)
  ds_read_b64_tr_b16 a[228:229], v5 offset:2336
  ds_read_b64_tr_b16 a[230:231], v5 offset:2304
  ds_read_b64_tr_b16 a[232:233], v5 offset:2592
  ds_read_b64_tr_b16 a[234:235], v5 offset:2560
  ds_read_b64_tr_b16 a[236:237], v5 offset:2848
  ds_read_b64_tr_b16 a[238:239], v5 offset:2816
  s_waitcnt lgkmcnt(8)
  ds_read_b64_tr_b16 a[240:241], v5 offset:3104
  ds_read_b64_tr_b16 a[242:243], v5 offset:3072
  ds_read_b64_tr_b16 a[244:245], v5 offset:3360
  ds_read_b64_tr_b16 a[246:247], v5 offset:3328
  ds_read_b64_tr_b16 a[248:249], v5 offset:3616
  ds_read_b64_tr_b16 a[250:251], v5 offset:3584
  s_waitcnt lgkmcnt(8)
  ds_read_b64_tr_b16 a[252:253], v5 offset:3872
  ds_read_b64_tr_b16 a[254:255], v5 offset:3840
  s_mov_b32 s60, 0
  s_add_u32 m0, s68, 256
  s_mov_b32 s61, 0xfffc0007
  s_waitcnt vmcnt(0)
  v_sub_co_u32 v16, vcc, v16, v56
  s_nop 1
  v_subb_co_u32 v17, vcc, v17, v57, vcc
  v_and_or_b32 v16, v16, s61, v17
  v_cmp_ne_u32 vcc, 0, v16
  s_nop 4
  s_cbranch_vccz p_go
p_pa:
  buffer_load_dwordx2 v[16:17], v14, s[20:23], s11 offen sc1
  s_add_u32 s60, s60, 1
  s_waitcnt vmcnt(0)
  v_sub_co_u32 v16, vcc, v16, v56
  s_nop 1
  v_subb_co_u32 v17, vcc, v17, v57, vcc
  v_and_or_b32 v16, v16, s61, v17
  v_cmp_ne_u32 vcc, 0, v16
  s_and_b32 s62, s60, 3
  s_nop 3
  s_cbranch_vccz p_go
  s_cbranch_scc1 p_pa
  s_memrealtime s[64:65]
  s_waitcnt lgkmcnt(0)
  s_andn2_b32 s64, s64, 7
  s_or_b32 s64, s64, s58
  v_mov_b32 v64, s64
  v_mov_b32 v65, s65
  s_cmp_ge_u32 s3, 2
  s_cbranch_scc1 p_nom0
  s_mov_b64 exec, 1
  buffer_store_dwordx2 v[64:65], v66, s[20:23], s10 offen
  s_mov_b64 exec, -1
p_nom0:
  s_cmp_lt_u32 s60, 48
  s_cbranch_scc1 p_pa
  s_lshl_b32 s63, s4, 2
  s_cmp_lg_u32 s60, 48
  s_cbranch_scc1 p_told
  s_lshl_b32 s62, 0x10000, s58
  v_mov_b32 v17, s62
  v_mov_b32 v18, 1
  s_mov_b64 exec, 1
  s_waitcnt vmcnt(0)
  buffer_atomic_or v17, v66, s[52:55], s63 offen offset:224 sc1
  buffer_atomic_add v18, v66, s[52:55], s63 offen offset:224 sc1
  s_mov_b64 exec, -1
p_told:
  buffer_load_dword v17, v66, s[52:55], s63 offen offset:224 sc1
  s_waitcnt vmcnt(0)
  v_lshrrev_b32 v18, 16, v17
  v_and_b32 v17, 0xffff, v17
  v_subrev_u32 v19, 1, v18
  v_and_b32 v18, v18, v19
  v_cmp_eq_u32 vcc, 0x80, v17
  s_nop 1
  v_cndmask_b32 v18, 0, v18, vcc
  v_cmp_ne_u32 vcc, 0, v18
  s_cmp_lt_u32 s60, 4000
  s_nop 3
  s_cbranch_vccnz slow_entry
  s_cbranch_scc1 p_pa
p_go:
  buffer_load_dwordx4 v157, s[20:23], s15 offen offset:0 sc1 lds
  s_add_u32 s15, s15, 64512
  buffer_load_dwordx4 v157, s[20:23], s15 offen offset:1024 sc1 lds
  s_add_u32 s15, s15, 64512
  buffer_load_dwordx4 v157, s[20:23], s15 offen offset:2048 sc1 lds
  s_add_u32 s15, s15, 64512
  buffer_load_dwordx4 v157, s[20:23], s15 offen offset:3072 sc1 lds
  s_and_b32 s61, s5, 15
  s_or_b32 s61, s61, s3
  s_cbranch_scc1 f_nosig
  v_mov_b32 v17, 1
  s_lshl_b32 s61, s4, 2
  s_lshl_b32 s62, s5, 1
  s_add_u32 s61, s61, s62
  s_mov_b64 exec, 1
  buffer_store_dword v17, v66, s[52:55], s61 offen sc1
  s_mov_b64 exec, -1
f_nosig:
  buffer_load_dwordx2 v[16:17], v24, s[16:19], 0 offen offset:0 nt
  s_and_b32 s62, s5, 1
  v_lshlrev_b32 v10, 4, v0
  v_add_u32 v10, 149504, v10
  s_mov_b32 s14, 0
  s_mov_b32 s15, 0x80000000
  v_mov_b32 v12, 0
  v_mov_b32 v13, 0
  s_lshr_b32 s60, s5, 4
  s_lshl_b32 s60, s60, 2
  s_add_u32 s60, s60, s3
  s_lshl_b32 s61, s4, 3
  s_add_u32 s58, s60, s61
  s_cmp_lg_u32 s62, 0
  s_cbranch_scc1 f_cv_h1
f_cv_h0:
  s_waitcnt vmcnt(4)
  ds_read_b64_tr_b16 v[64:65], v4 offset:0
  ds_read_b64_tr_b16 v[66:67], v4 offset:32
  ds_read_b64_tr_b16 v[68:69], v4 offset:128
  ds_read_b64_tr_b16 v[70:71], v4 offset:160
  ds_read_b64_tr_b16 v[72:73], v4 offset:256
  ds_read_b64_tr_b16 v[74:75], v4 offset:288
  ds_read_b64_tr_b16 v[76:77], v4 offset:384
  ds_read_b64_tr_b16 v[78:79], v4 offset:416
  ds_read_b64_tr_b16 v[80:81], v4 offset:512
  ds_read_b64_tr_b16 v[82:83], v4 offset:544
  s_waitcnt lgkmcnt(8)
  v_mfma_f32_16x16x32_bf16 v[32:35], v[64:67], v[192:195], 0
  ds_read_b64_tr_b16 v[84:85], v4 offset:640
  s_waitcnt lgkmcnt(7)
  v_mfma_f32_16x16x32_bf16 v[36:39], v[68:71], v[192:195], 0
  ds_read_b64_tr_b16 v[86:87], v4 offset:672
  ds_read_b64_tr_b16 v[88:89], v4 offset:768
  v_mfma_f32_16x16x32_bf16 v[40:43], v[64:67], v[196:199], 0
  ds_read_b64_tr_b16 v[90:91], v4 offset:800
  ds_read_u16_d16_hi v12, v7 offset:0
  v_mfma_f32_16x16x32_bf16 v[44:47], v[68:71], v[196:199], 0
  ds_read_u16_d16_hi v13, v7 offset:128
  s_waitcnt lgkmcnt(10)
  v_mfma_f32_16x16x32_bf16 v[40:43], v[72:75], v[192:195], v[40:43]
  ds_read_b64_tr_b16 v[92:93], v4 offset:896
  s_waitcnt lgkmcnt(7)
  v_mfma_f32_16x16x32_bf16 v[44:47], v[76:79], v[192:195], v[44:47]
  ds_read_b64_tr_b16 v[94:95], v4 offset:928
  s_waitcnt vmcnt(3)
  ds_read_b64_tr_b16 v[100:101], v4 offset:1152
  v_mfma_f32_16x16x32_bf16 v[48:51], v[64:67], v[200:203], 0
  ds_read_b64_tr_b16 v[102:103], v4 offset:1184
  buffer_load_dwordx2 v[18:19], v24, s[16:19], 0 offen offset:1024 nt
  v_mfma_f32_16x16x32_bf16 v[52:55], v[68:71], v[200:203], 0
  v_cndmask_b32 v57, v39, v35, s[14:15]
  v_add_f32_dpp v34, v35, v34 wave_shr:1 row_mask:0xf bank_mask:0xf bound_ctrl:0
  v_mfma_f32_16x16x32_bf16 v[48:51], v[72:75], v[196:199], v[48:51]
  v_add_f32_dpp v38, v57, v38 wave_ror:1 row_mask:0xf bank_mask:0xf
  v_cndmask_b32 v57, v38, v34, s[14:15]
  v_mfma_f32_16x16x32_bf16 v[52:55], v[76:79], v[196:199], v[52:55]
  v_add_f32_dpp v33, v34, v33 wave_shr:1 row_mask:0xf bank_mask:0xf bound_ctrl:0
  v_add_f32_dpp v37, v57, v37 wave_ror:1 row_mask:0xf bank_mask:0xf
  v_mfma_f32_16x16x32_bf16 v[48:51], v[80:83], v[192:195], v[48:51]
  ds_read_b64_tr_b16 v[108:109], v4 offset:1408
  s_waitcnt lgkmcnt(3)
  v_mfma_f32_16x16x32_bf16 v[52:55], v[84:87], v[192:195], v[52:55]
  ds_read_b64_tr_b16 v[110:111], v4 offset:1440
  ds_read_b64_tr_b16 v[116:117], v4 offset:1664
  v_mfma_f32_16x16x32_bf16 v[224:227], v[64:67], v[204:207], 0
  ds_read_b64_tr_b16 v[118:119], v4 offset:1696
  buffer_load_dwordx2 v[20:21], v24, s[16:19], 0 offen offset:128 nt
  v_mfma_f32_16x16x32_bf16 v[228:231], v[68:71], v[204:207], 0
  v_cndmask_b32 v57, v37, v33, s[14:15]
  v_add_f32_dpp v32, v33, v32 wave_shr:1 row_mask:0xf bank_mask:0xf bound_ctrl:0
  v_mfma_f32_16x16x32_bf16 v[224:227], v[72:75], v[200:203], v[224:227]
  v_add_f32_dpp v36, v57, v36 wave_ror:1 row_mask:0xf bank_mask:0xf
  v_fma_f32 v58, v12, s59, v32
  v_mfma_f32_16x16x32_bf16 v[228:231], v[76:79], v[200:203], v[228:231]
  v_fma_f32 v59, v13, s59, v36
  v_cvt_pk_bf16_f32 v58, v58, v59
  v_mfma_f32_16x16x32_bf16 v[224:227], v[80:83], v[196:199], v[224:227]
  ds_write_b16 v6, v58 offset:0
  ds_write_b16_d16_hi v6, v58 offset:512
  v_mfma_f32_16x16x32_bf16 v[228:231], v[84:87], v[196:199], v[228:231]
  ds_read_u16_d16_hi v12, v7 offset:256
  ds_read_u16_d16_hi v13, v7 offset:384
  v_mfma_f32_16x16x32_bf16 v[224:227], v[88:91], v[192:195], v[224:227]
  ds_read_b64_tr_b16 v[124:125], v4 offset:1920
  ds_read_b64_tr_b16 v[126:127], v4 offset:1952
  v_mfma_f32_16x16x32_bf16 v[228:231], v[92:95], v[192:195], v[228:231]
  s_waitcnt vmcnt(4)
  ds_read_b64_tr_b16 v[132:133], v4 offset:2176
  v_mfma_f32_16x16x32_bf16 v[232:235], v[68:71], a[236:239], 0
  buffer_load_dwordx2 v[22:23], v24, s[16:19], 0 offen offset:1152 nt
  v_cndmask_b32 v56, v43, v39, s[14:15]
  v_mfma_f32_16x16x32_bf16 v[232:235], v[76:79], a[232:235], v[232:235]
  v_cndmask_b32 v57, v47, v43, s[14:15]
  v_add_f32_dpp v42, v56, v42 wave_ror:1 row_mask:0xf bank_mask:0xf
  v_mfma_f32_16x16x32_bf16 v[232:235], v[84:87], a[228:231], v[232:235]
  v_add_f32_dpp v46, v57, v46 wave_ror:1 row_mask:0xf bank_mask:0xf
  v_cndmask_b32 v56, v42, v38, s[14:15]
  v_mfma_f32_16x16x32_bf16 v[232:235], v[92:95], a[224:227], v[232:235]
  v_cndmask_b32 v57, v46, v42, s[14:15]
  s_waitcnt lgkmcnt(1)
  v_mfma_f32_16x16x32_bf16 v[232:235], v[100:103], v[220:223], v[232:235]
  ds_read_b64_tr_b16 v[134:135], v4 offset:2208
  ds_read_b64_tr_b16 v[140:141], v4 offset:2432
  v_mfma_f32_16x16x32_bf16 v[232:235], v[108:111], v[216:219], v[232:235]
  ds_read_b64_tr_b16 v[142:143], v4 offset:2464
  ds_read_b64_tr_b16 v[148:149], v4 offset:2688
  v_mfma_f32_16x16x32_bf16 v[232:235], v[116:119], v[212:215], v[232:235]
  ds_read_b64_tr_b16 v[150:151], v4 offset:2720
  ds_read_b64_tr_b16 v[156:157], v4 offset:2944
  v_mfma_f32_16x16x32_bf16 v[232:235], v[124:127], v[208:211], v[232:235]
  ds_read_b64_tr_b16 v[158:159], v4 offset:2976
  s_waitcnt lgkmcnt(6)
  v_mfma_f32_16x16x32_bf16 v[232:235], v[132:135], v[204:207], v[232:235]
  ds_read_b64_tr_b16 v[96:97], v4 offset:1024
  s_waitcnt lgkmcnt(5)
  v_mfma_f32_16x16x32_bf16 v[232:235], v[140:143], v[200:203], v[232:235]
  ds_read_b64_tr_b16 v[98:99], v4 offset:1056
  s_waitcnt lgkmcnt(4)
  v_mfma_f32_16x16x32_bf16 v[232:235], v[148:151], v[196:199], v[232:235]
  ds_read_b64_tr_b16 v[104:105], v4 offset:1280
  s_waitcnt lgkmcnt(3)
  v_mfma_f32_16x16x32_bf16 v[232:235], v[156:159], v[192:195], v[232:235]
  ds_read_b64_tr_b16 v[106:107], v4 offset:1312
  ds_read_b64_tr_b16 v[112:113], v4 offset:1536
  v_mfma_f32_16x16x32_bf16 v[236:239], v[64:67], a[240:243], 0
  ds_read_b64_tr_b16 v[114:115], v4 offset:1568
  ds_read_b64_tr_b16 v[120:121], v4 offset:1792
  v_mfma_f32_16x16x32_bf16 v[240:243], v[68:71], a[240:243], 0
  ds_read_b64_tr_b16 v[122:123], v4 offset:1824
  ds_read_b64_tr_b16 v[128:129], v4 offset:2048
  v_mfma_f32_16x16x32_bf16 v[236:239], v[72:75], a[236:239], v[236:239]
  ds_read_b64_tr_b16 v[130:131], v4 offset:2080
  buffer_load_dword v25, v25, s[20:23], 0 offen
  v_mfma_f32_16x16x32_bf16 v[240:243], v[76:79], a[236:239], v[240:243]
  v_add_f32_dpp v41, v56, v41 wave_ror:1 row_mask:0xf bank_mask:0xf
  v_add_f32_dpp v45, v57, v45 wave_ror:1 row_mask:0xf bank_mask:0xf
  v_mfma_f32_16x16x32_bf16 v[236:239], v[80:83], a[232:235], v[236:239]
  buffer_load_dword v28, v26, s[36:39], 0 offen
  v_cndmask_b32 v56, v41, v37, s[14:15]
  v_mfma_f32_16x16x32_bf16 v[240:243], v[84:87], a[232:235], v[240:243]
  v_cndmask_b32 v57, v45, v41, s[14:15]
  v_add_f32_dpp v40, v56, v40 wave_ror:1 row_mask:0xf bank_mask:0xf
  v_mfma_f32_16x16x32_bf16 v[236:239], v[88:91], a[228:231], v[236:239]
  v_add_f32_dpp v44, v57, v44 wave_ror:1 row_mask:0xf bank_mask:0xf
  v_fma_f32 v58, v12, s59, v40
  v_mfma_f32_16x16x32_bf16 v[240:243], v[92:95], a[228:231], v[240:243]
  v_fma_f32 v59, v13, s59, v44
  s_waitcnt lgkmcnt(0)
  v_mfma_f32_16x16x32_bf16 v[236:239], v[96:99], a[224:227], v[236:239]
  ds_read_b64_tr_b16 v[136:137], v4 offset:2304
  ds_read_b64_tr_b16 v[138:139], v4 offset:2336
  v_mfma_f32_16x16x32_bf16 v[240:243], v[100:103], a[224:227], v[240:243]
  v_cvt_pk_bf16_f32 v58, v58, v59
  ds_write_b16 v6, v58 offset:1024
  v_mfma_f32_16x16x32_bf16 v[236:239], v[104:107], v[220:223], v[236:239]
  ds_read_b64_tr_b16 v[144:145], v4 offset:2560
  ds_read_b64_tr_b16 v[146:147], v4 offset:2592
  v_mfma_f32_16x16x32_bf16 v[240:243], v[108:111], v[220:223], v[240:243]
  ds_write_b16_d16_hi v6, v58 offset:1536
  ds_read_u16_d16_hi v12, v7 offset:512
  v_mfma_f32_16x16x32_bf16 v[236:239], v[112:115], v[216:219], v[236:239]
  ds_read_b64_tr_b16 v[152:153], v4 offset:2816
  ds_read_b64_tr_b16 v[154:155], v4 offset:2848
  v_mfma_f32_16x16x32_bf16 v[240:243], v[116:119], v[216:219], v[240:243]
  buffer_load_dword v29, v29, s[36:39], 0 offen
  ds_read_u16_d16_hi v13, v7 offset:640
  v_mfma_f32_16x16x32_bf16 v[236:239], v[120:123], v[212:215], v[236:239]
  s_waitcnt vmcnt(7)
  ds_read_b64_tr_b16 v[160:161], v4 offset:3072
  v_mfma_f32_16x16x32_bf16 v[240:243], v[124:127], v[212:215], v[240:243]
  ds_read_b64_tr_b16 v[162:163], v4 offset:3104
  v_cndmask_b32 v56, v51, v47, s[14:15]
  v_mfma_f32_16x16x32_bf16 v[236:239], v[128:131], v[208:211], v[236:239]
  ds_read_b64_tr_b16 v[164:165], v4 offset:3200
  v_cndmask_b32 v57, v55, v51, s[14:15]
  v_mfma_f32_16x16x32_bf16 v[240:243], v[132:135], v[208:211], v[240:243]
  v_add_f32_dpp v50, v56, v50 wave_ror:1 row_mask:0xf bank_mask:0xf
  s_waitcnt lgkmcnt(4)
  v_mfma_f32_16x16x32_bf16 v[236:239], v[136:139], v[204:207], v[236:239]
  ds_read_b64_tr_b16 v[166:167], v4 offset:3232
  ds_read_b64_tr_b16 v[168:169], v4 offset:3328
  v_mfma_f32_16x16x32_bf16 v[240:243], v[140:143], v[204:207], v[240:243]
  ds_read_b64_tr_b16 v[170:171], v4 offset:3360
  v_add_f32_dpp v54, v57, v54 wave_ror:1 row_mask:0xf bank_mask:0xf
  v_mfma_f32_16x16x32_bf16 v[236:239], v[144:147], v[200:203], v[236:239]
  ds_read_b64_tr_b16 v[172:173], v4 offset:3456
  ds_read_b64_tr_b16 v[174:175], v4 offset:3488
  v_mfma_f32_16x16x32_bf16 v[240:243], v[148:151], v[200:203], v[240:243]
  s_add_u32 s31, s31, 1
  s_and_b32 s31, s31, 7
  v_mfma_f32_16x16x32_bf16 v[236:239], v[152:155], v[196:199], v[236:239]
  ds_read_b64_tr_b16 v[176:177], v4 offset:3584
  ds_read_b64_tr_b16 v[178:179], v4 offset:3616
  v_mfma_f32_16x16x32_bf16 v[240:243], v[156:159], v[196:199], v[240:243]
  s_mul_i32 s30, s31, 3584
  s_waitcnt lgkmcnt(6)
  v_mfma_f32_16x16x32_bf16 v[236:239], v[160:163], v[192:195], v[236:239]
  ds_read_b64_tr_b16 v[180:181], v4 offset:3712
  ds_read_b64_tr_b16 v[182:183], v4 offset:3744
  v_mfma_f32_16x16x32_bf16 v[240:243], v[164:167], v[192:195], v[240:243]
  ds_read_b64_tr_b16 v[184:185], v4 offset:3840
  ds_read_b64_tr_b16 v[186:187], v4 offset:3872
  v_mfma_f32_16x16x32_bf16 v[244:247], v[64:67], a[244:247], 0
  s_add_u32 m0, s30, s29
  s_lshl4_add_u32 s30, s30, s28
  v_mfma_f32_16x16x32_bf16 v[248:251], v[68:71], a[244:247], 0
  buffer_load_dwordx4 v15, s[32:35], s30 offen offset:0 lds
  v_cndmask_b32 v56, v50, v46, s[14:15]
  v_mfma_f32_16x16x32_bf16 v[244:247], v[72:75], a[240:243], v[244:247]
  s_add_u32 s30, s30, 13440
  buffer_load_dwordx4 v15, s[32:35], s30 offen offset:896 lds
  v_mfma_f32_16x16x32_bf16 v[248:251], v[76:79], a[240:243], v[248:251]
  v_cndmask_b32 v57, v54, v50, s[14:15]
  v_add_f32_dpp v49, v56, v49 wave_ror:1 row_mask:0xf bank_mask:0xf
  v_mfma_f32_16x16x32_bf16 v[244:247], v[80:83], a[236:239], v[244:247]
  v_add_f32_dpp v53, v57, v53 wave_ror:1 row_mask:0xf bank_mask:0xf
  v_cndmask_b32 v56, v49, v45, s[14:15]
  v_mfma_f32_16x16x32_bf16 v[248:251], v[84:87], a[236:239], v[248:251]
  v_cndmask_b32 v57, v53, v49, s[14:15]
  v_add_f32_dpp v48, v56, v48 wave_ror:1 row_mask:0xf bank_mask:0xf
  v_mfma_f32_16x16x32_bf16 v[244:247], v[88:91], a[232:235], v[244:247]
  v_add_f32_dpp v52, v57, v52 wave_ror:1 row_mask:0xf bank_mask:0xf
  v_fma_f32 v58, v12, s59, v48
  v_mfma_f32_16x16x32_bf16 v[248:251], v[92:95], a[232:235], v[248:251]
  v_fma_f32 v59, v13, s59, v52
  v_cvt_pk_bf16_f32 v58, v58, v59
  v_mfma_f32_16x16x32_bf16 v[244:247], v[96:99], a[228:231], v[244:247]
  ds_write_b16 v6, v58 offset:2048
  ds_write_b16_d16_hi v6, v58 offset:2560
  v_mfma_f32_16x16x32_bf16 v[248:251], v[100:103], a[228:231], v[248:251]
  ds_read_u16_d16_hi v12, v7 offset:768
  ds_read_u16_d16_hi v13, v7 offset:896
  v_mfma_f32_16x16x32_bf16 v[244:247], v[104:107], a[224:227], v[244:247]
  s_add_u32 s30, s30, 13440
  buffer_load_dwordx4 v15, s[32:35], s30 offen offset:1792 lds
  v_mfma_f32_16x16x32_bf16 v[248:251], v[108:111], a[224:227], v[248:251]
  v_cndmask_b32 v56, v227, v55, s[14:15]
  v_cndmask_b32 v57, v231, v227, s[14:15]
  v_mfma_f32_16x16x32_bf16 v[244:247], v[112:115], v[220:223], v[244:247]
  v_add_f32_dpp v226, v56, v226 wave_ror:1 row_mask:0xf bank_mask:0xf
  v_add_f32_dpp v230, v57, v230 wave_ror:1 row_mask:0xf bank_mask:0xf
  v_mfma_f32_16x16x32_bf16 v[248:251], v[116:119], v[220:223], v[248:251]
  v_cndmask_b32 v56, v226, v54, s[14:15]
  v_cndmask_b32 v57, v230, v226, s[14:15]
  v_mfma_f32_16x16x32_bf16 v[244:247], v[120:123], v[216:219], v[244:247]
  v_add_f32_dpp v225, v56, v225 wave_ror:1 row_mask:0xf bank_mask:0xf
  v_add_f32_dpp v229, v57, v229 wave_ror:1 row_mask:0xf bank_mask:0xf
  v_mfma_f32_16x16x32_bf16 v[248:251], v[124:127], v[216:219], v[248:251]
  v_cndmask_b32 v56, v225, v53, s[14:15]
  v_cndmask_b32 v57, v229, v225, s[14:15]
  v_mfma_f32_16x16x32_bf16 v[244:247], v[128:131], v[212:215], v[244:247]
  v_add_f32_dpp v224, v56, v224 wave_ror:1 row_mask:0xf bank_mask:0xf
  v_add_f32_dpp v228, v57, v228 wave_ror:1 row_mask:0xf bank_mask:0xf
  v_mfma_f32_16x16x32_bf16 v[248:251], v[132:135], v[212:215], v[248:251]
  s_waitcnt lgkmcnt(1)
  v_fma_f32 v58, v12, s59, v224
  v_mfma_f32_16x16x32_bf16 v[244:247], v[136:139], v[208:211], v[244:247]
  s_add_u32 s30, s30, 13440
  ds_read_b64_tr_b16 v[188:189], v4 offset:3968
  v_mfma_f32_16x16x32_bf16 v[248:251], v[140:143], v[208:211], v[248:251]
  s_mov_b32 exec_hi, 0x00ffffff
  buffer_load_dwordx4 v15, s[32:35], s30 offen offset:2688 lds
  s_mov_b32 exec_hi, -1
  v_mfma_f32_16x16x32_bf16 v[244:247], v[144:147], v[204:207], v[244:247]
  s_waitcnt lgkmcnt(1)
  v_fma_f32 v59, v13, s59, v228
  v_mfma_f32_16x16x32_bf16 v[248:251], v[148:151], v[204:207], v[248:251]
  v_cvt_pk_bf16_f32 v58, v58, v59
  ds_write_b16 v6, v58 offset:3072
  v_mfma_f32_16x16x32_bf16 v[244:247], v[152:155], v[200:203], v[244:247]
  ds_write_b16_d16_hi v6, v58 offset:3584
  v_add_f32_dpp v234, v235, v234 wave_shr:1 row_mask:0xf bank_mask:0xf bound_ctrl:0
  v_mfma_f32_16x16x32_bf16 v[248:251], v[156:159], v[200:203], v[248:251]
  s_nop 0
  v_add_f32_dpp v233, v234, v233 wave_shr:1 row_mask:0xf bank_mask:0xf bound_ctrl:0
  v_mfma_f32_16x16x32_bf16 v[244:247], v[160:163], v[196:199], v[244:247]
  ds_read_u16_d16_hi v12, v7 offset:3072
  ds_read_u16_d16_hi v13, v7 offset:3200
  v_mfma_f32_16x16x32_bf16 v[248:251], v[164:167], v[196:199], v[248:251]
  v_cndmask_b32 v56, v239, v235, s[14:15]
  v_cndmask_b32 v57, v243, v239, s[14:15]
  v_mfma_f32_16x16x32_bf16 v[244:247], v[168:171], v[192:195], v[244:247]
  ds_read_b64_tr_b16 v[190:191], v4 offset:4000
  buffer_load_dword v30, v11, s[52:55], 0 offen sc1
  v_mfma_f32_16x16x32_bf16 v[248:251], v[172:175], v[192:195], v[248:251]
  v_add_f32_dpp v238, v56, v238 wave_ror:1 row_mask:0xf bank_mask:0xf
  v_add_f32_dpp v242, v57, v242 wave_ror:1 row_mask:0xf bank_mask:0xf
  v_mfma_f32_16x16x32_bf16 v[252:255], v[64:67], a[248:251], 0
  v_cndmask_b32 v56, v238, v234, s[14:15]
  v_cndmask_b32 v57, v242, v238, s[14:15]
  v_mfma_f32_16x16x32_bf16 v[32:35], v[68:71], a[248:251], 0
  v_add_f32_dpp v237, v56, v237 wave_ror:1 row_mask:0xf bank_mask:0xf
  v_add_f32_dpp v241, v57, v241 wave_ror:1 row_mask:0xf bank_mask:0xf
  v_mfma_f32_16x16x32_bf16 v[252:255], v[72:75], a[244:247], v[252:255]
  v_cndmask_b32 v56, v237, v233, s[14:15]
  v_cndmask_b32 v57, v241, v237, s[14:15]
  v_mfma_f32_16x16x32_bf16 v[32:35], v[76:79], a[244:247], v[32:35]
  v_add_f32_dpp v236, v56, v236 wave_ror:1 row_mask:0xf bank_mask:0xf
  v_add_f32_dpp v240, v57, v240 wave_ror:1 row_mask:0xf bank_mask:0xf
  v_mfma_f32_16x16x32_bf16 v[252:255], v[80:83], a[240:243], v[252:255]
  s_waitcnt lgkmcnt(2)
  v_fma_f32 v58, v12, s59, v236
  v_mfma_f32_16x16x32_bf16 v[32:35], v[84:87], a[240:243], v[32:35]
  s_waitcnt lgkmcnt(1)
  v_fma_f32 v59, v13, s59, v240
  v_mfma_f32_16x16x32_bf16 v[252:255], v[88:91], a[236:239], v[252:255]
  s_add_u32 s31, s31, 1
  s_and_b32 s31, s31, 7
  v_mfma_f32_16x16x32_bf16 v[32:35], v[92:95], a[236:239], v[32:35]
  s_mul_i32 s30, s31, 3584
  s_add_u32 m0, s30, s29
  v_mfma_f32_16x16x32_bf16 v[252:255], v[96:99], a[232:235], v[252:255]
  s_lshl4_add_u32 s30, s30, s28
  buffer_load_dwordx4 v15, s[32:35], s30 offen offset:0 lds
  v_mfma_f32_16x16x32_bf16 v[32:35], v[100:103], a[232:235], v[32:35]
  v_cvt_pk_bf16_f32 v58, v58, v59
  ds_write_b16 v6, v58 offset:4096
  v_mfma_f32_16x16x32_bf16 v[252:255], v[104:107], a[228:231], v[252:255]
  ds_write_b16_d16_hi v6, v58 offset:4608
  ds_read_u16_d16_hi v12, v7 offset:3328
  v_mfma_f32_16x16x32_bf16 v[32:35], v[108:111], a[228:231], v[32:35]
  ds_read_u16_d16_hi v13, v7 offset:3456
  v_cndmask_b32 v56, v247, v243, s[14:15]
  v_mfma_f32_16x16x32_bf16 v[252:255], v[112:115], a[224:227], v[252:255]
  v_cndmask_b32 v57, v251, v247, s[14:15]
  v_add_f32_dpp v246, v56, v246 wave_ror:1 row_mask:0xf bank_mask:0xf
  v_mfma_f32_16x16x32_bf16 v[32:35], v[116:119], a[224:227], v[32:35]
  v_add_f32_dpp v250, v57, v250 wave_ror:1 row_mask:0xf bank_mask:0xf
  v_cndmask_b32 v56, v246, v242, s[14:15]
  v_mfma_f32_16x16x32_bf16 v[252:255], v[120:123], v[220:223], v[252:255]
  s_add_u32 s30, s30, 13440
  buffer_load_dwordx4 v15, s[32:35], s30 offen offset:896 lds
  v_mfma_f32_16x16x32_bf16 v[32:35], v[124:127], v[220:223], v[32:35]
  v_cndmask_b32 v57, v250, v246, s[14:15]
  v_add_f32_dpp v245, v56, v245 wave_ror:1 row_mask:0xf bank_mask:0xf
  v_mfma_f32_16x16x32_bf16 v[252:255], v[128:131], v[216:219], v[252:255]
  v_add_f32_dpp v249, v57, v249 wave_ror:1 row_mask:0xf bank_mask:0xf
  v_cndmask_b32 v56, v245, v241, s[14:15]
  v_mfma_f32_16x16x32_bf16 v[32:35], v[132:135], v[216:219], v[32:35]
  v_cndmask_b32 v57, v249, v245, s[14:15]
  v_add_f32_dpp v244, v56, v244 wave_ror:1 row_mask:0xf bank_mask:0xf
  v_mfma_f32_16x16x32_bf16 v[252:255], v[136:139], v[212:215], v[252:255]
  v_add_f32_dpp v248, v57, v248 wave_ror:1 row_mask:0xf bank_mask:0xf
  v_mfma_f32_16x16x32_bf16 v[32:35], v[140:143], v[212:215], v[32:35]
  s_waitcnt lgkmcnt(1)
  v_fma_f32 v58, v12, s59, v244
  v_mfma_f32_16x16x32_bf16 v[252:255], v[144:147], v[208:211], v[252:255]
  s_waitcnt lgkmcnt(0)
  v_fma_f32 v59, v13, s59, v248
  v_mfma_f32_16x16x32_bf16 v[32:35], v[148:151], v[208:211], v[32:35]
  v_cvt_pk_bf16_f32 v58, v58, v59
  ds_write_b16 v6, v58 offset:5120
  v_mfma_f32_16x16x32_bf16 v[252:255], v[152:155], v[204:207], v[252:255]
  s_add_u32 s30, s30, 13440
  buffer_load_dwordx4 v15, s[32:35], s30 offen offset:1792 lds
  v_mfma_f32_16x16x32_bf16 v[32:35], v[156:159], v[204:207], v[32:35]
  ds_write_b16_d16_hi v6, v58 offset:5632
  v_mfma_f32_16x16x32_bf16 v[252:255], v[160:163], v[200:203], v[252:255]
  v_mfma_f32_16x16x32_bf16 v[32:35], v[164:167], v[200:203], v[32:35]
  v_mfma_f32_16x16x32_bf16 v[252:255], v[168:171], v[196:199], v[252:255]
  v_mfma_f32_16x16x32_bf16 v[32:35], v[172:175], v[196:199], v[32:35]
  v_mfma_f32_16x16x32_bf16 v[252:255], v[176:179], v[192:195], v[252:255]
  v_mfma_f32_16x16x32_bf16 v[32:35], v[180:183], v[192:195], v[32:35]
  v_mfma_f32_16x16x32_bf16 v[36:39], v[64:67], a[252:255], 0
  s_add_u32 s30, s30, 13440
  ds_read_u16_d16_hi v12, v7 offset:3584
  v_mfma_f32_16x16x32_bf16 v[40:43], v[68:71], a[252:255], 0
  s_mov_b32 exec_hi, 0x00ffffff
  buffer_load_dwordx4 v15, s[32:35], s30 offen offset:2688 lds
  s_mov_b32 exec_hi, -1
  v_mfma_f32_16x16x32_bf16 v[36:39], v[72:75], a[248:251], v[36:39]
  ds_read_u16_d16_hi v13, v7 offset:3712
  v_mfma_f32_16x16x32_bf16 v[40:43], v[76:79], a[248:251], v[40:43]
  v_cndmask_b32 v56, v255, v251, s[14:15]
  v_cndmask_b32 v57, v35, v255, s[14:15]
  v_mfma_f32_16x16x32_bf16 v[36:39], v[80:83], a[244:247], v[36:39]
  v_add_f32_dpp v254, v56, v254 wave_ror:1 row_mask:0xf bank_mask:0xf
  v_add_f32_dpp v34, v57, v34 wave_ror:1 row_mask:0xf bank_mask:0xf
  v_mfma_f32_16x16x32_bf16 v[40:43], v[84:87], a[244:247], v[40:43]
  v_cndmask_b32 v56, v254, v250, s[14:15]
  v_cndmask_b32 v57, v34, v254, s[14:15]
  v_mfma_f32_16x16x32_bf16 v[36:39], v[88:91], a[240:243], v[36:39]
  v_add_f32_dpp v253, v56, v253 wave_ror:1 row_mask:0xf bank_mask:0xf
  v_add_f32_dpp v33, v57, v33 wave_ror:1 row_mask:0xf bank_mask:0xf
  v_mfma_f32_16x16x32_bf16 v[40:43], v[92:95], a[240:243], v[40:43]
  v_cndmask_b32 v56, v253, v249, s[14:15]
  v_cndmask_b32 v57, v33, v253, s[14:15]
  v_mfma_f32_16x16x32_bf16 v[36:39], v[96:99], a[236:239], v[36:39]
  v_add_f32_dpp v252, v56, v252 wave_ror:1 row_mask:0xf bank_mask:0xf
  v_add_f32_dpp v32, v57, v32 wave_ror:1 row_mask:0xf bank_mask:0xf
  v_mfma_f32_16x16x32_bf16 v[40:43], v[100:103], a[236:239], v[40:43]
  s_waitcnt lgkmcnt(1)
  v_fma_f32 v58, v12, s59, v252
  v_mfma_f32_16x16x32_bf16 v[36:39], v[104:107], a[232:235], v[36:39]
  s_waitcnt lgkmcnt(0)
  v_fma_f32 v59, v13, s59, v32
  v_mfma_f32_16x16x32_bf16 v[40:43], v[108:111], a[232:235], v[40:43]
  v_cvt_pk_bf16_f32 v58, v58, v59
  ds_write_b16 v6, v58 offset:6144
  v_mfma_f32_16x16x32_bf16 v[36:39], v[112:115], a[228:231], v[36:39]
  ds_write_b16_d16_hi v6, v58 offset:6656
  v_mfma_f32_16x16x32_bf16 v[40:43], v[116:119], a[228:231], v[40:43]
  v_mfma_f32_16x16x32_bf16 v[36:39], v[120:123], a[224:227], v[36:39]
  v_mfma_f32_16x16x32_bf16 v[40:43], v[124:127], a[224:227], v[40:43]
  v_mfma_f32_16x16x32_bf16 v[36:39], v[128:131], v[220:223], v[36:39]
  v_mfma_f32_16x16x32_bf16 v[40:43], v[132:135], v[220:223], v[40:43]
  v_mfma_f32_16x16x32_bf16 v[36:39], v[136:139], v[216:219], v[36:39]
  v_mfma_f32_16x16x32_bf16 v[40:43], v[140:143], v[216:219], v[40:43]
  v_mfma_f32_16x16x32_bf16 v[36:39], v[144:147], v[212:215], v[36:39]
  v_mfma_f32_16x16x32_bf16 v[40:43], v[148:151], v[212:215], v[40:43]
  v_mfma_f32_16x16x32_bf16 v[36:39], v[152:155], v[208:211], v[36:39]
  v_mfma_f32_16x16x32_bf16 v[40:43], v[156:159], v[208:211], v[40:43]
  v_mfma_f32_16x16x32_bf16 v[36:39], v[160:163], v[204:207], v[36:39]
  v_mfma_f32_16x16x32_bf16 v[40:43], v[164:167], v[204:207], v[40:43]
  v_mfma_f32_16x16x32_bf16 v[36:39], v[168:171], v[200:203], v[36:39]
  v_mfma_f32_16x16x32_bf16 v[40:43], v[172:175], v[200:203], v[40:43]
  v_mfma_f32_16x16x32_bf16 v[36:39], v[176:179], v[196:199], v[36:39]
  v_mfma_f32_16x16x32_bf16 v[40:43], v[180:183], v[196:199], v[40:43]
  v_mfma_f32_16x16x32_bf16 v[36:39], v[184:187], v[192:195], v[36:39]
  v_mfma_f32_16x16x32_bf16 v[40:43], v[188:191], v[192:195], v[40:43]
  ds_read_u16_d16_hi v12, v7 offset:3840
  ds_read_u16_d16_hi v13, v7 offset:3968
  s_nop 4
  v_cndmask_b32 v56, v39, v35, s[14:15]
  v_cndmask_b32 v57, v43, v39, s[14:15]
  s_nop 0
  v_add_f32_dpp v38, v56, v38 wave_ror:1 row_mask:0xf bank_mask:0xf
  v_add_f32_dpp v42, v57, v42 wave_ror:1 row_mask:0xf bank_mask:0xf
  v_cndmask_b32 v56, v38, v34, s[14:15]
  v_cndmask_b32 v57, v42, v38, s[14:15]
  s_nop 0
  v_add_f32_dpp v37, v56, v37 wave_ror:1 row_mask:0xf bank_mask:0xf
  v_add_f32_dpp v41, v57, v41 wave_ror:1 row_mask:0xf bank_mask:0xf
  v_cndmask_b32 v56, v37, v33, s[14:15]
  v_cndmask_b32 v57, v41, v37, s[14:15]
  s_nop 0
  v_add_f32_dpp v36, v56, v36 wave_ror:1 row_mask:0xf bank_mask:0xf
  v_add_f32_dpp v40, v57, v40 wave_ror:1 row_mask:0xf bank_mask:0xf
  s_waitcnt lgkmcnt(1)
  v_fma_f32 v58, v12, s59, v36
  s_waitcnt lgkmcnt(0)
  v_fma_f32 v59, v13, s59, v40
  v_cvt_pk_bf16_f32 v58, v58, v59
  ds_write_b16 v6, v58 offset:7168
  ds_write_b16_d16_hi v6, v58 offset:7680
  s_branch f_cv_join
f_cv_h1:
  s_waitcnt vmcnt(4)
  ds_read_b64_tr_b16 v[68:69], v4 offset:128
  ds_read_b64_tr_b16 v[70:71], v4 offset:160
  ds_read_b64_tr_b16 v[76:77], v4 offset:384
  ds_read_b64_tr_b16 v[78:79], v4 offset:416
  ds_read_b64_tr_b16 v[84:85], v4 offset:640
  ds_read_b64_tr_b16 v[86:87], v4 offset:672
  ds_read_b64_tr_b16 v[92:93], v4 offset:896
  ds_read_b64_tr_b16 v[94:95], v4 offset:928
  ds_read_b64_tr_b16 v[64:65], v4 offset:0
  ds_read_b64_tr_b16 v[66:67], v4 offset:32
  s_waitcnt lgkmcnt(8)
  v_mfma_f32_16x16x32_bf16 v[32:35], v[68:71], v[204:207], 0
  ds_read_b64_tr_b16 v[72:73], v4 offset:256
  s_waitcnt lgkmcnt(7)
  v_mfma_f32_16x16x32_bf16 v[32:35], v[76:79], v[200:203], v[32:35]
  ds_read_b64_tr_b16 v[74:75], v4 offset:288
  s_waitcnt lgkmcnt(6)
  v_mfma_f32_16x16x32_bf16 v[32:35], v[84:87], v[196:199], v[32:35]
  ds_read_b64_tr_b16 v[80:81], v4 offset:512
  s_waitcnt lgkmcnt(5)
  v_mfma_f32_16x16x32_bf16 v[32:35], v[92:95], v[192:195], v[32:35]
  ds_read_b64_tr_b16 v[82:83], v4 offset:544
  s_waitcnt lgkmcnt(4)
  v_mfma_f32_16x16x32_bf16 v[36:39], v[64:67], v[208:211], 0
  ds_read_b64_tr_b16 v[88:89], v4 offset:768
  ds_read_b64_tr_b16 v[90:91], v4 offset:800
  v_mfma_f32_16x16x32_bf16 v[40:43], v[68:71], v[208:211], 0
  s_waitcnt vmcnt(3)
  ds_read_b64_tr_b16 v[96:97], v4 offset:1024
  s_waitcnt lgkmcnt(5)
  v_mfma_f32_16x16x32_bf16 v[36:39], v[72:75], v[204:207], v[36:39]
  ds_read_b64_tr_b16 v[98:99], v4 offset:1056
  ds_read_b64_tr_b16 v[100:101], v4 offset:1152
  v_mfma_f32_16x16x32_bf16 v[40:43], v[76:79], v[204:207], v[40:43]
  ds_read_b64_tr_b16 v[102:103], v4 offset:1184
  s_waitcnt lgkmcnt(6)
  v_mfma_f32_16x16x32_bf16 v[36:39], v[80:83], v[200:203], v[36:39]
  ds_read_b64_tr_b16 v[104:105], v4 offset:1280
  ds_read_b64_tr_b16 v[106:107], v4 offset:1312
  v_mfma_f32_16x16x32_bf16 v[40:43], v[84:87], v[200:203], v[40:43]
  ds_read_b64_tr_b16 v[108:109], v4 offset:1408
  s_waitcnt lgkmcnt(7)
  v_mfma_f32_16x16x32_bf16 v[36:39], v[88:91], v[196:199], v[36:39]
  ds_read_b64_tr_b16 v[110:111], v4 offset:1440
  ds_read_b64_tr_b16 v[112:113], v4 offset:1536
  v_mfma_f32_16x16x32_bf16 v[40:43], v[92:95], v[196:199], v[40:43]
  ds_read_b64_tr_b16 v[114:115], v4 offset:1568
  s_waitcnt lgkmcnt(8)
  v_mfma_f32_16x16x32_bf16 v[36:39], v[96:99], v[192:195], v[36:39]
  ds_read_b64_tr_b16 v[116:117], v4 offset:1664
  s_waitcnt lgkmcnt(7)
  v_mfma_f32_16x16x32_bf16 v[40:43], v[100:103], v[192:195], v[40:43]
  ds_read_b64_tr_b16 v[118:119], v4 offset:1696
  ds_read_b64_tr_b16 v[120:121], v4 offset:1792
  v_mfma_f32_16x16x32_bf16 v[44:47], v[64:67], v[212:215], 0
  ds_read_b64_tr_b16 v[122:123], v4 offset:1824
  buffer_load_dwordx2 v[18:19], v24, s[16:19], 0 offen offset:1024 nt
  v_mfma_f32_16x16x32_bf16 v[48:51], v[68:71], v[212:215], 0
  buffer_load_dwordx2 v[20:21], v24, s[16:19], 0 offen offset:128 nt
  v_add_f32_dpp v34, v35, v34 wave_shr:1 row_mask:0xf bank_mask:0xf bound_ctrl:0
  v_mfma_f32_16x16x32_bf16 v[44:47], v[72:75], v[208:211], v[44:47]
  s_nop 0
  v_add_f32_dpp v33, v34, v33 wave_shr:1 row_mask:0xf bank_mask:0xf bound_ctrl:0
  v_mfma_f32_16x16x32_bf16 v[48:51], v[76:79], v[208:211], v[48:51]
  ds_read_u16_d16_hi v12, v7 offset:1024
  ds_read_u16_d16_hi v13, v7 offset:1152
  v_mfma_f32_16x16x32_bf16 v[44:47], v[80:83], v[204:207], v[44:47]
  v_cndmask_b32 v56, v39, v35, s[14:15]
  v_cndmask_b32 v57, v43, v39, s[14:15]
  v_mfma_f32_16x16x32_bf16 v[48:51], v[84:87], v[204:207], v[48:51]
  v_add_f32_dpp v38, v56, v38 wave_ror:1 row_mask:0xf bank_mask:0xf
  v_add_f32_dpp v42, v57, v42 wave_ror:1 row_mask:0xf bank_mask:0xf
  v_mfma_f32_16x16x32_bf16 v[44:47], v[88:91], v[200:203], v[44:47]
  buffer_load_dwordx2 v[22:23], v24, s[16:19], 0 offen offset:1152 nt
  v_cndmask_b32 v56, v38, v34, s[14:15]
  v_mfma_f32_16x16x32_bf16 v[48:51], v[92:95], v[200:203], v[48:51]
  v_cndmask_b32 v57, v42, v38, s[14:15]
  v_add_f32_dpp v37, v56, v37 wave_ror:1 row_mask:0xf bank_mask:0xf
  v_mfma_f32_16x16x32_bf16 v[44:47], v[96:99], v[196:199], v[44:47]
  v_add_f32_dpp v41, v57, v41 wave_ror:1 row_mask:0xf bank_mask:0xf
  v_cndmask_b32 v56, v37, v33, s[14:15]
  v_mfma_f32_16x16x32_bf16 v[48:51], v[100:103], v[196:199], v[48:51]
  v_cndmask_b32 v57, v41, v37, s[14:15]
  s_waitcnt lgkmcnt(2)
  v_mfma_f32_16x16x32_bf16 v[44:47], v[104:107], v[192:195], v[44:47]
  ds_read_b64_tr_b16 v[124:125], v4 offset:1920
  ds_read_b64_tr_b16 v[126:127], v4 offset:1952
  v_mfma_f32_16x16x32_bf16 v[48:51], v[108:111], v[192:195], v[48:51]
  s_waitcnt vmcnt(5)
  ds_read_b64_tr_b16 v[128:129], v4 offset:2048
  v_mfma_f32_16x16x32_bf16 v[52:55], v[64:67], v[216:219], 0
  ds_read_b64_tr_b16 v[130:131], v4 offset:2080
  v_add_f32_dpp v36, v56, v36 wave_ror:1 row_mask:0xf bank_mask:0xf
  v_mfma_f32_16x16x32_bf16 v[224:227], v[68:71], v[216:219], 0
  v_add_f32_dpp v40, v57, v40 wave_ror:1 row_mask:0xf bank_mask:0xf
  ds_read_b64_tr_b16 v[132:133], v4 offset:2176
  v_mfma_f32_16x16x32_bf16 v[52:55], v[72:75], v[212:215], v[52:55]
  buffer_load_dword v25, v25, s[20:23], 0 offen
  ds_read_b64_tr_b16 v[134:135], v4 offset:2208
  v_mfma_f32_16x16x32_bf16 v[224:227], v[76:79], v[212:215], v[224:227]
  s_waitcnt lgkmcnt(7)
  v_fma_f32 v58, v12, s59, v36
  v_mfma_f32_16x16x32_bf16 v[52:55], v[80:83], v[208:211], v[52:55]
  s_waitcnt lgkmcnt(6)
  v_fma_f32 v59, v13, s59, v40
  v_mfma_f32_16x16x32_bf16 v[224:227], v[84:87], v[208:211], v[224:227]
  v_cvt_pk_bf16_f32 v58, v58, v59
  ds_write_b16 v6, v58 offset:0
  v_mfma_f32_16x16x32_bf16 v[52:55], v[88:91], v[204:207], v[52:55]
  ds_write_b16_d16_hi v6, v58 offset:512
  ds_read_u16_d16_hi v12, v7 offset:1280
  v_mfma_f32_16x16x32_bf16 v[224:227], v[92:95], v[204:207], v[224:227]
  ds_read_u16_d16_hi v13, v7 offset:1408
  v_cndmask_b32 v56, v47, v43, s[14:15]
  v_mfma_f32_16x16x32_bf16 v[52:55], v[96:99], v[200:203], v[52:55]
  v_cndmask_b32 v57, v51, v47, s[14:15]
  v_add_f32_dpp v46, v56, v46 wave_ror:1 row_mask:0xf bank_mask:0xf
  v_mfma_f32_16x16x32_bf16 v[224:227], v[100:103], v[200:203], v[224:227]
  v_add_f32_dpp v50, v57, v50 wave_ror:1 row_mask:0xf bank_mask:0xf
  v_cndmask_b32 v56, v46, v42, s[14:15]
  v_mfma_f32_16x16x32_bf16 v[52:55], v[104:107], v[196:199], v[52:55]
  buffer_load_dword v28, v26, s[36:39], 0 offen
  v_cndmask_b32 v57, v50, v46, s[14:15]
  v_mfma_f32_16x16x32_bf16 v[224:227], v[108:111], v[196:199], v[224:227]
  v_add_f32_dpp v45, v56, v45 wave_ror:1 row_mask:0xf bank_mask:0xf
  v_add_f32_dpp v49, v57, v49 wave_ror:1 row_mask:0xf bank_mask:0xf
  v_mfma_f32_16x16x32_bf16 v[52:55], v[112:115], v[192:195], v[52:55]
  v_cndmask_b32 v56, v45, v41, s[14:15]
  v_cndmask_b32 v57, v49, v45, s[14:15]
  v_mfma_f32_16x16x32_bf16 v[224:227], v[116:119], v[192:195], v[224:227]
  ds_read_b64_tr_b16 v[136:137], v4 offset:2304
  ds_read_b64_tr_b16 v[138:139], v4 offset:2336
  v_mfma_f32_16x16x32_bf16 v[228:231], v[64:67], v[220:223], 0
  v_add_f32_dpp v44, v56, v44 wave_ror:1 row_mask:0xf bank_mask:0xf
  v_add_f32_dpp v48, v57, v48 wave_ror:1 row_mask:0xf bank_mask:0xf
  v_mfma_f32_16x16x32_bf16 v[232:235], v[68:71], v[220:223], 0
  s_waitcnt lgkmcnt(3)
  v_fma_f32 v58, v12, s59, v44
  v_mfma_f32_16x16x32_bf16 v[228:231], v[72:75], v[216:219], v[228:231]
  s_waitcnt lgkmcnt(2)
  v_fma_f32 v59, v13, s59, v48
  v_mfma_f32_16x16x32_bf16 v[232:235], v[76:79], v[216:219], v[232:235]
  v_cvt_pk_bf16_f32 v58, v58, v59
  ds_write_b16 v6, v58 offset:1024
  v_mfma_f32_16x16x32_bf16 v[228:231], v[80:83], v[212:215], v[228:231]
  buffer_load_dword v29, v29, s[36:39], 0 offen
  ds_write_b16_d16_hi v6, v58 offset:1536
  v_mfma_f32_16x16x32_bf16 v[232:235], v[84:87], v[212:215], v[232:235]
  ds_read_u16_d16_hi v12, v7 offset:1536
  ds_read_u16_d16_hi v13, v7 offset:1664
  v_mfma_f32_16x16x32_bf16 v[228:231], v[88:91], v[208:211], v[228:231]
  v_cndmask_b32 v56, v55, v51, s[14:15]
  v_cndmask_b32 v57, v227, v55, s[14:15]
  v_mfma_f32_16x16x32_bf16 v[232:235], v[92:95], v[208:211], v[232:235]
  v_add_f32_dpp v54, v56, v54 wave_ror:1 row_mask:0xf bank_mask:0xf
  v_add_f32_dpp v226, v57, v226 wave_ror:1 row_mask:0xf bank_mask:0xf
  v_mfma_f32_16x16x32_bf16 v[228:231], v[96:99], v[204:207], v[228:231]
  v_cndmask_b32 v56, v54, v50, s[14:15]
  v_cndmask_b32 v57, v226, v54, s[14:15]
  v_mfma_f32_16x16x32_bf16 v[232:235], v[100:103], v[204:207], v[232:235]
  v_add_f32_dpp v53, v56, v53 wave_ror:1 row_mask:0xf bank_mask:0xf
  v_add_f32_dpp v225, v57, v225 wave_ror:1 row_mask:0xf bank_mask:0xf
  v_mfma_f32_16x16x32_bf16 v[228:231], v[104:107], v[200:203], v[228:231]
  v_cndmask_b32 v56, v53, v49, s[14:15]
  v_cndmask_b32 v57, v225, v53, s[14:15]
  v_mfma_f32_16x16x32_bf16 v[232:235], v[108:111], v[200:203], v[232:235]
  v_add_f32_dpp v52, v56, v52 wave_ror:1 row_mask:0xf bank_mask:0xf
  v_add_f32_dpp v224, v57, v224 wave_ror:1 row_mask:0xf bank_mask:0xf
  v_mfma_f32_16x16x32_bf16 v[228:231], v[112:115], v[196:199], v[228:231]
  s_add_u32 s31, s31, 1
  s_and_b32 s31, s31, 7
  v_mfma_f32_16x16x32_bf16 v[232:235], v[116:119], v[196:199], v[232:235]
  s_mul_i32 s30, s31, 3584
  s_add_u32 m0, s30, s29
  v_mfma_f32_16x16x32_bf16 v[228:231], v[120:123], v[192:195], v[228:231]
  ds_read_b64_tr_b16 v[140:141], v4 offset:2432
  ds_read_b64_tr_b16 v[142:143], v4 offset:2464
  v_mfma_f32_16x16x32_bf16 v[232:235], v[124:127], v[192:195], v[232:235]
  ds_read_b64_tr_b16 v[144:145], v4 offset:2560
  ds_read_b64_tr_b16 v[146:147], v4 offset:2592
  v_mfma_f32_16x16x32_bf16 v[236:239], v[64:67], a[224:227], 0
  s_lshl4_add_u32 s30, s30, s28
  buffer_load_dwordx4 v15, s[32:35], s30 offen offset:0 lds
  v_mfma_f32_16x16x32_bf16 v[240:243], v[68:71], a[224:227], 0
  s_waitcnt lgkmcnt(5)
  v_fma_f32 v58, v12, s59, v52
  v_mfma_f32_16x16x32_bf16 v[236:239], v[72:75], v[220:223], v[236:239]
  s_waitcnt lgkmcnt(4)
  v_fma_f32 v59, v13, s59, v224
  v_mfma_f32_16x16x32_bf16 v[240:243], v[76:79], v[220:223], v[240:243]
  v_cvt_pk_bf16_f32 v58, v58, v59
  ds_write_b16 v6, v58 offset:2048
  v_mfma_f32_16x16x32_bf16 v[236:239], v[80:83], v[216:219], v[236:239]
  s_add_u32 s30, s30, 13440
  buffer_load_dwordx4 v15, s[32:35], s30 offen offset:896 lds
  v_mfma_f32_16x16x32_bf16 v[240:243], v[84:87], v[216:219], v[240:243]
  ds_write_b16_d16_hi v6, v58 offset:2560
  ds_read_u16_d16_hi v12, v7 offset:1792
  v_mfma_f32_16x16x32_bf16 v[236:239], v[88:91], v[212:215], v[236:239]
  ds_read_u16_d16_hi v13, v7 offset:1920
  v_cndmask_b32 v56, v231, v227, s[14:15]
  v_mfma_f32_16x16x32_bf16 v[240:243], v[92:95], v[212:215], v[240:243]
  v_cndmask_b32 v57, v235, v231, s[14:15]
  v_add_f32_dpp v230, v56, v230 wave_ror:1 row_mask:0xf bank_mask:0xf
  v_mfma_f32_16x16x32_bf16 v[236:239], v[96:99], v[208:211], v[236:239]
  v_add_f32_dpp v234, v57, v234 wave_ror:1 row_mask:0xf bank_mask:0xf
  v_cndmask_b32 v56, v230, v226, s[14:15]
  v_mfma_f32_16x16x32_bf16 v[240:243], v[100:103], v[208:211], v[240:243]
  v_cndmask_b32 v57, v234, v230, s[14:15]
  v_add_f32_dpp v229, v56, v229 wave_ror:1 row_mask:0xf bank_mask:0xf
  v_mfma_f32_16x16x32_bf16 v[236:239], v[104:107], v[204:207], v[236:239]
  v_add_f32_dpp v233, v57, v233 wave_ror:1 row_mask:0xf bank_mask:0xf
  v_cndmask_b32 v56, v229, v225, s[14:15]
  v_mfma_f32_16x16x32_bf16 v[240:243], v[108:111], v[204:207], v[240:243]
  v_cndmask_b32 v57, v233, v229, s[14:15]
  v_add_f32_dpp v228, v56, v228 wave_ror:1 row_mask:0xf bank_mask:0xf
  v_mfma_f32_16x16x32_bf16 v[236:239], v[112:115], v[200:203], v[236:239]
  s_add_u32 s30, s30, 13440
  buffer_load_dwordx4 v15, s[32:35], s30 offen offset:1792 lds
  v_mfma_f32_16x16x32_bf16 v[240:243], v[116:119], v[200:203], v[240:243]
  v_add_f32_dpp v232, v57, v232 wave_ror:1 row_mask:0xf bank_mask:0xf
  ds_read_b64_tr_b16 v[148:149], v4 offset:2688
  v_mfma_f32_16x16x32_bf16 v[236:239], v[120:123], v[196:199], v[236:239]
  s_waitcnt lgkmcnt(2)
  v_fma_f32 v58, v12, s59, v228
  v_mfma_f32_16x16x32_bf16 v[240:243], v[124:127], v[196:199], v[240:243]
  s_waitcnt lgkmcnt(1)
  v_fma_f32 v59, v13, s59, v232
  v_mfma_f32_16x16x32_bf16 v[236:239], v[128:131], v[192:195], v[236:239]
  ds_read_b64_tr_b16 v[150:151], v4 offset:2720
  v_cvt_pk_bf16_f32 v58, v58, v59
  v_mfma_f32_16x16x32_bf16 v[240:243], v[132:135], v[192:195], v[240:243]
  ds_read_b64_tr_b16 v[152:153], v4 offset:2816
  ds_read_b64_tr_b16 v[154:155], v4 offset:2848
  v_mfma_f32_16x16x32_bf16 v[244:247], v[64:67], a[228:231], 0
  ds_write_b16 v6, v58 offset:3072
  ds_write_b16_d16_hi v6, v58 offset:3584
  v_mfma_f32_16x16x32_bf16 v[248:251], v[68:71], a[228:231], 0
  ds_read_u16_d16_hi v12, v7 offset:2048
  ds_read_u16_d16_hi v13, v7 offset:2176
  v_mfma_f32_16x16x32_bf16 v[244:247], v[72:75], a[224:227], v[244:247]
  s_add_u32 s30, s30, 13440
  ds_read_b64_tr_b16 v[156:157], v4 offset:2944
  v_mfma_f32_16x16x32_bf16 v[248:251], v[76:79], a[224:227], v[248:251]
  s_mov_b32 exec_hi, 0x00ffffff
  buffer_load_dwordx4 v15, s[32:35], s30 offen offset:2688 lds
  s_mov_b32 exec_hi, -1
  v_mfma_f32_16x16x32_bf16 v[244:247], v[80:83], v[220:223], v[244:247]
  v_cndmask_b32 v56, v239, v235, s[14:15]
  v_cndmask_b32 v57, v243, v239, s[14:15]
  v_mfma_f32_16x16x32_bf16 v[248:251], v[84:87], v[220:223], v[248:251]
  v_add_f32_dpp v238, v56, v238 wave_ror:1 row_mask:0xf bank_mask:0xf
  v_add_f32_dpp v242, v57, v242 wave_ror:1 row_mask:0xf bank_mask:0xf
  v_mfma_f32_16x16x32_bf16 v[244:247], v[88:91], v[216:219], v[244:247]
  v_cndmask_b32 v56, v238, v234, s[14:15]
  v_cndmask_b32 v57, v242, v238, s[14:15]
  v_mfma_f32_16x16x32_bf16 v[248:251], v[92:95], v[216:219], v[248:251]
  v_add_f32_dpp v237, v56, v237 wave_ror:1 row_mask:0xf bank_mask:0xf
  v_add_f32_dpp v241, v57, v241 wave_ror:1 row_mask:0xf bank_mask:0xf
  v_mfma_f32_16x16x32_bf16 v[244:247], v[96:99], v[212:215], v[244:247]
  v_cndmask_b32 v56, v237, v233, s[14:15]
  v_cndmask_b32 v57, v241, v237, s[14:15]
  v_mfma_f32_16x16x32_bf16 v[248:251], v[100:103], v[212:215], v[248:251]
  v_add_f32_dpp v236, v56, v236 wave_ror:1 row_mask:0xf bank_mask:0xf
  v_add_f32_dpp v240, v57, v240 wave_ror:1 row_mask:0xf bank_mask:0xf
  v_mfma_f32_16x16x32_bf16 v[244:247], v[104:107], v[208:211], v[244:247]
  buffer_load_dword v30, v11, s[52:55], 0 offen sc1
  ds_read_b64_tr_b16 v[158:159], v4 offset:2976
  v_mfma_f32_16x16x32_bf16 v[248:251], v[108:111], v[208:211], v[248:251]
  s_waitcnt lgkmcnt(3)
  v_fma_f32 v58, v12, s59, v236
  v_mfma_f32_16x16x32_bf16 v[244:247], v[112:115], v[204:207], v[244:247]
  s_waitcnt lgkmcnt(2)
  v_fma_f32 v59, v13, s59, v240
  v_mfma_f32_16x16x32_bf16 v[248:251], v[116:119], v[204:207], v[248:251]
  v_cvt_pk_bf16_f32 v58, v58, v59
  ds_write_b16 v6, v58 offset:4096
  v_mfma_f32_16x16x32_bf16 v[244:247], v[120:123], v[200:203], v[244:247]
  ds_write_b16_d16_hi v6, v58 offset:4608
  v_mfma_f32_16x16x32_bf16 v[248:251], v[124:127], v[200:203], v[248:251]
  v_mfma_f32_16x16x32_bf16 v[244:247], v[128:131], v[196:199], v[244:247]
  v_mfma_f32_16x16x32_bf16 v[248:251], v[132:135], v[196:199], v[248:251]
  v_mfma_f32_16x16x32_bf16 v[244:247], v[136:139], v[192:195], v[244:247]
  s_add_u32 s31, s31, 1
  s_and_b32 s31, s31, 7
  v_mfma_f32_16x16x32_bf16 v[248:251], v[140:143], v[192:195], v[248:251]
  s_mul_i32 s30, s31, 3584
  s_add_u32 m0, s30, s29
  v_mfma_f32_16x16x32_bf16 v[252:255], v[64:67], a[232:235], 0
  s_lshl4_add_u32 s30, s30, s28
  buffer_load_dwordx4 v15, s[32:35], s30 offen offset:0 lds
  v_mfma_f32_16x16x32_bf16 v[32:35], v[68:71], a[232:235], 0
  ds_read_u16_d16_hi v12, v7 offset:2304
  ds_read_u16_d16_hi v13, v7 offset:2432
  v_mfma_f32_16x16x32_bf16 v[252:255], v[72:75], a[228:231], v[252:255]
  v_mfma_f32_16x16x32_bf16 v[32:35], v[76:79], a[228:231], v[32:35]
  v_cndmask_b32 v56, v247, v243, s[14:15]
  v_cndmask_b32 v57, v251, v247, s[14:15]
  v_mfma_f32_16x16x32_bf16 v[252:255], v[80:83], a[224:227], v[252:255]
  v_add_f32_dpp v246, v56, v246 wave_ror:1 row_mask:0xf bank_mask:0xf
  v_add_f32_dpp v250, v57, v250 wave_ror:1 row_mask:0xf bank_mask:0xf
  v_mfma_f32_16x16x32_bf16 v[32:35], v[84:87], a[224:227], v[32:35]
  v_cndmask_b32 v56, v246, v242, s[14:15]
  v_cndmask_b32 v57, v250, v246, s[14:15]
  v_mfma_f32_16x16x32_bf16 v[252:255], v[88:91], v[220:223], v[252:255]
  s_add_u32 s30, s30, 13440
  buffer_load_dwordx4 v15, s[32:35], s30 offen offset:896 lds
  v_mfma_f32_16x16x32_bf16 v[32:35], v[92:95], v[220:223], v[32:35]
  v_add_f32_dpp v245, v56, v245 wave_ror:1 row_mask:0xf bank_mask:0xf
  v_add_f32_dpp v249, v57, v249 wave_ror:1 row_mask:0xf bank_mask:0xf
  v_mfma_f32_16x16x32_bf16 v[252:255], v[96:99], v[216:219], v[252:255]
  v_cndmask_b32 v56, v245, v241, s[14:15]
  v_cndmask_b32 v57, v249, v245, s[14:15]
  v_mfma_f32_16x16x32_bf16 v[32:35], v[100:103], v[216:219], v[32:35]
  v_add_f32_dpp v244, v56, v244 wave_ror:1 row_mask:0xf bank_mask:0xf
  v_add_f32_dpp v248, v57, v248 wave_ror:1 row_mask:0xf bank_mask:0xf
  v_mfma_f32_16x16x32_bf16 v[252:255], v[104:107], v[212:215], v[252:255]
  s_waitcnt lgkmcnt(1)
  v_fma_f32 v58, v12, s59, v244
  v_mfma_f32_16x16x32_bf16 v[32:35], v[108:111], v[212:215], v[32:35]
  s_waitcnt lgkmcnt(0)
  v_fma_f32 v59, v13, s59, v248
  v_mfma_f32_16x16x32_bf16 v[252:255], v[112:115], v[208:211], v[252:255]
  v_cvt_pk_bf16_f32 v58, v58, v59
  ds_write_b16 v6, v58 offset:5120
  v_mfma_f32_16x16x32_bf16 v[32:35], v[116:119], v[208:211], v[32:35]
  ds_write_b16_d16_hi v6, v58 offset:5632
  v_mfma_f32_16x16x32_bf16 v[252:255], v[120:123], v[204:207], v[252:255]
  s_add_u32 s30, s30, 13440
  buffer_load_dwordx4 v15, s[32:35], s30 offen offset:1792 lds
  v_mfma_f32_16x16x32_bf16 v[32:35], v[124:127], v[204:207], v[32:35]
  v_mfma_f32_16x16x32_bf16 v[252:255], v[128:131], v[200:203], v[252:255]
  v_mfma_f32_16x16x32_bf16 v[32:35], v[132:135], v[200:203], v[32:35]
  v_mfma_f32_16x16x32_bf16 v[252:255], v[136:139], v[196:199], v[252:255]
  v_mfma_f32_16x16x32_bf16 v[32:35], v[140:143], v[196:199], v[32:35]
  v_mfma_f32_16x16x32_bf16 v[252:255], v[144:147], v[192:195], v[252:255]
  v_mfma_f32_16x16x32_bf16 v[32:35], v[148:151], v[192:195], v[32:35]
  v_mfma_f32_16x16x32_bf16 v[36:39], v[64:67], a[236:239], 0
  s_add_u32 s30, s30, 13440
  ds_read_u16_d16_hi v12, v7 offset:2560
  v_mfma_f32_16x16x32_bf16 v[40:43], v[68:71], a[236:239], 0
  s_mov_b32 exec_hi, 0x00ffffff
  buffer_load_dwordx4 v15, s[32:35], s30 offen offset:2688 lds
  s_mov_b32 exec_hi, -1
  v_mfma_f32_16x16x32_bf16 v[36:39], v[72:75], a[232:235], v[36:39]
  ds_read_u16_d16_hi v13, v7 offset:2688
  v_mfma_f32_16x16x32_bf16 v[40:43], v[76:79], a[232:235], v[40:43]
  v_cndmask_b32 v56, v255, v251, s[14:15]
  v_cndmask_b32 v57, v35, v255, s[14:15]
  v_mfma_f32_16x16x32_bf16 v[36:39], v[80:83], a[228:231], v[36:39]
  v_add_f32_dpp v254, v56, v254 wave_ror:1 row_mask:0xf bank_mask:0xf
  v_add_f32_dpp v34, v57, v34 wave_ror:1 row_mask:0xf bank_mask:0xf
  v_mfma_f32_16x16x32_bf16 v[40:43], v[84:87], a[228:231], v[40:43]
  v_cndmask_b32 v56, v254, v250, s[14:15]
  v_cndmask_b32 v57, v34, v254, s[14:15]
  v_mfma_f32_16x16x32_bf16 v[36:39], v[88:91], a[224:227], v[36:39]
  v_add_f32_dpp v253, v56, v253 wave_ror:1 row_mask:0xf bank_mask:0xf
  v_add_f32_dpp v33, v57, v33 wave_ror:1 row_mask:0xf bank_mask:0xf
  v_mfma_f32_16x16x32_bf16 v[40:43], v[92:95], a[224:227], v[40:43]
  v_cndmask_b32 v56, v253, v249, s[14:15]
  v_cndmask_b32 v57, v33, v253, s[14:15]
  v_mfma_f32_16x16x32_bf16 v[36:39], v[96:99], v[220:223], v[36:39]
  v_add_f32_dpp v252, v56, v252 wave_ror:1 row_mask:0xf bank_mask:0xf
  v_add_f32_dpp v32, v57, v32 wave_ror:1 row_mask:0xf bank_mask:0xf
  v_mfma_f32_16x16x32_bf16 v[40:43], v[100:103], v[220:223], v[40:43]
  s_waitcnt lgkmcnt(1)
  v_fma_f32 v58, v12, s59, v252
  v_mfma_f32_16x16x32_bf16 v[36:39], v[104:107], v[216:219], v[36:39]
  s_waitcnt lgkmcnt(0)
  v_fma_f32 v59, v13, s59, v32
  v_mfma_f32_16x16x32_bf16 v[40:43], v[108:111], v[216:219], v[40:43]
  v_cvt_pk_bf16_f32 v58, v58, v59
  ds_write_b16 v6, v58 offset:6144
  v_mfma_f32_16x16x32_bf16 v[36:39], v[112:115], v[212:215], v[36:39]
  ds_write_b16_d16_hi v6, v58 offset:6656
  v_mfma_f32_16x16x32_bf16 v[40:43], v[116:119], v[212:215], v[40:43]
  v_mfma_f32_16x16x32_bf16 v[36:39], v[120:123], v[208:211], v[36:39]
  v_mfma_f32_16x16x32_bf16 v[40:43], v[124:127], v[208:211], v[40:43]
  v_mfma_f32_16x16x32_bf16 v[36:39], v[128:131], v[204:207], v[36:39]
  v_mfma_f32_16x16x32_bf16 v[40:43], v[132:135], v[204:207], v[40:43]
  v_mfma_f32_16x16x32_bf16 v[36:39], v[136:139], v[200:203], v[36:39]
  v_mfma_f32_16x16x32_bf16 v[40:43], v[140:143], v[200:203], v[40:43]
  v_mfma_f32_16x16x32_bf16 v[36:39], v[144:147], v[196:199], v[36:39]
  v_mfma_f32_16x16x32_bf16 v[40:43], v[148:151], v[196:199], v[40:43]
  v_mfma_f32_16x16x32_bf16 v[36:39], v[152:155], v[192:195], v[36:39]
  v_mfma_f32_16x16x32_bf16 v[40:43], v[156:159], v[192:195], v[40:43]
  ds_read_u16_d16_hi v12, v7 offset:2816
  ds_read_u16_d16_hi v13, v7 offset:2944
  s_nop 4
  v_cndmask_b32 v56, v39, v35, s[14:15]
  v_cndmask_b32 v57, v43, v39, s[14:15]
  s_nop 0
  v_add_f32_dpp v38, v56, v38 wave_ror:1 row_mask:0xf bank_mask:0xf
  v_add_f32_dpp v42, v57, v42 wave_ror:1 row_mask:0xf bank_mask:0xf
  v_cndmask_b32 v56, v38, v34, s[14:15]
  v_cndmask_b32 v57, v42, v38, s[14:15]
  s_nop 0
  v_add_f32_dpp v37, v56, v37 wave_ror:1 row_mask:0xf bank_mask:0xf
  v_add_f32_dpp v41, v57, v41 wave_ror:1 row_mask:0xf bank_mask:0xf
  v_cndmask_b32 v56, v37, v33, s[14:15]
  v_cndmask_b32 v57, v41, v37, s[14:15]
  s_nop 0
  v_add_f32_dpp v36, v56, v36 wave_ror:1 row_mask:0xf bank_mask:0xf
  v_add_f32_dpp v40, v57, v40 wave_ror:1 row_mask:0xf bank_mask:0xf
  s_waitcnt lgkmcnt(1)
  v_fma_f32 v58, v12, s59, v36
  s_waitcnt lgkmcnt(0)
  v_fma_f32 v59, v13, s59, v40
  v_cvt_pk_bf16_f32 v58, v58, v59
  ds_write_b16 v6, v58 offset:7168
  ds_write_b16_d16_hi v6, v58 offset:7680
f_cv_join:
  s_waitcnt vmcnt(4)
  v_cmp_gt_u32 vcc, s97, v30
  s_nop 4
  s_cbranch_vccz f_fb_ok
  s_mov_b32 s69, 0
f_fb:
  buffer_load_dword v30, v11, s[52:55], 0 offen offset:0 sc1
  s_add_u32 s69, s69, 1
  s_waitcnt vmcnt(0)
  v_cmp_gt_u32 vcc, s97, v30
  s_cmp_ge_u32 s69, 4000
  s_cbranch_scc1 f_fb_out
  s_nop 3
  s_cbranch_vccnz f_fb
f_fb_out:
f_fb_ok:
  s_waitcnt lgkmcnt(0)
  s_barrier
  ds_read_b128 v[200:203], v10 offset:0
  ds_read_b128 v[204:207], v10 offset:4096
  s_waitcnt lgkmcnt(1)
  buffer_store_dwordx4 v[200:203], v3, s[20:23], s66 offen sc1
  s_waitcnt lgkmcnt(0)
  buffer_store_dwordx4 v[204:207], v3, s[20:23], s67 offen sc1
  s_lshl_b32 s60, s4, 5
  s_add_u32 s60, s60, s5
  s_lshl_b32 s60, s60, 13
  s_lshl_b32 s61, s3, 11
  s_add_u32 s60, s60, s61
  s_add_u32 s52, s60, 4194304
  s_add_u32 s53, s60, 2097152
  s_lshl_b32 s61, s4, 11
  s_add_u32 s61, s61, 6292480
  s_lshl_b32 s54, s5, 4
  s_lshl_b32 s63, s3, 2
  s_add_u32 s54, s54, s63
  s_add_u32 s54, s54, s61
  s_and_b32 s60, s58, 7
  s_lshl_b32 s60, s60, 6
  s_add_u32 s55, s60, s61
  v_lshrrev_b32 v38, 3, v1
  s_add_u32 s31, s31, 1
  s_and_b32 s31, s31, 7
  s_mul_i32 s30, s31, 3584
  s_add_u32 m0, s30, s29
  s_lshl4_add_u32 s30, s30, s28
  buffer_load_dwordx4 v15, s[32:35], s30 offen offset:0 lds
  v_and_b32 v39, 7, v1
  v_and_b32 v40, 1, v38
  v_lshlrev_b32 v40, 2, v40
  v_xor_b32 v39, v39, v40
  v_lshlrev_b32 v38, 9, v38
  v_add_u32 v38, s68, v38
  v_lshl_add_u32 v250, v39, 4, v38
  v_xor_b32 v39, 2, v39
  v_lshl_add_u32 v251, v39, 4, v38
  v_lshrrev_b32 v38, 2, v1
  s_add_u32 s30, s30, 13440
  buffer_load_dwordx4 v15, s[32:35], s30 offen offset:896 lds
  v_bfe_u32 v39, v38, 1, 2
  v_and_b32 v40, 3, v1
  v_lshlrev_b32 v38, 7, v38
  v_lshl_add_u32 v38, v40, 3, v38
  v_add_u32 v38, s68, v38
  s_add_u32 s60, s3, 0
  s_and_b32 s60, s60, 3
  v_xor_b32 v40, s60, v39
  v_lshl_add_u32 v252, v40, 5, v38
  s_add_u32 s60, s3, 1
  s_and_b32 s60, s60, 3
  v_xor_b32 v40, s60, v39
  v_lshl_add_u32 v253, v40, 5, v38
  s_add_u32 s60, s3, 2
  s_and_b32 s60, s60, 3
  v_xor_b32 v40, s60, v39
  s_add_u32 s30, s30, 13440
  buffer_load_dwordx4 v15, s[32:35], s30 offen offset:1792 lds
  v_lshl_add_u32 v254, v40, 5, v38
  s_add_u32 s60, s3, 3
  s_and_b32 s60, s60, 3
  v_xor_b32 v40, s60, v39
  v_lshl_add_u32 v255, v40, 5, v38
  v_mov_b32 v12, v25
  v_lshrrev_b32 v38, 4, v1
  v_and_b32 v39, 3, v1
  v_lshl_add_u32 v40, v38, 2, v39
  v_lshlrev_b32 v43, 4, v40
  v_add_u32 v43, 161792, v43
  s_lshl_b32 s60, s3, 2
  v_add_u32 v42, s60, v43
  s_add_u32 s30, s30, 13440
  s_mov_b32 exec_hi, 0x00ffffff
  buffer_load_dwordx4 v15, s[32:35], s30 offen offset:2688 lds
  s_mov_b32 exec_hi, -1
  v_bfe_u32 v40, v1, 2, 2
  v_lshlrev_b32 v3, 13, v40
  v_lshl_add_u32 v3, v38, 6, v3
  v_lshl_add_u32 v3, v39, 4, v3
  v_mov_b32 v4, 0
  v_and_b32 v11, 15, v1
  v_lshlrev_b32 v11, 2, v11
  v_dot2_f32_bf16 v120, v16, s7, 0
  v_dot2_f32_bf16 v122, v16, v16, 0
  v_dot2_f32_bf16 v121, v18, s7, 0
  s_add_u32 s31, s31, 1
  s_and_b32 s31, s31, 7
  s_mul_i32 s30, s31, 3584
  s_add_u32 m0, s30, s29
  s_lshl4_add_u32 s30, s30, s28
  buffer_load_dwordx4 v15, s[32:35], s30 offen offset:0 lds
  v_dot2_f32_bf16 v123, v18, v18, 0
  v_dot2_f32_bf16 v120, v17, s7, v120
  v_dot2_f32_bf16 v122, v17, v17, v122
  v_dot2_f32_bf16 v121, v19, s7, v121
  v_dot2_f32_bf16 v123, v19, v19, v123
  v_dot2_f32_bf16 v120, v20, s7, v120
  v_dot2_f32_bf16 v122, v20, v20, v122
  v_dot2_f32_bf16 v121, v22, s7, v121
  v_dot2_f32_bf16 v123, v22, v22, v123
  v_dot2_f32_bf16 v120, v21, s7, v120
  s_add_u32 s30, s30, 13440
  buffer_load_dwordx4 v15, s[32:35], s30 offen offset:896 lds
  v_dot2_f32_bf16 v122, v21, v21, v122
  v_dot2_f32_bf16 v121, v23, s7, v121
  v_dot2_f32_bf16 v123, v23, v23, v123
  s_nop 1
  v_permlane32_swap_b32 v120, v121
  v_permlane32_swap_b32 v122, v123
  v_add_f32 v120, v120, v121
  v_add_f32 v122, v122, v123
  s_nop 1
  v_permlane16_swap_b32 v120, v122
  v_add_f32 v120, v120, v122
  s_nop 1
  v_add_f32_dpp v120, v120, v120 row_ror:4 row_mask:0xf bank_mask:0xf
  s_add_u32 s30, s30, 13440
  buffer_load_dwordx4 v15, s[32:35], s30 offen offset:1792 lds
  v_add_f32_dpp v120, v120, v120 row_ror:8 row_mask:0xf bank_mask:0xf
  ds_write_b32 v42, v120 offset:0
  s_and_b32 s60, s5, 15
  s_mul_i32 s60, s60, 224
  v_lshrrev_b32 v10, 4, v1
  v_lshl_add_u32 v10, v10, 3, s60
  s_lshr_b32 s61, s94, 9
  buffer_load_dwordx2 v[148:149], v10, s[40:43], s61 offen offset:0
  buffer_load_dwordx2 v[156:157], v10, s[40:43], s61 offen offset:32
  s_lshr_b32 s62, s95, 9
  buffer_load_dwordx2 v[164:165], v10, s[40:43], s62 offen offset:0
  buffer_load_dwordx2 v[172:173], v10, s[40:43], s62 offen offset:32
  s_lshr_b32 s63, s96, 9
  buffer_load_dwordx2 v[180:181], v10, s[40:43], s63 offen offset:0
  buffer_load_dwordx2 v[188:189], v10, s[40:43], s63 offen offset:32
  buffer_load_dwordx2 v[196:197], v10, s[40:43], 0 offen offset:192
  s_waitcnt lgkmcnt(0)
  s_barrier
  ds_read_b128 v[120:123], v43 offset:0
  s_waitcnt lgkmcnt(0)
  v_pk_add_f32 v[120:121], v[120:121], v[122:123]
  v_add_f32 v120, v120, v121
  v_mov_b32 v121, v120
  s_nop 1
  v_permlane16_swap_b32 v120, v121
  v_mul_f32 v120, 0x3b000000, v120
  v_mul_f32 v121, 0x3b000000, v121
  v_fma_f32 v121, -v120, v120, v121
  s_add_u32 s30, s30, 13440
  s_mov_b32 exec_hi, 0x00ffffff
  buffer_load_dwordx4 v15, s[32:35], s30 offen offset:2688 lds
  s_mov_b32 exec_hi, -1
  v_cvt_pk_bf16_f32 v120, v120, v120
  v_lshlrev_b32 v120, 16, v120
  v_cvt_pk_bf16_f32 v121, v121, v121
  v_lshlrev_b32 v121, 16, v121
  v_add_f32 v121, 0x3727c5ac, v121
  v_cvt_pk_bf16_f32 v121, v121, v121
  v_lshlrev_b32 v121, 16, v121
  v_sqrt_f32 v121, v121
  v_lshlrev_b32 v64, 16, v16
  v_and_b32 v65, s6, v16
  s_add_u32 s31, s31, 1
  s_and_b32 s31, s31, 7
  s_mul_i32 s30, s31, 3584
  s_add_u32 m0, s30, s29
  s_lshl4_add_u32 s30, s30, s28
  buffer_load_dwordx4 v15, s[32:35], s30 offen offset:0 lds
  v_lshlrev_b32 v66, 16, v17
  v_and_b32 v67, s6, v17
  v_lshlrev_b32 v68, 16, v18
  v_and_b32 v69, s6, v18
  v_lshlrev_b32 v70, 16, v19
  v_and_b32 v71, s6, v19
  v_cvt_pk_bf16_f32 v121, v121, v121
  v_lshlrev_b32 v121, 16, v121
  v_rcp_f32 v124, v121
  v_lshlrev_b32 v72, 16, v20
  s_add_u32 s30, s30, 13440
  buffer_load_dwordx4 v15, s[32:35], s30 offen offset:896 lds
  v_and_b32 v73, s6, v20
  v_lshlrev_b32 v74, 16, v21
  v_and_b32 v75, s6, v21
  v_lshlrev_b32 v76, 16, v22
  v_and_b32 v77, s6, v22
  v_lshlrev_b32 v78, 16, v23
  v_and_b32 v79, s6, v23
  v_mul_f32 v125, v120, v124
  v_sub_f32 v125, 0, v125
  v_mov_b32 v126, v124
  s_add_u32 s30, s30, 13440
  buffer_load_dwordx4 v15, s[32:35], s30 offen offset:1792 lds
  v_mov_b32 v127, v125
  v_permlane32_swap_b32 v124, v126
  s_nop 0
  v_permlane32_swap_b32 v125, v127
  v_pk_fma_f32 v[80:81], v[64:65], v[124:125], v[124:125] op_sel:[0,0,1] op_sel_hi:[1,0,1]
  v_pk_fma_f32 v[82:83], v[66:67], v[124:125], v[124:125] op_sel:[0,0,1] op_sel_hi:[1,0,1]
  v_pk_fma_f32 v[84:85], v[68:69], v[126:127], v[126:127] op_sel:[0,0,1] op_sel_hi:[1,0,1]
  v_pk_fma_f32 v[86:87], v[70:71], v[126:127], v[126:127] op_sel:[0,0,1] op_sel_hi:[1,0,1]
  v_pk_fma_f32 v[88:89], v[72:73], v[124:125], v[124:125] op_sel:[0,0,1] op_sel_hi:[1,0,1]
  v_pk_fma_f32 v[90:91], v[74:75], v[124:125], v[124:125] op_sel:[0,0,1] op_sel_hi:[1,0,1]
  v_pk_fma_f32 v[92:93], v[76:77], v[126:127], v[126:127] op_sel:[0,0,1] op_sel_hi:[1,0,1]
  s_add_u32 s30, s30, 13440
  s_mov_b32 exec_hi, 0x00ffffff
  buffer_load_dwordx4 v15, s[32:35], s30 offen offset:2688 lds
  s_mov_b32 exec_hi, -1
  v_pk_fma_f32 v[94:95], v[78:79], v[126:127], v[126:127] op_sel:[0,0,1] op_sel_hi:[1,0,1]
  v_lshrrev_b32 v6, 2, v1
  v_mul_u32_u24 v6, 224, v6
  v_and_b32 v10, 3, v1
  v_lshl_add_u32 v6, v10, 3, v6
  v_add_u32 v7, 57344, v6
  v_mov_b32 v240, 3222493025
  v_mov_b32 v241, 3184710632
  v_mov_b32 v242, 1.0
  s_and_b32 s61, s5, 15
  s_lshl_b32 s64, s58, 4
  s_add_u32 s64, s64, s61
  s_lshl_b32 s64, s64, 11
  s_lshl_b32 s67, s58, 15
  s_add_u32 s67, s67, 4194304
  s_add_u32 s59, s67, 4096
  s_bfe_u32 s65, s58, 0x20001
  s_lshl_b32 s65, s65, 7
  s_lshr_b32 s60, s61, 2
  s_lshl_b32 s60, s60, 5
  s_add_u32 s65, s65, s60
  s_and_b32 s60, s3, 1
  s_lshl_b32 s60, s60, 4
  s_add_u32 s65, s65, s60
  s_and_b32 s60, s61, 3
  s_lshl_b32 s60, s60, 2
  s_add_u32 s65, s65, s60
  s_lshl_b32 s60, s4, 11
  s_add_u32 s65, s65, s60
  s_add_u32 s65, s65, 6292992
  s_add_u32 s66, s60, 6292480
  v_add_u32 v14, 8388608, v2
  v_add_u32 v0, 10485760, v2
  v_add_u32 v244, 16777216, v2
  v_add_u32 v245, 4194304, v2
  s_andn2_b32 s60, s65, 0x6c
  s_sub_u32 s60, s60, s66
  v_bfe_u32 v247, v1, 2, 2
  v_lshl_add_u32 v247, v247, 5, s60
  v_and_b32 v10, 3, v1
  v_lshl_add_u32 v247, v10, 2, v247
  buffer_load_dwordx4 v[96:99], v2, s[20:23], s52 offen offset:0 sc1
  buffer_load_dwordx4 v[100:103], v2, s[20:23], s52 offen offset:1024 sc1
  s_waitcnt vmcnt(1)
  v_max3_u32 v120, v96, v97, v98
  s_waitcnt vmcnt(0)
  v_max3_u32 v121, v100, v101, v102
  v_max3_u32 v120, v120, v99, v103
  v_max_u32 v120, v120, v121
  v_cmp_eq_u32 vcc, -1, v120
  s_mov_b32 s69, 0
  v_lshlrev_b32 v104, 16, v96
  v_and_b32 v105, s6, v96
  v_lshlrev_b32 v106, 16, v97
  v_and_b32 v107, s6, v97
  s_cbranch_vccz f_y_ok
f_y_l:
  s_mov_b64 exec, vcc
  buffer_load_dwordx4 v[96:99], v2, s[20:23], s52 offen offset:0 sc1
  buffer_load_dwordx4 v[100:103], v2, s[20:23], s52 offen offset:1024 sc1
  s_mov_b64 exec, -1
  s_add_u32 s69, s69, 1
  s_waitcnt vmcnt(1)
  v_max3_u32 v120, v96, v97, v98
  s_waitcnt vmcnt(0)
  v_max3_u32 v121, v100, v101, v102
  v_max3_u32 v120, v120, v99, v103
  v_max_u32 v120, v120, v121
  v_cmp_eq_u32 vcc, -1, v120
  s_cmp_ge_u32 s69, 4000
  v_lshlrev_b32 v104, 16, v96
  v_and_b32 v105, s6, v96
  v_lshlrev_b32 v106, 16, v97
  v_and_b32 v107, s6, v97
  s_cbranch_scc1 f_y_ok
  s_cbranch_vccnz f_y_l
f_y_ok:
  v_lshlrev_b32 v108, 16, v98
  s_add_u32 s31, s31, 1
  s_and_b32 s31, s31, 7
  s_mul_i32 s30, s31, 3584
  s_add_u32 m0, s30, s29
  s_lshl4_add_u32 s30, s30, s28
  buffer_load_dwordx4 v15, s[32:35], s30 offen offset:0 lds
  v_and_b32 v109, s6, v98
  v_lshlrev_b32 v110, 16, v99
  v_and_b32 v111, s6, v99
  v_pk_fma_f32 v[104:105], v[80:81], v[104:105], v[64:65]
  v_pk_fma_f32 v[106:107], v[82:83], v[106:107], v[66:67]
  v_pk_fma_f32 v[108:109], v[84:85], v[108:109], v[68:69]
  v_pk_fma_f32 v[110:111], v[86:87], v[110:111], v[70:71]
  v_cvt_pk_bf16_f32 v96, v104, v105
  v_cvt_pk_bf16_f32 v97, v106, v107
  v_cvt_pk_bf16_f32 v98, v108, v109
  s_add_u32 s30, s30, 13440
  buffer_load_dwordx4 v15, s[32:35], s30 offen offset:896 lds
  v_cvt_pk_bf16_f32 v99, v110, v111
  v_lshlrev_b32 v112, 16, v100
  v_and_b32 v113, s6, v100
  v_lshlrev_b32 v114, 16, v101
  v_and_b32 v115, s6, v101
  v_lshlrev_b32 v116, 16, v102
  v_and_b32 v117, s6, v102
  v_lshlrev_b32 v118, 16, v103
  v_and_b32 v119, s6, v103
  v_pk_fma_f32 v[112:113], v[88:89], v[112:113], v[72:73]
  s_add_u32 s30, s30, 13440
  buffer_load_dwordx4 v15, s[32:35], s30 offen offset:1792 lds
  v_pk_fma_f32 v[114:115], v[90:91], v[114:115], v[74:75]
  v_pk_fma_f32 v[116:117], v[92:93], v[116:117], v[76:77]
  v_pk_fma_f32 v[118:119], v[94:95], v[118:119], v[78:79]
  v_cvt_pk_bf16_f32 v100, v112, v113
  v_cvt_pk_bf16_f32 v101, v114, v115
  v_cvt_pk_bf16_f32 v102, v116, v117
  v_cvt_pk_bf16_f32 v103, v118, v119
  v_dot2_f32_bf16 v120, v96, s7, 0
  v_dot2_f32_bf16 v122, v96, v96, 0
  v_dot2_f32_bf16 v121, v98, s7, 0
  s_add_u32 s30, s30, 13440
  s_mov_b32 exec_hi, 0x00ffffff
  buffer_load_dwordx4 v15, s[32:35], s30 offen offset:2688 lds
  s_mov_b32 exec_hi, -1
  v_dot2_f32_bf16 v123, v98, v98, 0
  v_dot2_f32_bf16 v120, v97, s7, v120
  v_dot2_f32_bf16 v122, v97, v97, v122
  v_dot2_f32_bf16 v121, v99, s7, v121
  v_dot2_f32_bf16 v123, v99, v99, v123
  v_dot2_f32_bf16 v120, v100, s7, v120
  v_dot2_f32_bf16 v122, v100, v100, v122
  v_dot2_f32_bf16 v121, v102, s7, v121
  v_dot2_f32_bf16 v123, v102, v102, v123
  v_dot2_f32_bf16 v120, v101, s7, v120
  s_add_u32 s31, s31, 1
  s_and_b32 s31, s31, 7
  s_mul_i32 s30, s31, 3584
  s_add_u32 m0, s30, s29
  s_lshl4_add_u32 s30, s30, s28
  buffer_load_dwordx4 v15, s[32:35], s30 offen offset:0 lds
  v_dot2_f32_bf16 v122, v101, v101, v122
  v_dot2_f32_bf16 v121, v103, s7, v121
  v_dot2_f32_bf16 v123, v103, v103, v123
  s_nop 1
  v_permlane32_swap_b32 v120, v121
  v_permlane32_swap_b32 v122, v123
  v_add_f32 v120, v120, v121
  v_add_f32 v122, v122, v123
  s_nop 1
  v_permlane16_swap_b32 v120, v122
  v_add_f32 v120, v120, v122
  s_nop 1
  v_add_f32_dpp v120, v120, v120 row_ror:4 row_mask:0xf bank_mask:0xf
  s_add_u32 s30, s30, 13440
  buffer_load_dwordx4 v15, s[32:35], s30 offen offset:896 lds
  v_add_f32_dpp v120, v120, v120 row_ror:8 row_mask:0xf bank_mask:0xf
  ds_write_b32 v42, v120 offset:256
  buffer_store_dwordx4 v[96:99], v2, s[20:23], s53 offen offset:0
  buffer_store_dwordx4 v[100:103], v2, s[20:23], s53 offen offset:1024
  s_waitcnt lgkmcnt(0)
  s_barrier
  ds_read_b128 v[120:123], v43 offset:256
  v_lshlrev_b32 v104, 16, v96
  v_and_b32 v105, s6, v96
  v_lshlrev_b32 v106, 16, v97
  v_and_b32 v107, s6, v97
  v_lshlrev_b32 v108, 16, v98
  v_and_b32 v109, s6, v98
  v_lshlrev_b32 v110, 16, v99
  v_and_b32 v111, s6, v99
  v_lshlrev_b32 v112, 16, v100
  s_add_u32 s30, s30, 13440
  buffer_load_dwordx4 v15, s[32:35], s30 offen offset:1792 lds
  v_and_b32 v113, s6, v100
  v_lshlrev_b32 v114, 16, v101
  v_and_b32 v115, s6, v101
  v_lshlrev_b32 v116, 16, v102
  v_and_b32 v117, s6, v102
  v_lshlrev_b32 v118, 16, v103
  v_and_b32 v119, s6, v103
  s_waitcnt lgkmcnt(0)
  v_pk_add_f32 v[120:121], v[120:121], v[122:123]
  v_add_f32 v120, v120, v121
  v_mov_b32 v121, v120
  s_add_u32 s30, s30, 13440
  s_mov_b32 exec_hi, 0x00ffffff
  buffer_load_dwordx4 v15, s[32:35], s30 offen offset:2688 lds
  s_mov_b32 exec_hi, -1
  v_permlane16_swap_b32 v120, v121
  v_mul_f32 v120, 0xbb000000, v120
  v_mul_f32 v121, 0x3b000000, v121
  v_fma_f32 v121, -v120, v120, v121
  v_cvt_pk_bf16_f32 v122, v121, v121
  v_lshlrev_b32 v122, 16, v122
  v_add_f32 v122, 0x3727c5ac, v122
  v_cvt_pk_bf16_f32 v122, v122, v122
  v_lshlrev_b32 v122, 16, v122
  v_sqrt_f32 v122, v122
  s_nop 0
  v_cvt_pk_bf16_f32 v122, v122, v122
  v_lshlrev_b32 v122, 16, v122
  v_rcp_f32 v122, v122
  s_nop 0
  v_mul_f32 v121, v121, v122
  v_mul_f32 v121, v121, v122
  v_cvt_pk_bf16_f32 v121, v121, v121
  v_lshlrev_b32 v121, 16, v121
  v_add_f32 v121, 0x3727c5ac, v121
  v_cvt_pk_bf16_f32 v121, v121, v121
  v_lshlrev_b32 v121, 16, v121
  v_sqrt_f32 v121, v121
  s_nop 0
  v_cvt_pk_bf16_f32 v121, v121, v121
  v_lshlrev_b32 v121, 16, v121
  v_rcp_f32 v121, v121
  s_nop 0
  v_mul_f32 v124, v122, v121
  v_mul_f32 v125, v120, v124
  v_mov_b32 v126, v124
  v_mov_b32 v127, v125
  s_nop 0
  v_permlane32_swap_b32 v124, v126
  v_permlane32_swap_b32 v125, v127
  v_pk_fma_f32 v[104:105], v[104:105], v[124:125], v[124:125] op_sel:[0,0,1] op_sel_hi:[1,0,1]
  v_pk_fma_f32 v[106:107], v[106:107], v[124:125], v[124:125] op_sel:[0,0,1] op_sel_hi:[1,0,1]
  v_pk_fma_f32 v[108:109], v[108:109], v[126:127], v[126:127] op_sel:[0,0,1] op_sel_hi:[1,0,1]
  v_pk_fma_f32 v[110:111], v[110:111], v[126:127], v[126:127] op_sel:[0,0,1] op_sel_hi:[1,0,1]
  v_cvt_pk_bf16_f32 v64, v104, v105
  v_cvt_pk_bf16_f32 v65, v106, v107
  v_cvt_pk_bf16_f32 v66, v108, v109
  v_cvt_pk_bf16_f32 v67, v110, v111
  buffer_store_dwordx4 v[64:67], v2, s[20:23], s52 offen offset:0
  v_pk_fma_f32 v[112:113], v[112:113], v[124:125], v[124:125] op_sel:[0,0,1] op_sel_hi:[1,0,1]
  v_pk_fma_f32 v[114:115], v[114:115], v[124:125], v[124:125] op_sel:[0,0,1] op_sel_hi:[1,0,1]
  v_pk_fma_f32 v[116:117], v[116:117], v[126:127], v[126:127] op_sel:[0,0,1] op_sel_hi:[1,0,1]
  v_pk_fma_f32 v[118:119], v[118:119], v[126:127], v[126:127] op_sel:[0,0,1] op_sel_hi:[1,0,1]
  v_cvt_pk_bf16_f32 v68, v112, v113
  v_cvt_pk_bf16_f32 v69, v114, v115
  v_cvt_pk_bf16_f32 v70, v116, v117
  v_cvt_pk_bf16_f32 v71, v118, v119
  buffer_store_dwordx4 v[68:71], v2, s[20:23], s52 offen offset:1024
  v_lshlrev_b32 v144, 16, v148
  v_and_b32 v145, s6, v148
  v_lshlrev_b32 v146, 16, v149
  v_and_b32 v147, s6, v149
  v_lshlrev_b32 v152, 16, v156
  v_and_b32 v153, s6, v156
  v_lshlrev_b32 v154, 16, v157
  v_and_b32 v155, s6, v157
  v_lshlrev_b32 v160, 16, v164
  v_and_b32 v161, s6, v164
  v_lshlrev_b32 v162, 16, v165
  v_and_b32 v163, s6, v165
  v_lshlrev_b32 v168, 16, v172
  v_and_b32 v169, s6, v172
  v_lshlrev_b32 v170, 16, v173
  v_and_b32 v171, s6, v173
  v_lshlrev_b32 v176, 16, v180
  v_and_b32 v177, s6, v180
  v_lshlrev_b32 v178, 16, v181
  v_and_b32 v179, s6, v181
  v_lshlrev_b32 v184, 16, v188
  v_and_b32 v185, s6, v188
  v_lshlrev_b32 v186, 16, v189
  v_and_b32 v187, s6, v189
  v_lshlrev_b32 v192, 16, v196
  v_and_b32 v193, s6, v196
  v_lshlrev_b32 v194, 16, v197
  v_and_b32 v195, s6, v197
  s_waitcnt vmcnt(0)
  v_mov_b32 v5, 1
  s_mov_b64 exec, 1
  buffer_store_dword v5, v4, s[20:23], s54 offen
  s_mov_b64 exec, -1
  buffer_load_dword v13, v11, s[20:23], s55 offen sc1
  s_lshl_b32 s16, s4, 2
  s_lshr_b32 s17, s5, 3
  s_add_u32 s16, s16, s17
  s_lshl_b32 s16, s16, 1
  s_lshl_b32 s17, s16, 4
  s_lshl_b32 s18, s3, 2
  s_add_u32 s17, s17, s18
  s_xor_b32 s19, s56, 0
  s_add_u32 s19, s19, s17
  s_lshl_b32 s8, s19, 11
  s_add_u32 s12, s8, 32768
  s_xor_b32 s19, s56, 1
  s_add_u32 s19, s19, s17
  s_lshl_b32 s9, s19, 11
  s_add_u32 s13, s9, 32768
  s_xor_b32 s19, s56, 2
  s_add_u32 s19, s19, s17
  s_lshl_b32 s10, s19, 11
  s_add_u32 s14, s10, 32768
  s_xor_b32 s19, s56, 3
  s_add_u32 s19, s19, s17
  s_lshl_b32 s11, s19, 11
  s_add_u32 s15, s11, 32768
  s_lshr_b32 s17, s5, 3
  s_lshl_b32 s17, s17, 7
  s_lshl_b32 s18, s3, 5
  s_add_u32 s17, s17, s18
  s_lshl_b32 s18, s4, 11
  s_add_u32 s17, s17, s18
  s_add_u32 s17, s17, 6292992
  v_and_b32 v15, 7, v1
  v_lshlrev_b32 v15, 2, v15
  s_barrier
  ds_read_b64_tr_b16 v[200:201], v6 offset:0
  ds_read_b64_tr_b16 v[202:203], v6 offset:3584
  ds_read_b64_tr_b16 v[204:205], v6 offset:32
  ds_read_b64_tr_b16 v[206:207], v6 offset:3616
  ds_read_b64_tr_b16 v[208:209], v6 offset:64
  ds_read_b64_tr_b16 v[210:211], v6 offset:3648
  ds_read_b64_tr_b16 v[212:213], v6 offset:96
  ds_read_b64_tr_b16 v[214:215], v6 offset:3680
  s_waitcnt vmcnt(0)
  v_cmp_gt_u32 vcc, 1, v13
  s_nop 4
  s_cbranch_vccz f_hp_ok
  s_mov_b32 s69, 0
f_hp:
  buffer_load_dword v13, v11, s[20:23], s55 offen offset:0 sc1
  s_add_u32 s69, s69, 1
  s_waitcnt vmcnt(0)
  v_cmp_gt_u32 vcc, 1, v13
  s_cmp_ge_u32 s69, 4000
  s_cbranch_scc1 f_hp_out
  s_nop 3
  s_cbranch_vccnz f_hp
f_hp_out:
f_hp_ok:
  buffer_load_dwordx4 v[16:19], v3, s[20:23], s67 offen offset:0 sc1
  buffer_load_dwordx4 v[20:23], v3, s[20:23], s67 offen offset:256 sc1
  buffer_load_dwordx4 v[24:27], v3, s[20:23], s67 offen offset:512 sc1
  buffer_load_dwordx4 v[28:31], v3, s[20:23], s67 offen offset:768 sc1
  buffer_load_dwordx4 v[32:35], v3, s[20:23], s67 offen offset:1024 sc1
  buffer_load_dwordx4 v[36:39], v3, s[20:23], s67 offen offset:1280 sc1
  buffer_load_dwordx4 v[40:43], v3, s[20:23], s67 offen offset:1536 sc1
  buffer_load_dwordx4 v[44:47], v3, s[20:23], s67 offen offset:1792 sc1
  buffer_load_dwordx4 v[48:51], v3, s[20:23], s67 offen offset:2048 sc1
  buffer_load_dwordx4 v[52:55], v3, s[20:23], s67 offen offset:2304 sc1
  buffer_load_dwordx4 v[56:59], v3, s[20:23], s67 offen offset:2560 sc1
  buffer_load_dwordx4 v[60:63], v3, s[20:23], s67 offen offset:2816 sc1
  s_waitcnt vmcnt(10)
  v_swap_b32 v18, v20
  v_swap_b32 v19, v21
  s_waitcnt lgkmcnt(6)
  s_nop 0
  v_mfma_f32_16x16x32_bf16 v[148:151], v[200:203], v[20:23], v[144:147]
  buffer_load_dwordx4 v[64:67], v3, s[20:23], s67 offen offset:3072 sc1
  buffer_load_dwordx4 v[68:71], v3, s[20:23], s67 offen offset:3328 sc1
  v_mfma_f32_16x16x32_bf16 v[144:147], v[200:203], v[16:19], v[144:147]
  ds_read_b64_tr_b16 v[216:217], v6 offset:192
  s_waitcnt lgkmcnt(5)
  v_mfma_f32_16x16x32_bf16 v[156:159], v[204:207], v[20:23], v[152:155]
  ds_read_b64_tr_b16 v[218:219], v6 offset:3776
  ds_read_b64_tr_b16 v[220:221], v6 offset:7168
  v_mfma_f32_16x16x32_bf16 v[152:155], v[204:207], v[16:19], v[152:155]
  ds_read_b64_tr_b16 v[222:223], v6 offset:10752
  s_waitcnt lgkmcnt(6)
  v_mfma_f32_16x16x32_bf16 v[164:167], v[208:211], v[20:23], v[160:163]
  ds_read_b64_tr_b16 v[200:201], v6 offset:7200
  ds_read_b64_tr_b16 v[202:203], v6 offset:10784
  v_mfma_f32_16x16x32_bf16 v[160:163], v[208:211], v[16:19], v[160:163]
  ds_read_b64_tr_b16 v[204:205], v6 offset:7232
  s_waitcnt lgkmcnt(7)
  v_mfma_f32_16x16x32_bf16 v[172:175], v[212:215], v[20:23], v[168:171]
  s_waitcnt vmcnt(10)
  ds_read_b64_tr_b16 v[206:207], v6 offset:10816
  v_mfma_f32_16x16x32_bf16 v[168:171], v[212:215], v[16:19], v[168:171]
  v_swap_b32 v26, v28
  s_waitcnt lgkmcnt(6)
  v_mfma_f32_16x16x32_bf16 v[196:199], v[216:219], v[20:23], v[192:195]
  v_swap_b32 v27, v29
  v_mfma_f32_16x16x32_bf16 v[192:195], v[216:219], v[16:19], v[192:195]
  ds_read_b64_tr_b16 v[208:209], v6 offset:7264
  s_waitcnt lgkmcnt(3)
  v_mfma_f32_16x16x32_bf16 v[148:151], v[220:223], v[28:31], v[148:151]
  ds_read_b64_tr_b16 v[210:211], v6 offset:10848
  buffer_load_dwordx4 v[72:75], v3, s[20:23], s67 offen offset:3584 sc1
  v_mfma_f32_16x16x32_bf16 v[144:147], v[220:223], v[24:27], v[144:147]
  ds_read_b64_tr_b16 v[212:213], v6 offset:7360
  ds_read_b64_tr_b16 v[214:215], v6 offset:10944
  v_mfma_f32_16x16x32_bf16 v[156:159], v[200:203], v[28:31], v[156:159]
  buffer_load_dwordx4 v[76:79], v3, s[20:23], s67 offen offset:3840 sc1
  ds_read_b64_tr_b16 v[216:217], v6 offset:14336
  v_mfma_f32_16x16x32_bf16 v[152:155], v[200:203], v[24:27], v[152:155]
  ds_read_b64_tr_b16 v[218:219], v6 offset:17920
  s_waitcnt lgkmcnt(6)
  v_mfma_f32_16x16x32_bf16 v[164:167], v[204:207], v[28:31], v[164:167]
  ds_read_b64_tr_b16 v[220:221], v6 offset:14368
  ds_read_b64_tr_b16 v[222:223], v6 offset:17952
  v_mfma_f32_16x16x32_bf16 v[160:163], v[204:207], v[24:27], v[160:163]
  ds_read_b64_tr_b16 v[200:201], v6 offset:14400
  s_waitcnt lgkmcnt(7)
  v_mfma_f32_16x16x32_bf16 v[172:175], v[208:211], v[28:31], v[172:175]
  s_waitcnt vmcnt(10)
  ds_read_b64_tr_b16 v[202:203], v6 offset:17984
  v_mfma_f32_16x16x32_bf16 v[168:171], v[208:211], v[24:27], v[168:171]
  v_swap_b32 v34, v36
  s_waitcnt lgkmcnt(6)
  v_mfma_f32_16x16x32_bf16 v[196:199], v[212:215], v[28:31], v[196:199]
  v_swap_b32 v35, v37
  v_mfma_f32_16x16x32_bf16 v[192:195], v[212:215], v[24:27], v[192:195]
  ds_read_b64_tr_b16 v[204:205], v6 offset:14432
  s_waitcnt lgkmcnt(3)
  v_mfma_f32_16x16x32_bf16 v[148:151], v[216:219], v[36:39], v[148:151]
  ds_read_b64_tr_b16 v[206:207], v6 offset:18016
  buffer_load_dwordx4 v[80:83], v3, s[20:23], s59 offen offset:0 sc1
  v_mfma_f32_16x16x32_bf16 v[144:147], v[216:219], v[32:35], v[144:147]
  ds_read_b64_tr_b16 v[208:209], v6 offset:14528
  ds_read_b64_tr_b16 v[210:211], v6 offset:18112
  v_mfma_f32_16x16x32_bf16 v[156:159], v[220:223], v[36:39], v[156:159]
  buffer_load_dwordx4 v[84:87], v3, s[20:23], s59 offen offset:256 sc1
  ds_read_b64_tr_b16 v[212:213], v6 offset:21504
  v_mfma_f32_16x16x32_bf16 v[152:155], v[220:223], v[32:35], v[152:155]
  ds_read_b64_tr_b16 v[214:215], v6 offset:25088
  s_waitcnt lgkmcnt(6)
  v_mfma_f32_16x16x32_bf16 v[164:167], v[200:203], v[36:39], v[164:167]
  buffer_load_dwordx4 v[88:91], v3, s[20:23], s59 offen offset:512 sc1
  buffer_load_dwordx4 v[92:95], v3, s[20:23], s59 offen offset:768 sc1
  v_mfma_f32_16x16x32_bf16 v[160:163], v[200:203], v[32:35], v[160:163]
  ds_read_b64_tr_b16 v[216:217], v6 offset:21536
  s_waitcnt lgkmcnt(5)
  v_mfma_f32_16x16x32_bf16 v[172:175], v[204:207], v[36:39], v[172:175]
  ds_read_b64_tr_b16 v[218:219], v6 offset:25120
  s_waitcnt vmcnt(12)
  v_mfma_f32_16x16x32_bf16 v[168:171], v[204:207], v[32:35], v[168:171]
  ds_read_b64_tr_b16 v[220:221], v6 offset:21568
  s_waitcnt lgkmcnt(5)
  v_mfma_f32_16x16x32_bf16 v[196:199], v[208:211], v[36:39], v[196:199]
  ds_read_b64_tr_b16 v[222:223], v6 offset:25152
  ds_read_b64_tr_b16 v[200:201], v6 offset:21600
  v_mfma_f32_16x16x32_bf16 v[192:195], v[208:211], v[32:35], v[192:195]
  ds_read_b64_tr_b16 v[202:203], v6 offset:25184
  s_waitcnt lgkmcnt(6)
  v_swap_b32 v42, v44
  v_swap_b32 v43, v45
  s_nop 1
  v_mfma_f32_16x16x32_bf16 v[148:151], v[212:215], v[44:47], v[148:151]
  ds_read_b64_tr_b16 v[204:205], v6 offset:21696
  ds_read_b64_tr_b16 v[206:207], v6 offset:25280
  v_mfma_f32_16x16x32_bf16 v[144:147], v[212:215], v[40:43], v[144:147]
  ds_read_b64_tr_b16 v[208:209], v6 offset:28672
  s_waitcnt lgkmcnt(7)
  v_mfma_f32_16x16x32_bf16 v[156:159], v[216:219], v[44:47], v[156:159]
  buffer_load_dwordx4 v[96:99], v3, s[20:23], s59 offen offset:1024 sc1
  buffer_load_dwordx4 v[100:103], v3, s[20:23], s59 offen offset:1280 sc1
  v_mfma_f32_16x16x32_bf16 v[152:155], v[216:219], v[40:43], v[152:155]
  ds_read_b64_tr_b16 v[210:211], v6 offset:32256
  s_waitcnt lgkmcnt(6)
  v_mfma_f32_16x16x32_bf16 v[164:167], v[220:223], v[44:47], v[164:167]
  ds_read_b64_tr_b16 v[212:213], v6 offset:28704
  ds_read_b64_tr_b16 v[214:215], v6 offset:32288
  v_mfma_f32_16x16x32_bf16 v[160:163], v[220:223], v[40:43], v[160:163]
  ds_read_b64_tr_b16 v[216:217], v6 offset:28736
  s_waitcnt lgkmcnt(5)
  v_mfma_f32_16x16x32_bf16 v[172:175], v[200:203], v[44:47], v[172:175]
  s_waitcnt vmcnt(12)
  ds_read_b64_tr_b16 v[218:219], v6 offset:32320
  v_mfma_f32_16x16x32_bf16 v[168:171], v[200:203], v[40:43], v[168:171]
  v_swap_b32 v50, v52
  v_mfma_f32_16x16x32_bf16 v[196:199], v[204:207], v[44:47], v[196:199]
  v_swap_b32 v51, v53
  v_mfma_f32_16x16x32_bf16 v[192:195], v[204:207], v[40:43], v[192:195]
  ds_read_b64_tr_b16 v[220:221], v6 offset:28768
  s_waitcnt lgkmcnt(3)
  v_mfma_f32_16x16x32_bf16 v[148:151], v[208:211], v[52:55], v[148:151]
  ds_read_b64_tr_b16 v[222:223], v6 offset:32352
  buffer_load_dwordx4 v[104:107], v3, s[20:23], s59 offen offset:1536 sc1
  v_mfma_f32_16x16x32_bf16 v[144:147], v[208:211], v[48:51], v[144:147]
  ds_read_b64_tr_b16 v[200:201], v6 offset:28864
  ds_read_b64_tr_b16 v[202:203], v6 offset:32448
  v_mfma_f32_16x16x32_bf16 v[156:159], v[212:215], v[52:55], v[156:159]
  buffer_load_dwordx4 v[108:111], v3, s[20:23], s59 offen offset:1792 sc1
  ds_read_b64_tr_b16 v[204:205], v6 offset:35840
  v_mfma_f32_16x16x32_bf16 v[152:155], v[212:215], v[48:51], v[152:155]
  ds_read_b64_tr_b16 v[206:207], v6 offset:39424
  s_waitcnt lgkmcnt(6)
  v_mfma_f32_16x16x32_bf16 v[164:167], v[216:219], v[52:55], v[164:167]
  ds_read_b64_tr_b16 v[208:209], v6 offset:35872
  ds_read_b64_tr_b16 v[210:211], v6 offset:39456
  v_mfma_f32_16x16x32_bf16 v[160:163], v[216:219], v[48:51], v[160:163]
  ds_read_b64_tr_b16 v[212:213], v6 offset:35904
  s_waitcnt lgkmcnt(7)
  v_mfma_f32_16x16x32_bf16 v[172:175], v[220:223], v[52:55], v[172:175]
  s_waitcnt vmcnt(12)
  ds_read_b64_tr_b16 v[214:215], v6 offset:39488
  v_mfma_f32_16x16x32_bf16 v[168:171], v[220:223], v[48:51], v[168:171]
  v_swap_b32 v58, v60
  s_waitcnt lgkmcnt(6)
  v_mfma_f32_16x16x32_bf16 v[196:199], v[200:203], v[52:55], v[196:199]
  v_swap_b32 v59, v61
  v_mfma_f32_16x16x32_bf16 v[192:195], v[200:203], v[48:51], v[192:195]
  ds_read_b64_tr_b16 v[216:217], v6 offset:35936
  s_waitcnt lgkmcnt(3)
  v_mfma_f32_16x16x32_bf16 v[148:151], v[204:207], v[60:63], v[148:151]
  ds_read_b64_tr_b16 v[218:219], v6 offset:39520
  buffer_load_dwordx4 v[112:115], v3, s[20:23], s59 offen offset:2048 sc1
  v_mfma_f32_16x16x32_bf16 v[144:147], v[204:207], v[56:59], v[144:147]
  ds_read_b64_tr_b16 v[220:221], v6 offset:36032
  ds_read_b64_tr_b16 v[222:223], v6 offset:39616
  v_mfma_f32_16x16x32_bf16 v[156:159], v[208:211], v[60:63], v[156:159]
  buffer_load_dwordx4 v[116:119], v3, s[20:23], s59 offen offset:2304 sc1
  ds_read_b64_tr_b16 v[200:201], v6 offset:43008
  v_mfma_f32_16x16x32_bf16 v[152:155], v[208:211], v[56:59], v[152:155]
  ds_read_b64_tr_b16 v[202:203], v6 offset:46592
  s_waitcnt lgkmcnt(6)
  v_mfma_f32_16x16x32_bf16 v[164:167], v[212:215], v[60:63], v[164:167]
  ds_read_b64_tr_b16 v[204:205], v6 offset:43040
  ds_read_b64_tr_b16 v[206:207], v6 offset:46624
  v_mfma_f32_16x16x32_bf16 v[160:163], v[212:215], v[56:59], v[160:163]
  ds_read_b64_tr_b16 v[208:209], v6 offset:43072
  s_waitcnt lgkmcnt(7)
  v_mfma_f32_16x16x32_bf16 v[172:175], v[216:219], v[60:63], v[172:175]
  s_waitcnt vmcnt(12)
  ds_read_b64_tr_b16 v[210:211], v6 offset:46656
  v_mfma_f32_16x16x32_bf16 v[168:171], v[216:219], v[56:59], v[168:171]
  v_swap_b32 v66, v68
  s_waitcnt lgkmcnt(6)
  v_mfma_f32_16x16x32_bf16 v[196:199], v[220:223], v[60:63], v[196:199]
  v_swap_b32 v67, v69
  v_mfma_f32_16x16x32_bf16 v[192:195], v[220:223], v[56:59], v[192:195]
  ds_read_b64_tr_b16 v[212:213], v6 offset:43104
  s_waitcnt lgkmcnt(3)
  v_mfma_f32_16x16x32_bf16 v[148:151], v[200:203], v[68:71], v[148:151]
  ds_read_b64_tr_b16 v[214:215], v6 offset:46688
  buffer_load_dwordx4 v[120:123], v3, s[20:23], s59 offen offset:2560 sc1
  v_mfma_f32_16x16x32_bf16 v[144:147], v[200:203], v[64:67], v[144:147]
  ds_read_b64_tr_b16 v[216:217], v6 offset:43200
  ds_read_b64_tr_b16 v[218:219], v6 offset:46784
  v_mfma_f32_16x16x32_bf16 v[156:159], v[204:207], v[68:71], v[156:159]
  buffer_load_dwordx4 v[124:127], v3, s[20:23], s59 offen offset:2816 sc1
  ds_read_b64_tr_b16 v[220:221], v6 offset:50176
  v_mfma_f32_16x16x32_bf16 v[152:155], v[204:207], v[64:67], v[152:155]
  ds_read_b64_tr_b16 v[222:223], v6 offset:53760
  s_waitcnt lgkmcnt(6)
  v_mfma_f32_16x16x32_bf16 v[164:167], v[208:211], v[68:71], v[164:167]
  buffer_load_dwordx4 v[128:131], v3, s[20:23], s59 offen offset:3072 sc1
  buffer_load_dwordx4 v[132:135], v3, s[20:23], s59 offen offset:3328 sc1
  v_mfma_f32_16x16x32_bf16 v[160:163], v[208:211], v[64:67], v[160:163]
  ds_read_b64_tr_b16 v[200:201], v6 offset:50208
  s_waitcnt lgkmcnt(5)
  v_mfma_f32_16x16x32_bf16 v[172:175], v[212:215], v[68:71], v[172:175]
  ds_read_b64_tr_b16 v[202:203], v6 offset:53792
  s_waitcnt vmcnt(14)
  v_mfma_f32_16x16x32_bf16 v[168:171], v[212:215], v[64:67], v[168:171]
  ds_read_b64_tr_b16 v[204:205], v6 offset:50240
  s_waitcnt lgkmcnt(5)
  v_mfma_f32_16x16x32_bf16 v[196:199], v[216:219], v[68:71], v[196:199]
  ds_read_b64_tr_b16 v[206:207], v6 offset:53824
  ds_read_b64_tr_b16 v[208:209], v6 offset:50272
  v_mfma_f32_16x16x32_bf16 v[192:195], v[216:219], v[64:67], v[192:195]
  ds_read_b64_tr_b16 v[210:211], v6 offset:53856
  s_waitcnt lgkmcnt(6)
  v_swap_b32 v74, v76
  v_swap_b32 v75, v77
  s_nop 1
  v_mfma_f32_16x16x32_bf16 v[148:151], v[220:223], v[76:79], v[148:151]
  ds_read_b64_tr_b16 v[212:213], v6 offset:50368
  ds_read_b64_tr_b16 v[214:215], v6 offset:53952
  v_mfma_f32_16x16x32_bf16 v[144:147], v[220:223], v[72:75], v[144:147]
  ds_read_b64_tr_b16 v[216:217], v7 offset:0
  s_waitcnt lgkmcnt(7)
  v_mfma_f32_16x16x32_bf16 v[156:159], v[200:203], v[76:79], v[156:159]
  buffer_load_dwordx4 v[136:139], v3, s[20:23], s59 offen offset:3584 sc1
  buffer_load_dwordx4 v[140:143], v3, s[20:23], s59 offen offset:3840 sc1
  v_mfma_f32_16x16x32_bf16 v[152:155], v[200:203], v[72:75], v[152:155]
  ds_read_b64_tr_b16 v[218:219], v7 offset:3584
  s_waitcnt lgkmcnt(6)
  v_mfma_f32_16x16x32_bf16 v[164:167], v[204:207], v[76:79], v[164:167]
  ds_read_b64_tr_b16 v[220:221], v7 offset:32
  ds_read_b64_tr_b16 v[222:223], v7 offset:3616
  v_mfma_f32_16x16x32_bf16 v[160:163], v[204:207], v[72:75], v[160:163]
  ds_read_b64_tr_b16 v[200:201], v7 offset:64
  s_waitcnt lgkmcnt(5)
  v_mfma_f32_16x16x32_bf16 v[172:175], v[208:211], v[76:79], v[172:175]
  s_waitcnt vmcnt(14)
  ds_read_b64_tr_b16 v[202:203], v7 offset:3648
  v_mfma_f32_16x16x32_bf16 v[168:171], v[208:211], v[72:75], v[168:171]
  v_swap_b32 v82, v84
  v_mfma_f32_16x16x32_bf16 v[196:199], v[212:215], v[76:79], v[196:199]
  v_swap_b32 v83, v85
  v_mfma_f32_16x16x32_bf16 v[192:195], v[212:215], v[72:75], v[192:195]
  ds_read_b64_tr_b16 v[204:205], v7 offset:96
  s_waitcnt lgkmcnt(3)
  v_mfma_f32_16x16x32_bf16 v[148:151], v[216:219], v[84:87], v[148:151]
  ds_read_b64_tr_b16 v[206:207], v7 offset:3680
  ds_read_b64_tr_b16 v[208:209], v7 offset:192
  v_mfma_f32_16x16x32_bf16 v[144:147], v[216:219], v[80:83], v[144:147]
  ds_read_b64_tr_b16 v[210:211], v7 offset:3776
  ds_read_b64_tr_b16 v[212:213], v7 offset:7168
  v_mfma_f32_16x16x32_bf16 v[156:159], v[220:223], v[84:87], v[156:159]
  ds_read_b64_tr_b16 v[214:215], v7 offset:10752
  ds_read_b64_tr_b16 v[216:217], v7 offset:7200
  v_mfma_f32_16x16x32_bf16 v[152:155], v[220:223], v[80:83], v[152:155]
  ds_read_b64_tr_b16 v[218:219], v7 offset:10784
  s_waitcnt lgkmcnt(8)
  v_mfma_f32_16x16x32_bf16 v[164:167], v[200:203], v[84:87], v[164:167]
  s_add_u32 s57, s24, s94
  buffer_load_dwordx4 a[0:3], v8, s[36:39], s57 offen offset:0
  v_mfma_f32_16x16x32_bf16 v[160:163], v[200:203], v[80:83], v[160:163]
  ds_read_b64_tr_b16 v[220:221], v7 offset:7232
  s_waitcnt lgkmcnt(7)
  v_mfma_f32_16x16x32_bf16 v[172:175], v[204:207], v[84:87], v[172:175]
  s_waitcnt vmcnt(13)
  ds_read_b64_tr_b16 v[222:223], v7 offset:10816
  v_mfma_f32_16x16x32_bf16 v[168:171], v[204:207], v[80:83], v[168:171]
  v_swap_b32 v90, v92
  s_waitcnt lgkmcnt(4)
  v_mfma_f32_16x16x32_bf16 v[196:199], v[208:211], v[84:87], v[196:199]
  v_swap_b32 v91, v93
  v_mfma_f32_16x16x32_bf16 v[192:195], v[208:211], v[80:83], v[192:195]
  ds_read_b64_tr_b16 v[200:201], v7 offset:7264
  ds_read_b64_tr_b16 v[202:203], v7 offset:10848
  v_mfma_f32_16x16x32_bf16 v[148:151], v[212:215], v[92:95], v[148:151]
  buffer_load_dwordx4 a[4:7], v8, s[36:39], s57 offen offset:1024
  ds_read_b64_tr_b16 v[204:205], v7 offset:7360
  v_mfma_f32_16x16x32_bf16 v[144:147], v[212:215], v[88:91], v[144:147]
  ds_read_b64_tr_b16 v[206:207], v7 offset:10944
  s_waitcnt lgkmcnt(4)
  v_mfma_f32_16x16x32_bf16 v[156:159], v[216:219], v[92:95], v[156:159]
  buffer_load_dwordx4 a[8:11], v8, s[36:39], s57 offen offset:2048
  ds_read_b64_tr_b16 v[208:209], v7 offset:14336
  v_mfma_f32_16x16x32_bf16 v[152:155], v[216:219], v[88:91], v[152:155]
  ds_read_b64_tr_b16 v[210:211], v7 offset:17920
  ds_read_b64_tr_b16 v[212:213], v7 offset:14368
  v_mfma_f32_16x16x32_bf16 v[164:167], v[220:223], v[92:95], v[164:167]
  ds_read_b64_tr_b16 v[214:215], v7 offset:17952
  ds_read_b64_tr_b16 v[216:217], v7 offset:14400
  v_mfma_f32_16x16x32_bf16 v[160:163], v[220:223], v[88:91], v[160:163]
  ds_read_b64_tr_b16 v[218:219], v7 offset:17984
  s_waitcnt lgkmcnt(8)
  v_mfma_f32_16x16x32_bf16 v[172:175], v[200:203], v[92:95], v[172:175]
  s_waitcnt vmcnt(13)
  ds_read_b64_tr_b16 v[220:221], v7 offset:14432
  v_mfma_f32_16x16x32_bf16 v[168:171], v[200:203], v[88:91], v[168:171]
  v_swap_b32 v98, v100
  s_waitcnt lgkmcnt(7)
  v_mfma_f32_16x16x32_bf16 v[196:199], v[204:207], v[92:95], v[196:199]
  v_swap_b32 v99, v101
  v_mfma_f32_16x16x32_bf16 v[192:195], v[204:207], v[88:91], v[192:195]
  ds_read_b64_tr_b16 v[222:223], v7 offset:18016
  s_waitcnt lgkmcnt(4)
  v_mfma_f32_16x16x32_bf16 v[148:151], v[208:211], v[100:103], v[148:151]
  buffer_load_dwordx4 a[12:15], v8, s[36:39], s57 offen offset:3072
  s_add_u32 s57, s25, s94
  v_mfma_f32_16x16x32_bf16 v[144:147], v[208:211], v[96:99], v[144:147]
  ds_read_b64_tr_b16 v[200:201], v7 offset:14528
  ds_read_b64_tr_b16 v[202:203], v7 offset:18112
  v_mfma_f32_16x16x32_bf16 v[156:159], v[212:215], v[100:103], v[156:159]
  buffer_load_dwordx4 a[16:19], v8, s[36:39], s57 offen offset:0
  ds_read_b64_tr_b16 v[204:205], v7 offset:21504
  v_mfma_f32_16x16x32_bf16 v[152:155], v[212:215], v[96:99], v[152:155]
  ds_read_b64_tr_b16 v[206:207], v7 offset:25088
  s_waitcnt lgkmcnt(6)
  v_mfma_f32_16x16x32_bf16 v[164:167], v[216:219], v[100:103], v[164:167]
  buffer_load_dwordx4 a[20:23], v8, s[36:39], s57 offen offset:1024
  ds_read_b64_tr_b16 v[208:209], v7 offset:21536
  v_mfma_f32_16x16x32_bf16 v[160:163], v[216:219], v[96:99], v[160:163]
  ds_read_b64_tr_b16 v[210:211], v7 offset:25120
  s_waitcnt lgkmcnt(6)
  v_mfma_f32_16x16x32_bf16 v[172:175], v[220:223], v[100:103], v[172:175]
  s_waitcnt vmcnt(14)
  ds_read_b64_tr_b16 v[212:213], v7 offset:21568
  v_mfma_f32_16x16x32_bf16 v[168:171], v[220:223], v[96:99], v[168:171]
  ds_read_b64_tr_b16 v[214:215], v7 offset:25152
  s_waitcnt lgkmcnt(6)
  v_mfma_f32_16x16x32_bf16 v[196:199], v[200:203], v[100:103], v[196:199]
  v_swap_b32 v106, v108
  v_mfma_f32_16x16x32_bf16 v[192:195], v[200:203], v[96:99], v[192:195]
  ds_read_b64_tr_b16 v[216:217], v7 offset:21600
  s_waitcnt lgkmcnt(5)
  v_swap_b32 v107, v109
  s_nop 1
  v_mfma_f32_16x16x32_bf16 v[148:151], v[204:207], v[108:111], v[148:151]
  ds_read_b64_tr_b16 v[218:219], v7 offset:25184
  buffer_load_dwordx4 a[24:27], v8, s[36:39], s57 offen offset:2048
  v_mfma_f32_16x16x32_bf16 v[144:147], v[204:207], v[104:107], v[144:147]
  ds_read_b64_tr_b16 v[220:221], v7 offset:21696
  s_waitcnt lgkmcnt(5)
  v_mfma_f32_16x16x32_bf16 v[156:159], v[208:211], v[108:111], v[156:159]
  ds_read_b64_tr_b16 v[222:223], v7 offset:25280
  buffer_load_dwordx4 a[28:31], v8, s[36:39], s57 offen offset:3072
  v_mfma_f32_16x16x32_bf16 v[152:155], v[208:211], v[104:107], v[152:155]
  ds_read_b64_tr_b16 v[200:201], v7 offset:28672
  s_waitcnt lgkmcnt(5)
  v_mfma_f32_16x16x32_bf16 v[164:167], v[212:215], v[108:111], v[164:167]
  ds_read_b64_tr_b16 v[202:203], v7 offset:32256
  ds_read_b64_tr_b16 v[204:205], v7 offset:28704
  v_mfma_f32_16x16x32_bf16 v[160:163], v[212:215], v[104:107], v[160:163]
  ds_read_b64_tr_b16 v[206:207], v7 offset:32288
  s_waitcnt lgkmcnt(6)
  v_mfma_f32_16x16x32_bf16 v[172:175], v[216:219], v[108:111], v[172:175]
  s_waitcnt vmcnt(14)
  ds_read_b64_tr_b16 v[208:209], v7 offset:28736
  v_mfma_f32_16x16x32_bf16 v[168:171], v[216:219], v[104:107], v[168:171]
  ds_read_b64_tr_b16 v[210:211], v7 offset:32320
  s_waitcnt lgkmcnt(6)
  v_mfma_f32_16x16x32_bf16 v[196:199], v[220:223], v[108:111], v[196:199]
  v_swap_b32 v114, v116
  v_mfma_f32_16x16x32_bf16 v[192:195], v[220:223], v[104:107], v[192:195]
  ds_read_b64_tr_b16 v[212:213], v7 offset:28768
  s_waitcnt lgkmcnt(5)
  v_swap_b32 v115, v117
  s_nop 1
  v_mfma_f32_16x16x32_bf16 v[148:151], v[200:203], v[116:119], v[148:151]
  ds_read_b64_tr_b16 v[214:215], v7 offset:32352
  s_add_u32 s57, s26, s94
  v_mfma_f32_16x16x32_bf16 v[144:147], v[200:203], v[112:115], v[144:147]
  ds_read_b64_tr_b16 v[216:217], v7 offset:28864
  s_waitcnt lgkmcnt(5)
  v_mfma_f32_16x16x32_bf16 v[156:159], v[204:207], v[116:119], v[156:159]
  ds_read_b64_tr_b16 v[218:219], v7 offset:32448
  buffer_load_dwordx4 a[32:35], v8, s[36:39], s57 offen offset:0
  v_mfma_f32_16x16x32_bf16 v[152:155], v[204:207], v[112:115], v[152:155]
  ds_read_b64_tr_b16 v[220:221], v7 offset:35840
  s_waitcnt lgkmcnt(5)
  v_mfma_f32_16x16x32_bf16 v[164:167], v[208:211], v[116:119], v[164:167]
  ds_read_b64_tr_b16 v[222:223], v7 offset:39424
  buffer_load_dwordx4 a[36:39], v8, s[36:39], s57 offen offset:1024
  v_mfma_f32_16x16x32_bf16 v[160:163], v[208:211], v[112:115], v[160:163]
  ds_read_b64_tr_b16 v[200:201], v7 offset:35872
  s_waitcnt lgkmcnt(5)
  v_mfma_f32_16x16x32_bf16 v[172:175], v[212:215], v[116:119], v[172:175]
  ds_read_b64_tr_b16 v[202:203], v7 offset:39456
  buffer_load_dwordx4 a[40:43], v8, s[36:39], s57 offen offset:2048
  v_mfma_f32_16x16x32_bf16 v[168:171], v[212:215], v[112:115], v[168:171]
  ds_read_b64_tr_b16 v[204:205], v7 offset:35904
  s_waitcnt lgkmcnt(5)
  v_mfma_f32_16x16x32_bf16 v[196:199], v[216:219], v[116:119], v[196:199]
  ds_read_b64_tr_b16 v[206:207], v7 offset:39488
  s_waitcnt vmcnt(15)
  v_mfma_f32_16x16x32_bf16 v[192:195], v[216:219], v[112:115], v[192:195]
  ds_read_b64_tr_b16 v[208:209], v7 offset:35936
  s_waitcnt lgkmcnt(5)
  v_swap_b32 v122, v124
  v_swap_b32 v123, v125
  s_nop 1
  v_mfma_f32_16x16x32_bf16 v[148:151], v[220:223], v[124:127], v[148:151]
  ds_read_b64_tr_b16 v[210:211], v7 offset:39520
  buffer_load_dwordx4 a[44:47], v8, s[36:39], s57 offen offset:3072
  v_mfma_f32_16x16x32_bf16 v[144:147], v[220:223], v[120:123], v[144:147]
  ds_read_b64_tr_b16 v[212:213], v7 offset:36032
  s_waitcnt lgkmcnt(5)
  v_mfma_f32_16x16x32_bf16 v[156:159], v[200:203], v[124:127], v[156:159]
  ds_read_b64_tr_b16 v[214:215], v7 offset:39616
  s_add_u32 s57, s27, s94
  v_mfma_f32_16x16x32_bf16 v[152:155], v[200:203], v[120:123], v[152:155]
  ds_read_b64_tr_b16 v[216:217], v7 offset:43008
  s_waitcnt lgkmcnt(5)
  v_mfma_f32_16x16x32_bf16 v[164:167], v[204:207], v[124:127], v[164:167]
  ds_read_b64_tr_b16 v[218:219], v7 offset:46592
  buffer_load_dwordx4 a[48:51], v8, s[36:39], s57 offen offset:0
  v_mfma_f32_16x16x32_bf16 v[160:163], v[204:207], v[120:123], v[160:163]
  ds_read_b64_tr_b16 v[220:221], v7 offset:43040
  s_waitcnt lgkmcnt(5)
  v_mfma_f32_16x16x32_bf16 v[172:175], v[208:211], v[124:127], v[172:175]
  ds_read_b64_tr_b16 v[222:223], v7 offset:46624
  s_waitcnt vmcnt(15)
  v_mfma_f32_16x16x32_bf16 v[168:171], v[208:211], v[120:123], v[168:171]
  ds_read_b64_tr_b16 v[200:201], v7 offset:43072
  s_waitcnt lgkmcnt(5)
  v_mfma_f32_16x16x32_bf16 v[196:199], v[212:215], v[124:127], v[196:199]
  ds_read_b64_tr_b16 v[202:203], v7 offset:46656
  ds_read_b64_tr_b16 v[204:205], v7 offset:43104
  v_mfma_f32_16x16x32_bf16 v[192:195], v[212:215], v[120:123], v[192:195]
  ds_read_b64_tr_b16 v[206:207], v7 offset:46688
  s_waitcnt lgkmcnt(6)
  v_swap_b32 v130, v132
  v_swap_b32 v131, v133
  s_nop 1
  v_mfma_f32_16x16x32_bf16 v[148:151], v[216:219], v[132:135], v[148:151]
  buffer_load_dwordx4 a[52:55], v8, s[36:39], s57 offen offset:1024
  buffer_load_dwordx4 a[56:59], v8, s[36:39], s57 offen offset:2048
  v_mfma_f32_16x16x32_bf16 v[144:147], v[216:219], v[128:131], v[144:147]
  ds_read_b64_tr_b16 v[208:209], v7 offset:43200
  s_waitcnt lgkmcnt(5)
  v_mfma_f32_16x16x32_bf16 v[156:159], v[220:223], v[132:135], v[156:159]
  ds_read_b64_tr_b16 v[210:211], v7 offset:46784
  ds_read_b64_tr_b16 v[212:213], v7 offset:50176
  v_mfma_f32_16x16x32_bf16 v[152:155], v[220:223], v[128:131], v[152:155]
  ds_read_b64_tr_b16 v[214:215], v7 offset:53760
  s_waitcnt lgkmcnt(6)
  v_mfma_f32_16x16x32_bf16 v[164:167], v[200:203], v[132:135], v[164:167]
  buffer_load_dwordx4 a[60:63], v8, s[36:39], s57 offen offset:3072
  ds_read_b64_tr_b16 v[216:217], v7 offset:50208
  v_mfma_f32_16x16x32_bf16 v[160:163], v[200:203], v[128:131], v[160:163]
  ds_read_b64_tr_b16 v[218:219], v7 offset:53792
  s_waitcnt lgkmcnt(6)
  v_mfma_f32_16x16x32_bf16 v[172:175], v[204:207], v[132:135], v[172:175]
  s_waitcnt vmcnt(16)
  ds_read_b64_tr_b16 v[220:221], v7 offset:50240
  v_mfma_f32_16x16x32_bf16 v[168:171], v[204:207], v[128:131], v[168:171]
  ds_read_b64_tr_b16 v[222:223], v7 offset:53824
  s_waitcnt lgkmcnt(6)
  v_mfma_f32_16x16x32_bf16 v[196:199], v[208:211], v[132:135], v[196:199]
  v_swap_b32 v138, v140
  v_mfma_f32_16x16x32_bf16 v[192:195], v[208:211], v[128:131], v[192:195]
  ds_read_b64_tr_b16 v[200:201], v7 offset:50272
  s_waitcnt lgkmcnt(5)
  v_swap_b32 v139, v141
  s_nop 1
  v_mfma_f32_16x16x32_bf16 v[148:151], v[212:215], v[140:143], v[148:151]
  ds_read_b64_tr_b16 v[202:203], v7 offset:53856
  s_add_u32 s57, s24, s95
  v_mfma_f32_16x16x32_bf16 v[144:147], v[212:215], v[136:139], v[144:147]
  ds_read_b64_tr_b16 v[204:205], v7 offset:50368
  s_waitcnt lgkmcnt(5)
  v_mfma_f32_16x16x32_bf16 v[156:159], v[216:219], v[140:143], v[156:159]
  ds_read_b64_tr_b16 v[206:207], v7 offset:53952
  buffer_load_dwordx4 a[64:67], v8, s[36:39], s57 offen offset:0
  v_mfma_f32_16x16x32_bf16 v[152:155], v[216:219], v[136:139], v[152:155]
  ds_read_b64_tr_b16 v[208:209], v6 offset:128
  s_waitcnt lgkmcnt(5)
  v_mfma_f32_16x16x32_bf16 v[164:167], v[220:223], v[140:143], v[164:167]
  ds_read_b64_tr_b16 v[210:211], v6 offset:3712
  buffer_load_dwordx4 a[68:71], v8, s[36:39], s57 offen offset:1024
  v_mfma_f32_16x16x32_bf16 v[160:163], v[220:223], v[136:139], v[160:163]
  ds_read_b64_tr_b16 v[212:213], v6 offset:160
  s_waitcnt lgkmcnt(5)
  v_mfma_f32_16x16x32_bf16 v[172:175], v[200:203], v[140:143], v[172:175]
  ds_read_b64_tr_b16 v[214:215], v6 offset:3744
  ds_read_b64_tr_b16 v[216:217], v6 offset:7296
  v_mfma_f32_16x16x32_bf16 v[168:171], v[200:203], v[136:139], v[168:171]
  ds_read_b64_tr_b16 v[218:219], v6 offset:10880
  s_waitcnt lgkmcnt(6)
  v_mfma_f32_16x16x32_bf16 v[196:199], v[204:207], v[140:143], v[196:199]
  ds_read_b64_tr_b16 v[220:221], v6 offset:7328
  ds_read_b64_tr_b16 v[222:223], v6 offset:10912
  v_mfma_f32_16x16x32_bf16 v[192:195], v[204:207], v[136:139], v[192:195]
  ds_read_b64_tr_b16 v[200:201], v6 offset:14464
  v_pk_mul_f32 v[224:225], v[144:145], v[144:145]
  v_pk_mul_f32 v[226:227], v[146:147], v[146:147]
  v_pk_mul_f32 v[228:229], v[152:153], v[152:153]
  v_pk_mul_f32 v[230:231], v[154:155], v[154:155]
  v_pk_fma_f32 v[224:225], v[224:225], v[240:241], v[240:241] op_sel:[0,1,0] op_sel_hi:[1,1,0]
  v_pk_fma_f32 v[226:227], v[226:227], v[240:241], v[240:241] op_sel:[0,1,0] op_sel_hi:[1,1,0]
  v_pk_fma_f32 v[228:229], v[228:229], v[240:241], v[240:241] op_sel:[0,1,0] op_sel_hi:[1,1,0]
  v_pk_fma_f32 v[230:231], v[230:231], v[240:241], v[240:241] op_sel:[0,1,0] op_sel_hi:[1,1,0]
  v_pk_mul_f32 v[224:225], v[224:225], v[144:145]
  v_pk_mul_f32 v[226:227], v[226:227], v[146:147]
  buffer_load_dwordx4 a[72:75], v8, s[36:39], s57 offen offset:2048
  buffer_load_dwordx4 a[76:79], v8, s[36:39], s57 offen offset:3072
  v_pk_mul_f32 v[228:229], v[228:229], v[152:153]
  v_pk_mul_f32 v[230:231], v[230:231], v[154:155]
  v_exp_f32 v224, v224
  v_exp_f32 v225, v225
  v_exp_f32 v226, v226
  v_exp_f32 v227, v227
  v_exp_f32 v228, v228
  v_exp_f32 v229, v229
  v_exp_f32 v230, v230
  v_exp_f32 v231, v231
  v_pk_add_f32 v[224:225], v[224:225], v[242:243] op_sel:[0,0] op_sel_hi:[1,0]
  v_pk_add_f32 v[226:227], v[226:227], v[242:243] op_sel:[0,0] op_sel_hi:[1,0]
  v_pk_add_f32 v[228:229], v[228:229], v[242:243] op_sel:[0,0] op_sel_hi:[1,0]
  v_pk_add_f32 v[230:231], v[230:231], v[242:243] op_sel:[0,0] op_sel_hi:[1,0]
  v_rcp_f32 v224, v224
  v_rcp_f32 v225, v225
  v_rcp_f32 v226, v226
  v_rcp_f32 v227, v227
  v_rcp_f32 v228, v228
  v_rcp_f32 v229, v229
  v_rcp_f32 v230, v230
  v_rcp_f32 v231, v231
  v_pk_mul_f32 v[224:225], v[224:225], v[144:145]
  v_pk_mul_f32 v[226:227], v[226:227], v[146:147]
  v_pk_mul_f32 v[228:229], v[228:229], v[152:153]
  v_pk_mul_f32 v[230:231], v[230:231], v[154:155]
  v_cvt_pk_bf16_f32 v144, v224, v225
  v_cvt_pk_bf16_f32 v145, v226, v227
  v_cvt_pk_bf16_f32 v146, v228, v229
  v_cvt_pk_bf16_f32 v147, v230, v231
  buffer_store_dwordx4 v[144:147], v14, s[20:23], s64 offen offset:0 sc1
  v_pk_mul_f32 v[224:225], v[148:149], v[148:149]
  v_pk_mul_f32 v[226:227], v[150:151], v[150:151]
  v_pk_mul_f32 v[228:229], v[156:157], v[156:157]
  v_pk_mul_f32 v[230:231], v[158:159], v[158:159]
  s_add_u32 s57, s25, s95
  buffer_load_dwordx4 a[80:83], v8, s[36:39], s57 offen offset:0
  buffer_load_dwordx4 a[84:87], v8, s[36:39], s57 offen offset:1024
  v_pk_fma_f32 v[224:225], v[224:225], v[240:241], v[240:241] op_sel:[0,1,0] op_sel_hi:[1,1,0]
  v_pk_fma_f32 v[226:227], v[226:227], v[240:241], v[240:241] op_sel:[0,1,0] op_sel_hi:[1,1,0]
  v_pk_fma_f32 v[228:229], v[228:229], v[240:241], v[240:241] op_sel:[0,1,0] op_sel_hi:[1,1,0]
  v_pk_fma_f32 v[230:231], v[230:231], v[240:241], v[240:241] op_sel:[0,1,0] op_sel_hi:[1,1,0]
  v_pk_mul_f32 v[224:225], v[224:225], v[148:149]
  v_pk_mul_f32 v[226:227], v[226:227], v[150:151]
  v_pk_mul_f32 v[228:229], v[228:229], v[156:157]
  v_pk_mul_f32 v[230:231], v[230:231], v[158:159]
  v_exp_f32 v224, v224
  v_exp_f32 v225, v225
  v_exp_f32 v226, v226
  v_exp_f32 v227, v227
  v_exp_f32 v228, v228
  v_exp_f32 v229, v229
  v_exp_f32 v230, v230
  v_exp_f32 v231, v231
  v_pk_add_f32 v[224:225], v[224:225], v[242:243] op_sel:[0,0] op_sel_hi:[1,0]
  v_pk_add_f32 v[226:227], v[226:227], v[242:243] op_sel:[0,0] op_sel_hi:[1,0]
  v_pk_add_f32 v[228:229], v[228:229], v[242:243] op_sel:[0,0] op_sel_hi:[1,0]
  v_pk_add_f32 v[230:231], v[230:231], v[242:243] op_sel:[0,0] op_sel_hi:[1,0]
  v_rcp_f32 v224, v224
  v_rcp_f32 v225, v225
  v_rcp_f32 v226, v226
  v_rcp_f32 v227, v227
  v_rcp_f32 v228, v228
  v_rcp_f32 v229, v229
  v_rcp_f32 v230, v230
  v_rcp_f32 v231, v231
  v_pk_mul_f32 v[224:225], v[224:225], v[148:149]
  v_pk_mul_f32 v[226:227], v[226:227], v[150:151]
  v_pk_mul_f32 v[228:229], v[228:229], v[156:157]
  v_pk_mul_f32 v[230:231], v[230:231], v[158:159]
  v_cvt_pk_bf16_f32 v148, v224, v225
  v_cvt_pk_bf16_f32 v149, v226, v227
  v_cvt_pk_bf16_f32 v150, v228, v229
  v_cvt_pk_bf16_f32 v151, v230, v231
  buffer_store_dwordx4 v[148:151], v14, s[20:23], s64 offen offset:1024 sc1
  v_pk_mul_f32 v[224:225], v[160:161], v[160:161]
  v_pk_mul_f32 v[226:227], v[162:163], v[162:163]
  v_pk_mul_f32 v[228:229], v[168:169], v[168:169]
  v_pk_mul_f32 v[230:231], v[170:171], v[170:171]
  v_pk_fma_f32 v[224:225], v[224:225], v[240:241], v[240:241] op_sel:[0,1,0] op_sel_hi:[1,1,0]
  v_pk_fma_f32 v[226:227], v[226:227], v[240:241], v[240:241] op_sel:[0,1,0] op_sel_hi:[1,1,0]
  v_pk_fma_f32 v[228:229], v[228:229], v[240:241], v[240:241] op_sel:[0,1,0] op_sel_hi:[1,1,0]
  v_pk_fma_f32 v[230:231], v[230:231], v[240:241], v[240:241] op_sel:[0,1,0] op_sel_hi:[1,1,0]
  v_pk_mul_f32 v[224:225], v[224:225], v[160:161]
  v_pk_mul_f32 v[226:227], v[226:227], v[162:163]
  buffer_load_dwordx4 a[88:91], v8, s[36:39], s57 offen offset:2048
  buffer_load_dwordx4 a[92:95], v8, s[36:39], s57 offen offset:3072
  v_pk_mul_f32 v[228:229], v[228:229], v[168:169]
  v_pk_mul_f32 v[230:231], v[230:231], v[170:171]
  v_exp_f32 v224, v224
  v_exp_f32 v225, v225
  v_exp_f32 v226, v226
  v_exp_f32 v227, v227
  v_exp_f32 v228, v228
  v_exp_f32 v229, v229
  v_exp_f32 v230, v230
  v_exp_f32 v231, v231
  v_pk_add_f32 v[224:225], v[224:225], v[242:243] op_sel:[0,0] op_sel_hi:[1,0]
  v_pk_add_f32 v[226:227], v[226:227], v[242:243] op_sel:[0,0] op_sel_hi:[1,0]
  v_pk_add_f32 v[228:229], v[228:229], v[242:243] op_sel:[0,0] op_sel_hi:[1,0]
  v_pk_add_f32 v[230:231], v[230:231], v[242:243] op_sel:[0,0] op_sel_hi:[1,0]
  v_rcp_f32 v224, v224
  s_waitcnt lgkmcnt(3)
  s_waitcnt vmcnt(25)
  ds_write_b128 v250, a[0:3] offset:0
  s_waitcnt vmcnt(24)
  ds_write_b128 v250, a[4:7] offset:128
  s_waitcnt vmcnt(23)
  ds_write_b128 v251, a[8:11] offset:256
  s_waitcnt vmcnt(22)
  ds_write_b128 v251, a[12:15] offset:384
  ds_read_b64_tr_b16 a[0:1], v252 offset:0
  ds_read_b64_tr_b16 a[2:3], v252 offset:2048
  ds_read_b64_tr_b16 a[4:5], v253 offset:0
  ds_read_b64_tr_b16 a[6:7], v253 offset:2048
  ds_read_b64_tr_b16 a[8:9], v254 offset:0
  ds_read_b64_tr_b16 a[10:11], v254 offset:2048
  ds_read_b64_tr_b16 a[12:13], v255 offset:0
  ds_read_b64_tr_b16 a[14:15], v255 offset:2048
  v_rcp_f32 v225, v225
  v_rcp_f32 v226, v226
  v_rcp_f32 v227, v227
  v_rcp_f32 v228, v228
  v_rcp_f32 v229, v229
  v_rcp_f32 v230, v230
  v_rcp_f32 v231, v231
  v_pk_mul_f32 v[224:225], v[224:225], v[160:161]
  v_pk_mul_f32 v[226:227], v[226:227], v[162:163]
  v_pk_mul_f32 v[228:229], v[228:229], v[168:169]
  v_pk_mul_f32 v[230:231], v[230:231], v[170:171]
  v_cvt_pk_bf16_f32 v160, v224, v225
  v_cvt_pk_bf16_f32 v161, v226, v227
  v_cvt_pk_bf16_f32 v162, v228, v229
  v_cvt_pk_bf16_f32 v163, v230, v231
  buffer_store_dwordx4 v[160:163], v0, s[20:23], s64 offen offset:0 sc1
  v_pk_mul_f32 v[224:225], v[164:165], v[164:165]
  v_pk_mul_f32 v[226:227], v[166:167], v[166:167]
  v_pk_mul_f32 v[228:229], v[172:173], v[172:173]
  v_pk_mul_f32 v[230:231], v[174:175], v[174:175]
  s_add_u32 s57, s26, s95
  buffer_load_dwordx4 a[96:99], v8, s[36:39], s57 offen offset:0
  buffer_load_dwordx4 a[100:103], v8, s[36:39], s57 offen offset:1024
  v_pk_fma_f32 v[224:225], v[224:225], v[240:241], v[240:241] op_sel:[0,1,0] op_sel_hi:[1,1,0]
  v_pk_fma_f32 v[226:227], v[226:227], v[240:241], v[240:241] op_sel:[0,1,0] op_sel_hi:[1,1,0]
  v_pk_fma_f32 v[228:229], v[228:229], v[240:241], v[240:241] op_sel:[0,1,0] op_sel_hi:[1,1,0]
  v_pk_fma_f32 v[230:231], v[230:231], v[240:241], v[240:241] op_sel:[0,1,0] op_sel_hi:[1,1,0]
  v_pk_mul_f32 v[224:225], v[224:225], v[164:165]
  v_pk_mul_f32 v[226:227], v[226:227], v[166:167]
  v_pk_mul_f32 v[228:229], v[228:229], v[172:173]
  v_pk_mul_f32 v[230:231], v[230:231], v[174:175]
  v_exp_f32 v224, v224
  v_exp_f32 v225, v225
  v_exp_f32 v226, v226
  v_exp_f32 v227, v227
  v_exp_f32 v228, v228
  v_exp_f32 v229, v229
  v_exp_f32 v230, v230
  v_exp_f32 v231, v231
  v_pk_add_f32 v[224:225], v[224:225], v[242:243] op_sel:[0,0] op_sel_hi:[1,0]
  v_pk_add_f32 v[226:227], v[226:227], v[242:243] op_sel:[0,0] op_sel_hi:[1,0]
  v_pk_add_f32 v[228:229], v[228:229], v[242:243] op_sel:[0,0] op_sel_hi:[1,0]
  v_pk_add_f32 v[230:231], v[230:231], v[242:243] op_sel:[0,0] op_sel_hi:[1,0]
  v_rcp_f32 v224, v224
  v_rcp_f32 v225, v225
  v_rcp_f32 v226, v226
  v_rcp_f32 v227, v227
  v_rcp_f32 v228, v228
  v_rcp_f32 v229, v229
  v_rcp_f32 v230, v230
  v_rcp_f32 v231, v231
  v_pk_mul_f32 v[224:225], v[224:225], v[164:165]
  v_pk_mul_f32 v[226:227], v[226:227], v[166:167]
  v_pk_mul_f32 v[228:229], v[228:229], v[172:173]
  v_pk_mul_f32 v[230:231], v[230:231], v[174:175]
  v_cvt_pk_bf16_f32 v164, v224, v225
  v_cvt_pk_bf16_f32 v165, v226, v227
  v_cvt_pk_bf16_f32 v166, v228, v229
  v_cvt_pk_bf16_f32 v167, v230, v231
  buffer_store_dwordx4 v[164:167], v0, s[20:23], s64 offen offset:1024 sc1
  v_pk_mul_f32 v[224:225], v[192:193], v[192:193]
  v_pk_mul_f32 v[226:227], v[194:195], v[194:195]
  v_pk_mul_f32 v[228:229], v[196:197], v[196:197]
  v_pk_mul_f32 v[230:231], v[198:199], v[198:199]
  v_pk_fma_f32 v[224:225], v[224:225], v[240:241], v[240:241] op_sel:[0,1,0] op_sel_hi:[1,1,0]
  v_pk_fma_f32 v[226:227], v[226:227], v[240:241], v[240:241] op_sel:[0,1,0] op_sel_hi:[1,1,0]
  v_pk_fma_f32 v[228:229], v[228:229], v[240:241], v[240:241] op_sel:[0,1,0] op_sel_hi:[1,1,0]
  v_pk_fma_f32 v[230:231], v[230:231], v[240:241], v[240:241] op_sel:[0,1,0] op_sel_hi:[1,1,0]
  v_pk_mul_f32 v[224:225], v[224:225], v[192:193]
  v_pk_mul_f32 v[226:227], v[226:227], v[194:195]
  v_pk_mul_f32 v[228:229], v[228:229], v[196:197]
  v_pk_mul_f32 v[230:231], v[230:231], v[198:199]
  v_exp_f32 v224, v224
  v_exp_f32 v225, v225
  v_exp_f32 v226, v226
  v_exp_f32 v227, v227
  v_exp_f32 v228, v228
  v_exp_f32 v229, v229
  v_exp_f32 v230, v230
  v_exp_f32 v231, v231
  v_pk_add_f32 v[224:225], v[224:225], v[242:243] op_sel:[0,0] op_sel_hi:[1,0]
  v_pk_add_f32 v[226:227], v[226:227], v[242:243] op_sel:[0,0] op_sel_hi:[1,0]
  v_pk_add_f32 v[228:229], v[228:229], v[242:243] op_sel:[0,0] op_sel_hi:[1,0]
  v_pk_add_f32 v[230:231], v[230:231], v[242:243] op_sel:[0,0] op_sel_hi:[1,0]
  v_rcp_f32 v224, v224
  v_rcp_f32 v225, v225
  v_rcp_f32 v226, v226
  v_rcp_f32 v227, v227
  v_rcp_f32 v228, v228
  v_rcp_f32 v229, v229
  s_waitcnt vmcnt(6)
  v_mov_b32 v5, 1
  s_mov_b64 exec, 1
  buffer_store_dword v5, v4, s[20:23], s65 offen
  s_mov_b64 exec, -1
  v_rcp_f32 v230, v230
  v_rcp_f32 v231, v231
  v_pk_mul_f32 v[224:225], v[224:225], v[192:193]
  v_pk_mul_f32 v[226:227], v[226:227], v[194:195]
  v_pk_mul_f32 v[228:229], v[228:229], v[196:197]
  v_pk_mul_f32 v[230:231], v[230:231], v[198:199]
  v_cvt_pk_bf16_f32 v192, v224, v225
  v_cvt_pk_bf16_f32 v193, v226, v227
  v_cvt_pk_bf16_f32 v194, v228, v229
  v_cvt_pk_bf16_f32 v195, v230, v231
  buffer_store_dwordx4 v[192:195], v244, s[20:23], s64 offen offset:0 sc1
  v_mfma_f32_16x16x32_bf16 v[180:183], v[208:211], v[20:23], v[176:179]
  buffer_load_dwordx4 a[104:107], v8, s[36:39], s57 offen offset:2048
  ds_read_b64_tr_b16 v[202:203], v6 offset:18048
  v_mfma_f32_16x16x32_bf16 v[176:179], v[208:211], v[16:19], v[176:179]
  ds_read_b64_tr_b16 v[204:205], v6 offset:14496
  ds_read_b64_tr_b16 v[206:207], v6 offset:18080
  v_mfma_f32_16x16x32_bf16 v[188:191], v[212:215], v[20:23], v[184:187]
  ds_read_b64_tr_b16 v[208:209], v6 offset:21632
  ds_read_b64_tr_b16 v[210:211], v6 offset:25216
  v_mfma_f32_16x16x32_bf16 v[184:187], v[212:215], v[16:19], v[184:187]
  ds_read_b64_tr_b16 v[212:213], v6 offset:21664
  ds_read_b64_tr_b16 v[214:215], v6 offset:25248
  v_mfma_f32_16x16x32_bf16 v[180:183], v[216:219], v[28:31], v[180:183]
  buffer_load_dwordx4 a[108:111], v8, s[36:39], s57 offen offset:3072
  v_mfma_f32_16x16x32_bf16 v[176:179], v[216:219], v[24:27], v[176:179]
  ds_read_b64_tr_b16 v[216:217], v6 offset:28800
  s_waitcnt lgkmcnt(7)
  v_mfma_f32_16x16x32_bf16 v[188:191], v[220:223], v[28:31], v[188:191]
  ds_read_b64_tr_b16 v[218:219], v6 offset:32384
  v_mfma_f32_16x16x32_bf16 v[184:187], v[220:223], v[24:27], v[184:187]
  ds_read_b64_tr_b16 v[220:221], v6 offset:28832
  ds_read_b64_tr_b16 v[222:223], v6 offset:32416
  v_mfma_f32_16x16x32_bf16 v[180:183], v[200:203], v[36:39], v[180:183]
  s_add_u32 s57, s27, s95
  buffer_load_dwordx4 a[112:115], v8, s[36:39], s57 offen offset:0
  v_mfma_f32_16x16x32_bf16 v[176:179], v[200:203], v[32:35], v[176:179]
  ds_read_b64_tr_b16 v[200:201], v6 offset:35968
  s_waitcnt lgkmcnt(5)
  v_mfma_f32_16x16x32_bf16 v[188:191], v[204:207], v[36:39], v[188:191]
  ds_write_b128 v250, a[16:19] offset:17408
  v_mfma_f32_16x16x32_bf16 v[184:187], v[204:207], v[32:35], v[184:187]
  ds_write_b128 v250, a[20:23] offset:17536
  v_mfma_f32_16x16x32_bf16 v[180:183], v[208:211], v[44:47], v[180:183]
  ds_write_b128 v251, a[24:27] offset:17664
  v_mfma_f32_16x16x32_bf16 v[176:179], v[208:211], v[40:43], v[176:179]
  ds_read_b64_tr_b16 v[202:203], v6 offset:39552
  ds_write_b128 v251, a[28:31] offset:17792
  v_mfma_f32_16x16x32_bf16 v[188:191], v[212:215], v[44:47], v[188:191]
  ds_read_b64_tr_b16 a[16:17], v252 offset:17408
  ds_read_b64_tr_b16 a[18:19], v252 offset:19456
  v_mfma_f32_16x16x32_bf16 v[184:187], v[212:215], v[40:43], v[184:187]
  ds_read_b64_tr_b16 v[204:205], v6 offset:36000
  s_waitcnt lgkmcnt(9)
  v_mfma_f32_16x16x32_bf16 v[180:183], v[216:219], v[52:55], v[180:183]
  ds_read_b64_tr_b16 v[206:207], v6 offset:39584
  ds_read_b64_tr_b16 a[20:21], v253 offset:17408
  v_mfma_f32_16x16x32_bf16 v[176:179], v[216:219], v[48:51], v[176:179]
  ds_read_b64_tr_b16 v[208:209], v6 offset:43136
  ds_read_b64_tr_b16 v[210:211], v6 offset:46720
  v_mfma_f32_16x16x32_bf16 v[188:191], v[220:223], v[52:55], v[188:191]
  ds_read_b64_tr_b16 a[22:23], v253 offset:19456
  ds_read_b64_tr_b16 a[24:25], v254 offset:17408
  v_mfma_f32_16x16x32_bf16 v[184:187], v[220:223], v[48:51], v[184:187]
  ds_read_b64_tr_b16 v[212:213], v6 offset:43168
  s_waitcnt lgkmcnt(11)
  v_mfma_f32_16x16x32_bf16 v[180:183], v[200:203], v[60:63], v[180:183]
  ds_read_b64_tr_b16 v[214:215], v6 offset:46752
  ds_read_b64_tr_b16 a[26:27], v254 offset:19456
  v_mfma_f32_16x16x32_bf16 v[176:179], v[200:203], v[56:59], v[176:179]
  ds_read_b64_tr_b16 v[216:217], v6 offset:50304
  s_waitcnt lgkmcnt(9)
  v_mfma_f32_16x16x32_bf16 v[188:191], v[204:207], v[60:63], v[188:191]
  ds_read_b64_tr_b16 v[218:219], v6 offset:53888
  ds_read_b64_tr_b16 a[28:29], v255 offset:17408
  v_mfma_f32_16x16x32_bf16 v[184:187], v[204:207], v[56:59], v[184:187]
  ds_read_b64_tr_b16 v[220:221], v6 offset:50336
  s_waitcnt lgkmcnt(9)
  v_mfma_f32_16x16x32_bf16 v[180:183], v[208:211], v[68:71], v[180:183]
  ds_read_b64_tr_b16 v[222:223], v6 offset:53920
  ds_read_b64_tr_b16 a[30:31], v255 offset:19456
  v_mfma_f32_16x16x32_bf16 v[176:179], v[208:211], v[64:67], v[176:179]
  ds_read_b64_tr_b16 v[200:201], v7 offset:128
  s_waitcnt lgkmcnt(8)
  v_mfma_f32_16x16x32_bf16 v[188:191], v[212:215], v[68:71], v[188:191]
  ds_read_b64_tr_b16 v[202:203], v7 offset:3712
  buffer_load_dwordx4 a[116:119], v8, s[36:39], s57 offen offset:1024
  v_mfma_f32_16x16x32_bf16 v[184:187], v[212:215], v[64:67], v[184:187]
  ds_read_b64_tr_b16 v[204:205], v7 offset:160
  s_waitcnt lgkmcnt(7)
  v_mfma_f32_16x16x32_bf16 v[180:183], v[216:219], v[76:79], v[180:183]
  ds_read_b64_tr_b16 v[206:207], v7 offset:3744
  buffer_load_dwordx4 a[120:123], v8, s[36:39], s57 offen offset:2048
  v_mfma_f32_16x16x32_bf16 v[176:179], v[216:219], v[72:75], v[176:179]
  ds_read_b64_tr_b16 v[208:209], v7 offset:7296
  s_waitcnt lgkmcnt(6)
  s_waitcnt vmcnt(5)
  v_mov_b32 v5, 3
  s_mov_b64 exec, 1
  buffer_store_dword v5, v4, s[20:23], s65 offen
  s_mov_b64 exec, -1
  v_mfma_f32_16x16x32_bf16 v[188:191], v[220:223], v[76:79], v[188:191]
  ds_read_b64_tr_b16 v[210:211], v7 offset:10880
  buffer_load_dwordx4 a[124:127], v8, s[36:39], s57 offen offset:3072
  v_mfma_f32_16x16x32_bf16 v[184:187], v[220:223], v[72:75], v[184:187]
  ds_read_b64_tr_b16 v[212:213], v7 offset:7328
  s_waitcnt lgkmcnt(5)
  v_mfma_f32_16x16x32_bf16 v[180:183], v[200:203], v[84:87], v[180:183]
  ds_read_b64_tr_b16 v[214:215], v7 offset:10912
  s_min_u32 s57, s24, s25
  v_mfma_f32_16x16x32_bf16 v[176:179], v[200:203], v[80:83], v[176:179]
  ds_read_b64_tr_b16 v[216:217], v7 offset:14464
  s_waitcnt lgkmcnt(5)
  v_mfma_f32_16x16x32_bf16 v[188:191], v[204:207], v[84:87], v[188:191]
  ds_read_b64_tr_b16 v[218:219], v7 offset:18048
  buffer_load_dwordx4 a[192:195], v9, s[36:39], s57 offen offset:0
  v_mfma_f32_16x16x32_bf16 v[184:187], v[204:207], v[80:83], v[184:187]
  ds_read_b64_tr_b16 v[220:221], v7 offset:14496
  s_waitcnt lgkmcnt(5)
  v_mfma_f32_16x16x32_bf16 v[180:183], v[208:211], v[92:95], v[180:183]
  ds_read_b64_tr_b16 v[222:223], v7 offset:18080
  buffer_load_dwordx4 a[196:199], v9, s[36:39], s57 offen offset:1024
  v_mfma_f32_16x16x32_bf16 v[176:179], v[208:211], v[88:91], v[176:179]
  ds_read_b64_tr_b16 v[200:201], v7 offset:21632
  s_waitcnt lgkmcnt(5)
  v_mfma_f32_16x16x32_bf16 v[188:191], v[212:215], v[92:95], v[188:191]
  ds_read_b64_tr_b16 v[202:203], v7 offset:25216
  buffer_load_dwordx4 a[200:203], v9, s[36:39], s57 offen offset:2048
  v_mfma_f32_16x16x32_bf16 v[184:187], v[212:215], v[88:91], v[184:187]
  ds_read_b64_tr_b16 v[204:205], v7 offset:21664
  s_waitcnt lgkmcnt(5)
  buffer_load_dword v13, v15, s[20:23], s17 offen sc1
  v_mfma_f32_16x16x32_bf16 v[180:183], v[216:219], v[100:103], v[180:183]
  ds_read_b64_tr_b16 v[206:207], v7 offset:25248
  ds_write_b128 v250, a[32:35] offset:0
  v_mfma_f32_16x16x32_bf16 v[176:179], v[216:219], v[96:99], v[176:179]
  ds_read_b64_tr_b16 v[208:209], v7 offset:28800
  s_waitcnt lgkmcnt(6)
  v_mfma_f32_16x16x32_bf16 v[188:191], v[220:223], v[100:103], v[188:191]
  ds_read_b64_tr_b16 v[210:211], v7 offset:32384
  ds_write_b128 v250, a[36:39] offset:128
  v_mfma_f32_16x16x32_bf16 v[184:187], v[220:223], v[96:99], v[184:187]
  ds_read_b64_tr_b16 v[212:213], v7 offset:28832
  s_waitcnt lgkmcnt(7)
  v_mfma_f32_16x16x32_bf16 v[180:183], v[200:203], v[108:111], v[180:183]
  ds_read_b64_tr_b16 v[214:215], v7 offset:32416
  ds_write_b128 v251, a[40:43] offset:256
  v_mfma_f32_16x16x32_bf16 v[176:179], v[200:203], v[104:107], v[176:179]
  ds_read_b64_tr_b16 v[216:217], v7 offset:35968
  s_waitcnt lgkmcnt(8)
  v_mfma_f32_16x16x32_bf16 v[188:191], v[204:207], v[108:111], v[188:191]
  ds_read_b64_tr_b16 v[218:219], v7 offset:39552
  ds_write_b128 v251, a[44:47] offset:384
  v_mfma_f32_16x16x32_bf16 v[184:187], v[204:207], v[104:107], v[184:187]
  ds_read_b64_tr_b16 v[220:221], v7 offset:36000
  s_waitcnt lgkmcnt(8)
  v_mfma_f32_16x16x32_bf16 v[180:183], v[208:211], v[116:119], v[180:183]
  ds_read_b64_tr_b16 v[222:223], v7 offset:39584
  ds_read_b64_tr_b16 a[32:33], v252 offset:0
  v_mfma_f32_16x16x32_bf16 v[176:179], v[208:211], v[112:115], v[176:179]
  ds_read_b64_tr_b16 v[200:201], v7 offset:43136
  s_waitcnt lgkmcnt(8)
  buffer_load_dword v248, v247, s[20:23], s66 offen sc1
  v_mfma_f32_16x16x32_bf16 v[188:191], v[212:215], v[116:119], v[188:191]
  ds_read_b64_tr_b16 v[202:203], v7 offset:46720
  ds_read_b64_tr_b16 a[34:35], v252 offset:2048
  v_mfma_f32_16x16x32_bf16 v[184:187], v[212:215], v[112:115], v[184:187]
  ds_read_b64_tr_b16 v[204:205], v7 offset:43168
  s_waitcnt lgkmcnt(8)
  v_mfma_f32_16x16x32_bf16 v[180:183], v[216:219], v[124:127], v[180:183]
  ds_read_b64_tr_b16 v[206:207], v7 offset:46752
  ds_read_b64_tr_b16 a[36:37], v253 offset:0
  v_mfma_f32_16x16x32_bf16 v[176:179], v[216:219], v[120:123], v[176:179]
  ds_read_b64_tr_b16 v[208:209], v7 offset:50304
  s_waitcnt lgkmcnt(8)
  v_mfma_f32_16x16x32_bf16 v[188:191], v[220:223], v[124:127], v[188:191]
  ds_read_b64_tr_b16 v[210:211], v7 offset:53888
  ds_read_b64_tr_b16 a[38:39], v253 offset:2048
  v_mfma_f32_16x16x32_bf16 v[184:187], v[220:223], v[120:123], v[184:187]
  ds_read_b64_tr_b16 v[212:213], v7 offset:50336
  s_waitcnt lgkmcnt(8)
  v_mfma_f32_16x16x32_bf16 v[180:183], v[200:203], v[132:135], v[180:183]
  ds_read_b64_tr_b16 v[214:215], v7 offset:53920
  ds_read_b64_tr_b16 a[40:41], v254 offset:0
  v_mfma_f32_16x16x32_bf16 v[176:179], v[200:203], v[128:131], v[176:179]
  ds_read_b64_tr_b16 a[42:43], v254 offset:2048
  s_waitcnt lgkmcnt(8)
  v_mfma_f32_16x16x32_bf16 v[188:191], v[204:207], v[132:135], v[188:191]
  ds_read_b64_tr_b16 a[44:45], v255 offset:0
  ds_read_b64_tr_b16 a[46:47], v255 offset:2048
  v_mfma_f32_16x16x32_bf16 v[184:187], v[204:207], v[128:131], v[184:187]
  buffer_load_dwordx4 a[204:207], v9, s[36:39], s57 offen offset:3072
  s_waitcnt lgkmcnt(7)
  v_mfma_f32_16x16x32_bf16 v[180:183], v[208:211], v[140:143], v[180:183]
  s_min_u32 s57, s26, s27
  buffer_load_dwordx4 a[208:211], v9, s[36:39], s57 offen offset:0
  v_mfma_f32_16x16x32_bf16 v[176:179], v[208:211], v[136:139], v[176:179]
  buffer_load_dwordx4 a[212:215], v9, s[36:39], s57 offen offset:1024
  s_waitcnt lgkmcnt(4)
  v_mfma_f32_16x16x32_bf16 v[188:191], v[212:215], v[140:143], v[188:191]
  v_mfma_f32_16x16x32_bf16 v[184:187], v[212:215], v[136:139], v[184:187]
  s_waitcnt vmcnt(4)
  v_cmp_gt_u32 vcc, 1, v13
  s_nop 4
  s_cbranch_vccz f_g2p1_ok
  s_mov_b32 s69, 0
f_g2p1:
  buffer_load_dword v13, v15, s[20:23], s17 offen offset:0 sc1
  s_add_u32 s69, s69, 1
  s_waitcnt vmcnt(0)
  v_cmp_gt_u32 vcc, 1, v13
  s_cmp_ge_u32 s69, 4000
  s_cbranch_scc1 f_g2p1_out
  s_nop 3
  s_cbranch_vccnz f_g2p1
f_g2p1_out:
f_g2p1_ok:
  v_pk_mul_f32 v[224:225], v[176:177], v[176:177]
  s_waitcnt vmcnt(3)
  v_cmp_gt_u32 vcc, 1, v248
  s_nop 4
  s_cbranch_vccz f_al4_ok
  s_mov_b32 s69, 0
f_al4:
  buffer_load_dword v248, v247, s[20:23], s66 offen offset:0 sc1
  s_add_u32 s69, s69, 1
  s_waitcnt vmcnt(0)
  v_cmp_gt_u32 vcc, 1, v248
  s_cmp_ge_u32 s69, 4000
  s_cbranch_scc1 f_al4_out
  s_nop 3
  s_cbranch_vccnz f_al4
f_al4_out:
f_al4_ok:
  buffer_load_dwordx4 a[224:227], v14, s[20:23], s8 offen offset:0 sc1
  v_pk_mul_f32 v[226:227], v[178:179], v[178:179]
  v_pk_mul_f32 v[228:229], v[184:185], v[184:185]
  buffer_load_dwordx4 a[228:231], v14, s[20:23], s8 offen offset:1024 sc1
  v_pk_mul_f32 v[230:231], v[186:187], v[186:187]
  v_pk_fma_f32 v[224:225], v[224:225], v[240:241], v[240:241] op_sel:[0,1,0] op_sel_hi:[1,1,0]
  buffer_load_dwordx4 a[232:235], v14, s[20:23], s12 offen offset:0 sc1
  v_pk_fma_f32 v[226:227], v[226:227], v[240:241], v[240:241] op_sel:[0,1,0] op_sel_hi:[1,1,0]
  v_pk_fma_f32 v[228:229], v[228:229], v[240:241], v[240:241] op_sel:[0,1,0] op_sel_hi:[1,1,0]
  buffer_load_dwordx4 a[236:239], v14, s[20:23], s12 offen offset:1024 sc1
  v_pk_fma_f32 v[230:231], v[230:231], v[240:241], v[240:241] op_sel:[0,1,0] op_sel_hi:[1,1,0]
  v_pk_mul_f32 v[224:225], v[224:225], v[176:177]
  buffer_load_dwordx4 a[240:243], v14, s[20:23], s9 offen offset:0 sc1
  v_pk_mul_f32 v[226:227], v[226:227], v[178:179]
  v_pk_mul_f32 v[228:229], v[228:229], v[184:185]
  buffer_load_dwordx4 a[244:247], v14, s[20:23], s9 offen offset:1024 sc1
  v_pk_mul_f32 v[230:231], v[230:231], v[186:187]
  v_exp_f32 v224, v224
  buffer_load_dwordx4 a[248:251], v14, s[20:23], s13 offen offset:0 sc1
  v_exp_f32 v225, v225
  v_exp_f32 v226, v226
  buffer_load_dwordx4 a[252:255], v14, s[20:23], s13 offen offset:1024 sc1
  v_exp_f32 v227, v227
  v_exp_f32 v228, v228
  buffer_load_dwordx4 v[144:147], v14, s[20:23], s10 offen offset:0 sc1
  v_exp_f32 v229, v229
  v_exp_f32 v230, v230
  buffer_load_dwordx4 v[148:151], v14, s[20:23], s10 offen offset:1024 sc1
  v_exp_f32 v231, v231
  v_pk_add_f32 v[224:225], v[224:225], v[242:243] op_sel:[0,0] op_sel_hi:[1,0]
  buffer_load_dwordx4 v[152:155], v14, s[20:23], s14 offen offset:0 sc1
  v_pk_add_f32 v[226:227], v[226:227], v[242:243] op_sel:[0,0] op_sel_hi:[1,0]
  v_pk_add_f32 v[228:229], v[228:229], v[242:243] op_sel:[0,0] op_sel_hi:[1,0]
  buffer_load_dwordx4 v[156:159], v14, s[20:23], s14 offen offset:1024 sc1
  v_pk_add_f32 v[230:231], v[230:231], v[242:243] op_sel:[0,0] op_sel_hi:[1,0]
  v_rcp_f32 v224, v224
  buffer_load_dwordx4 v[160:163], v14, s[20:23], s11 offen offset:0 sc1
  v_rcp_f32 v225, v225
  v_rcp_f32 v226, v226
  buffer_load_dwordx4 v[164:167], v14, s[20:23], s11 offen offset:1024 sc1
  v_rcp_f32 v227, v227
  v_rcp_f32 v228, v228
  buffer_load_dwordx4 v[168:171], v14, s[20:23], s15 offen offset:0 sc1
  v_rcp_f32 v229, v229
  buffer_load_dword v13, v15, s[20:23], s17 offen sc1
  v_rcp_f32 v230, v230
  buffer_load_dwordx4 v[172:175], v14, s[20:23], s15 offen offset:1024 sc1
  v_rcp_f32 v231, v231
  v_pk_mul_f32 v[224:225], v[224:225], v[176:177]
  v_pk_mul_f32 v[226:227], v[226:227], v[178:179]
  v_pk_mul_f32 v[228:229], v[228:229], v[184:185]
  v_pk_mul_f32 v[230:231], v[230:231], v[186:187]
  v_cvt_pk_bf16_f32 v176, v224, v225
  v_cvt_pk_bf16_f32 v177, v226, v227
  v_cvt_pk_bf16_f32 v178, v228, v229
  v_cvt_pk_bf16_f32 v179, v230, v231
  buffer_store_dwordx4 v[176:179], v245, s[20:23], s64 offen offset:0
  v_pk_mul_f32 v[224:225], v[180:181], v[180:181]
  v_pk_mul_f32 v[226:227], v[182:183], v[182:183]
  v_pk_mul_f32 v[228:229], v[188:189], v[188:189]
  v_pk_mul_f32 v[230:231], v[190:191], v[190:191]
  v_pk_fma_f32 v[224:225], v[224:225], v[240:241], v[240:241] op_sel:[0,1,0] op_sel_hi:[1,1,0]
  v_pk_fma_f32 v[226:227], v[226:227], v[240:241], v[240:241] op_sel:[0,1,0] op_sel_hi:[1,1,0]
  v_pk_fma_f32 v[228:229], v[228:229], v[240:241], v[240:241] op_sel:[0,1,0] op_sel_hi:[1,1,0]
  v_pk_fma_f32 v[230:231], v[230:231], v[240:241], v[240:241] op_sel:[0,1,0] op_sel_hi:[1,1,0]
  v_pk_mul_f32 v[224:225], v[224:225], v[180:181]
  v_pk_mul_f32 v[226:227], v[226:227], v[182:183]
  v_pk_mul_f32 v[228:229], v[228:229], v[188:189]
  v_pk_mul_f32 v[230:231], v[230:231], v[190:191]
  v_exp_f32 v224, v224
  v_exp_f32 v225, v225
  v_exp_f32 v226, v226
  v_exp_f32 v227, v227
  v_exp_f32 v228, v228
  v_exp_f32 v229, v229
  v_exp_f32 v230, v230
  v_exp_f32 v231, v231
  v_pk_add_f32 v[224:225], v[224:225], v[242:243] op_sel:[0,0] op_sel_hi:[1,0]
  v_pk_add_f32 v[226:227], v[226:227], v[242:243] op_sel:[0,0] op_sel_hi:[1,0]
  v_pk_add_f32 v[228:229], v[228:229], v[242:243] op_sel:[0,0] op_sel_hi:[1,0]
  v_pk_add_f32 v[230:231], v[230:231], v[242:243] op_sel:[0,0] op_sel_hi:[1,0]
  v_rcp_f32 v224, v224
  v_rcp_f32 v225, v225
  v_rcp_f32 v226, v226
  v_rcp_f32 v227, v227
  v_rcp_f32 v228, v228
  v_rcp_f32 v229, v229
  v_rcp_f32 v230, v230
  v_rcp_f32 v231, v231
  v_pk_mul_f32 v[224:225], v[224:225], v[180:181]
  v_pk_mul_f32 v[226:227], v[226:227], v[182:183]
  v_pk_mul_f32 v[228:229], v[228:229], v[188:189]
  v_pk_mul_f32 v[230:231], v[230:231], v[190:191]
  v_cvt_pk_bf16_f32 v180, v224, v225
  v_cvt_pk_bf16_f32 v181, v226, v227
  v_cvt_pk_bf16_f32 v182, v228, v229
  v_cvt_pk_bf16_f32 v183, v230, v231
  buffer_store_dwordx4 v[180:183], v245, s[20:23], s64 offen offset:1024
  s_waitcnt vmcnt(18)
  v_mfma_f32_16x16x32_bf16 v[80:83], a[0:3], a[224:227], 0
  buffer_load_dwordx4 a[216:219], v9, s[36:39], s57 offen offset:2048
  s_and_b32 s18, s5, 7
  v_mfma_f32_16x16x32_bf16 v[84:87], a[4:7], a[224:227], 0
  ds_write_b128 v250, a[48:51] offset:17408
  v_mfma_f32_16x16x32_bf16 v[88:91], a[8:11], a[224:227], 0
  s_lshl_b32 s18, s18, 2
  s_add_u32 s18, s18, s3
  v_mfma_f32_16x16x32_bf16 v[92:95], a[12:15], a[224:227], 0
  ds_write_b128 v250, a[52:55] offset:17536
  s_waitcnt vmcnt(18)
  v_mfma_f32_16x16x32_bf16 v[96:99], a[0:3], a[228:231], 0
  buffer_load_dwordx4 a[220:223], v9, s[36:39], s57 offen offset:3072
  s_lshl_b32 s19, s18, 8
  v_mfma_f32_16x16x32_bf16 v[100:103], a[4:7], a[228:231], 0
  ds_write_b128 v251, a[56:59] offset:17664
  v_mfma_f32_16x16x32_bf16 v[104:107], a[8:11], a[228:231], 0
  s_add_u32 s57, s24, s96
  buffer_load_dwordx4 a[128:131], v8, s[36:39], s57 offen offset:0
  v_mfma_f32_16x16x32_bf16 v[108:111], a[12:15], a[228:231], 0
  ds_write_b128 v251, a[60:63] offset:17792
  s_waitcnt vmcnt(19)
  v_mfma_f32_16x16x32_bf16 v[112:115], a[0:3], a[232:235], 0
  ds_read_b64_tr_b16 a[48:49], v252 offset:17408
  s_lshl_b32 s60, s16, 15
  v_mfma_f32_16x16x32_bf16 v[116:119], a[4:7], a[232:235], 0
  ds_read_b64_tr_b16 a[50:51], v252 offset:19456
  buffer_load_dwordx4 a[132:135], v8, s[36:39], s57 offen offset:1024
  v_mfma_f32_16x16x32_bf16 v[120:123], a[8:11], a[232:235], 0
  ds_read_b64_tr_b16 a[52:53], v253 offset:17408
  s_add_u32 s19, s19, s60
  v_mfma_f32_16x16x32_bf16 v[124:127], a[12:15], a[232:235], 0
  ds_read_b64_tr_b16 a[54:55], v253 offset:19456
  s_waitcnt vmcnt(19)
  v_mfma_f32_16x16x32_bf16 v[128:131], a[0:3], a[236:239], 0
  ds_read_b64_tr_b16 a[56:57], v254 offset:17408
  buffer_load_dwordx4 a[136:139], v8, s[36:39], s57 offen offset:2048
  v_mfma_f32_16x16x32_bf16 v[132:135], a[4:7], a[236:239], 0
  ds_read_b64_tr_b16 a[58:59], v254 offset:19456
  s_add_u32 s19, s19, 2097152
  v_mfma_f32_16x16x32_bf16 v[136:139], a[8:11], a[236:239], 0
  ds_read_b64_tr_b16 a[60:61], v255 offset:17408
  buffer_load_dwordx4 a[140:143], v8, s[36:39], s57 offen offset:3072
  v_mfma_f32_16x16x32_bf16 v[140:143], a[12:15], a[236:239], 0
  ds_read_b64_tr_b16 a[62:63], v255 offset:19456
  ds_write_b128 v250, a[64:67] offset:0
  ds_write_b128 v250, a[68:71] offset:128
  ds_write_b128 v251, a[72:75] offset:256
  ds_write_b128 v251, a[76:79] offset:384
  ds_read_b64_tr_b16 a[64:65], v252 offset:0
  ds_read_b64_tr_b16 a[66:67], v252 offset:2048
  ds_read_b64_tr_b16 a[68:69], v253 offset:0
  ds_read_b64_tr_b16 a[70:71], v253 offset:2048
  ds_read_b64_tr_b16 a[72:73], v254 offset:0
  ds_read_b64_tr_b16 a[74:75], v254 offset:2048
  ds_read_b64_tr_b16 a[76:77], v255 offset:0
  ds_read_b64_tr_b16 a[78:79], v255 offset:2048
  s_add_u32 s63, s19, 32768
  s_lshl_b32 s18, s18, 5
  v_lshrrev_b32 v11, 4, v1
  v_lshlrev_b32 v11, 3, v11
  v_and_b32 v12, 15, v1
  v_lshl_add_u32 v10, v12, 11, v11
  s_add_u32 s60, s60, s18
  s_add_u32 s61, s60, 32768
  s_add_u32 s62, s3, 1
  s_and_b32 s62, s62, 3
  s_mul_i32 s62, s62, 6144
  v_add_u32 v6, s62, v2
  s_add_u32 s62, s3, 2
  s_and_b32 s62, s62, 3
  s_mul_i32 s62, s62, 6144
  v_add_u32 v7, s62, v2
  s_add_u32 s62, s3, 3
  s_and_b32 s62, s62, 3
  s_mul_i32 s62, s62, 6144
  v_add_u32 v14, s62, v2
  s_mul_i32 s62, s3, 6144
  v_add_u32 v12, s62, v2
  s_waitcnt vmcnt(9)
  v_cmp_gt_u32 vcc, 3, v13
  s_nop 4
  s_cbranch_vccz f_g2p3_ok
  s_mov_b32 s69, 0
f_g2p3:
  buffer_load_dword v13, v15, s[20:23], s17 offen offset:0 sc1
  s_add_u32 s69, s69, 1
  s_waitcnt vmcnt(0)
  v_cmp_gt_u32 vcc, 3, v13
  s_cmp_ge_u32 s69, 4000
  s_cbranch_scc1 f_g2p3_out
  s_nop 3
  s_cbranch_vccnz f_g2p3
f_g2p3_out:
f_g2p3_ok:
  v_mfma_f32_16x16x32_bf16 v[80:83], a[16:19], a[240:243], v[80:83]
  v_mfma_f32_16x16x32_bf16 v[84:87], a[20:23], a[240:243], v[84:87]
  ds_write_b128 v250, a[80:83] offset:17408
  v_mfma_f32_16x16x32_bf16 v[88:91], a[24:27], a[240:243], v[88:91]
  buffer_load_dwordx4 v[16:19], v0, s[20:23], s8 offen offset:0 sc1
  v_mfma_f32_16x16x32_bf16 v[92:95], a[28:31], a[240:243], v[92:95]
  ds_write_b128 v250, a[84:87] offset:17536
  v_mfma_f32_16x16x32_bf16 v[96:99], a[16:19], a[244:247], v[96:99]
  buffer_load_dwordx4 v[20:23], v0, s[20:23], s8 offen offset:1024 sc1
  v_mfma_f32_16x16x32_bf16 v[100:103], a[20:23], a[244:247], v[100:103]
  ds_write_b128 v251, a[88:91] offset:17664
  v_mfma_f32_16x16x32_bf16 v[104:107], a[24:27], a[244:247], v[104:107]
  v_mfma_f32_16x16x32_bf16 v[108:111], a[28:31], a[244:247], v[108:111]
  ds_write_b128 v251, a[92:95] offset:17792
  v_mfma_f32_16x16x32_bf16 v[112:115], a[16:19], a[248:251], v[112:115]
  ds_read_b64_tr_b16 a[80:81], v252 offset:17408
  buffer_load_dwordx4 v[24:27], v0, s[20:23], s12 offen offset:0 sc1
  v_mfma_f32_16x16x32_bf16 v[116:119], a[20:23], a[248:251], v[116:119]
  ds_read_b64_tr_b16 a[82:83], v252 offset:19456
  v_mfma_f32_16x16x32_bf16 v[120:123], a[24:27], a[248:251], v[120:123]
  ds_read_b64_tr_b16 a[84:85], v253 offset:17408
  buffer_load_dwordx4 v[28:31], v0, s[20:23], s12 offen offset:1024 sc1
  v_mfma_f32_16x16x32_bf16 v[124:127], a[28:31], a[248:251], v[124:127]
  ds_read_b64_tr_b16 a[86:87], v253 offset:19456
  v_mfma_f32_16x16x32_bf16 v[128:131], a[16:19], a[252:255], v[128:131]
  ds_read_b64_tr_b16 a[88:89], v254 offset:17408
  v_mfma_f32_16x16x32_bf16 v[132:135], a[20:23], a[252:255], v[132:135]
  ds_read_b64_tr_b16 a[90:91], v254 offset:19456
  buffer_load_dwordx4 v[32:35], v0, s[20:23], s9 offen offset:0 sc1
  v_mfma_f32_16x16x32_bf16 v[136:139], a[24:27], a[252:255], v[136:139]
  ds_read_b64_tr_b16 a[92:93], v255 offset:17408
  v_mfma_f32_16x16x32_bf16 v[140:143], a[28:31], a[252:255], v[140:143]
  ds_read_b64_tr_b16 a[94:95], v255 offset:19456
  s_waitcnt vmcnt(11)
  v_mov_b32 v5, 4
  s_mov_b64 exec, 1
  buffer_store_dword v5, v4, s[20:23], s65 offen
  s_mov_b64 exec, -1
  s_waitcnt lgkmcnt(15)
  v_mfma_f32_16x16x32_bf16 v[80:83], a[32:35], v[144:147], v[80:83]
  buffer_load_dwordx4 v[36:39], v0, s[20:23], s9 offen offset:1024 sc1
  v_mfma_f32_16x16x32_bf16 v[84:87], a[36:39], v[144:147], v[84:87]
  ds_write_b128 v250, a[96:99] offset:0
  v_mfma_f32_16x16x32_bf16 v[88:91], a[40:43], v[144:147], v[88:91]
  buffer_load_dwordx4 v[40:43], v0, s[20:23], s13 offen offset:0 sc1
  v_mfma_f32_16x16x32_bf16 v[92:95], a[44:47], v[144:147], v[92:95]
  ds_write_b128 v250, a[100:103] offset:128
  v_mfma_f32_16x16x32_bf16 v[96:99], a[32:35], v[148:151], v[96:99]
  v_mfma_f32_16x16x32_bf16 v[100:103], a[36:39], v[148:151], v[100:103]
  ds_write_b128 v251, a[104:107] offset:256
  v_mfma_f32_16x16x32_bf16 v[104:107], a[40:43], v[148:151], v[104:107]
  buffer_load_dwordx4 v[44:47], v0, s[20:23], s13 offen offset:1024 sc1
  v_mfma_f32_16x16x32_bf16 v[108:111], a[44:47], v[148:151], v[108:111]
  ds_write_b128 v251, a[108:111] offset:384
  v_mfma_f32_16x16x32_bf16 v[112:115], a[32:35], v[152:155], v[112:115]
  ds_read_b64_tr_b16 a[96:97], v252 offset:0
  s_add_u32 s57, s25, s96
  v_mfma_f32_16x16x32_bf16 v[116:119], a[36:39], v[152:155], v[116:119]
  ds_read_b64_tr_b16 a[98:99], v252 offset:2048
  buffer_load_dwordx4 a[144:147], v8, s[36:39], s57 offen offset:0
  v_mfma_f32_16x16x32_bf16 v[120:123], a[40:43], v[152:155], v[120:123]
  ds_read_b64_tr_b16 a[100:101], v253 offset:0
  buffer_load_dwordx4 v[48:51], v0, s[20:23], s10 offen offset:0 sc1
  v_mfma_f32_16x16x32_bf16 v[124:127], a[44:47], v[152:155], v[124:127]
  ds_read_b64_tr_b16 a[102:103], v253 offset:2048
  v_mfma_f32_16x16x32_bf16 v[128:131], a[32:35], v[156:159], v[128:131]
  ds_read_b64_tr_b16 a[104:105], v254 offset:0
  v_mfma_f32_16x16x32_bf16 v[132:135], a[36:39], v[156:159], v[132:135]
  ds_read_b64_tr_b16 a[106:107], v254 offset:2048
  buffer_load_dwordx4 a[148:151], v8, s[36:39], s57 offen offset:1024
  v_mfma_f32_16x16x32_bf16 v[136:139], a[40:43], v[156:159], v[136:139]
  ds_read_b64_tr_b16 a[108:109], v255 offset:0
  v_mfma_f32_16x16x32_bf16 v[140:143], a[44:47], v[156:159], v[140:143]
  ds_read_b64_tr_b16 a[110:111], v255 offset:2048
  s_barrier
  v_mfma_f32_16x16x32_bf16 v[80:83], a[48:51], v[160:163], v[80:83]
  buffer_load_dwordx4 v[52:55], v0, s[20:23], s10 offen offset:1024 sc1
  v_mfma_f32_16x16x32_bf16 v[84:87], a[52:55], v[160:163], v[84:87]
  ds_write_b128 v250, a[112:115] offset:17408
  v_mfma_f32_16x16x32_bf16 v[88:91], a[56:59], v[160:163], v[88:91]
  v_mfma_f32_16x16x32_bf16 v[92:95], a[60:63], v[160:163], v[92:95]
  ds_write_b128 v250, a[116:119] offset:17536
  v_mfma_f32_16x16x32_bf16 v[96:99], a[48:51], v[164:167], v[96:99]
  buffer_load_dwordx4 a[152:155], v8, s[36:39], s57 offen offset:2048
  v_mfma_f32_16x16x32_bf16 v[100:103], a[52:55], v[164:167], v[100:103]
  ds_write_b128 v251, a[120:123] offset:17664
  v_mfma_f32_16x16x32_bf16 v[104:107], a[56:59], v[164:167], v[104:107]
  buffer_load_dwordx4 v[56:59], v0, s[20:23], s14 offen offset:0 sc1
  v_mfma_f32_16x16x32_bf16 v[108:111], a[60:63], v[164:167], v[108:111]
  ds_write_b128 v251, a[124:127] offset:17792
  v_mfma_f32_16x16x32_bf16 v[112:115], a[48:51], v[168:171], v[112:115]
  ds_read_b64_tr_b16 a[112:113], v252 offset:17408
  buffer_load_dwordx4 a[156:159], v8, s[36:39], s57 offen offset:3072
  v_mfma_f32_16x16x32_bf16 v[116:119], a[52:55], v[168:171], v[116:119]
  ds_read_b64_tr_b16 a[114:115], v252 offset:19456
  v_mfma_f32_16x16x32_bf16 v[120:123], a[56:59], v[168:171], v[120:123]
  ds_read_b64_tr_b16 a[116:117], v253 offset:17408
  v_mfma_f32_16x16x32_bf16 v[124:127], a[60:63], v[168:171], v[124:127]
  ds_read_b64_tr_b16 a[118:119], v253 offset:19456
  v_mfma_f32_16x16x32_bf16 v[128:131], a[48:51], v[172:175], v[128:131]
  ds_read_b64_tr_b16 a[120:121], v254 offset:17408
  buffer_load_dwordx4 v[60:63], v0, s[20:23], s14 offen offset:1024 sc1
  v_mfma_f32_16x16x32_bf16 v[132:135], a[52:55], v[172:175], v[132:135]
  ds_read_b64_tr_b16 a[122:123], v254 offset:19456
  v_mfma_f32_16x16x32_bf16 v[136:139], a[56:59], v[172:175], v[136:139]
  ds_read_b64_tr_b16 a[124:125], v255 offset:17408
  s_add_u32 s57, s26, s96
  v_mfma_f32_16x16x32_bf16 v[140:143], a[60:63], v[172:175], v[140:143]
  ds_read_b64_tr_b16 a[126:127], v255 offset:19456
  s_waitcnt lgkmcnt(15)
  s_waitcnt vmcnt(16)
  v_mfma_f32_16x16x32_bf16 v[80:83], a[64:67], v[16:19], v[80:83]
  buffer_load_dwordx4 a[160:163], v8, s[36:39], s57 offen offset:0
  v_mfma_f32_16x16x32_bf16 v[84:87], a[68:71], v[16:19], v[84:87]
  ds_write_b128 v250, a[192:195] offset:0
  v_mfma_f32_16x16x32_bf16 v[88:91], a[72:75], v[16:19], v[88:91]
  buffer_load_dwordx4 v[64:67], v0, s[20:23], s11 offen offset:0 sc1
  v_mfma_f32_16x16x32_bf16 v[92:95], a[76:79], v[16:19], v[92:95]
  ds_write_b128 v250, a[196:199] offset:128
  s_waitcnt vmcnt(17)
  v_mfma_f32_16x16x32_bf16 v[96:99], a[64:67], v[20:23], v[96:99]
  buffer_load_dwordx4 a[164:167], v8, s[36:39], s57 offen offset:1024
  v_mfma_f32_16x16x32_bf16 v[100:103], a[68:71], v[20:23], v[100:103]
  ds_write_b128 v251, a[200:203] offset:256
  v_mfma_f32_16x16x32_bf16 v[104:107], a[72:75], v[20:23], v[104:107]
  buffer_load_dwordx4 v[68:71], v0, s[20:23], s11 offen offset:1024 sc1
  v_mfma_f32_16x16x32_bf16 v[108:111], a[76:79], v[20:23], v[108:111]
  ds_write_b128 v251, a[204:207] offset:384
  s_waitcnt vmcnt(18)
  v_mfma_f32_16x16x32_bf16 v[112:115], a[64:67], v[24:27], v[112:115]
  ds_read_b64_tr_b16 a[192:193], v252 offset:0
  v_mfma_f32_16x16x32_bf16 v[116:119], a[68:71], v[24:27], v[116:119]
  ds_read_b64_tr_b16 a[194:195], v252 offset:2048
  buffer_load_dwordx4 a[168:171], v8, s[36:39], s57 offen offset:2048
  v_mfma_f32_16x16x32_bf16 v[120:123], a[72:75], v[24:27], v[120:123]
  ds_read_b64_tr_b16 a[196:197], v253 offset:0
  v_mfma_f32_16x16x32_bf16 v[124:127], a[76:79], v[24:27], v[124:127]
  ds_read_b64_tr_b16 a[198:199], v253 offset:2048
  s_waitcnt vmcnt(18)
  v_mfma_f32_16x16x32_bf16 v[128:131], a[64:67], v[28:31], v[128:131]
  ds_read_b64_tr_b16 a[200:201], v254 offset:0
  buffer_load_dwordx4 v[72:75], v0, s[20:23], s15 offen offset:0 sc1
  v_mfma_f32_16x16x32_bf16 v[132:135], a[68:71], v[28:31], v[132:135]
  ds_read_b64_tr_b16 a[202:203], v254 offset:2048
  v_mfma_f32_16x16x32_bf16 v[136:139], a[72:75], v[28:31], v[136:139]
  ds_read_b64_tr_b16 a[204:205], v255 offset:0
  v_mfma_f32_16x16x32_bf16 v[140:143], a[76:79], v[28:31], v[140:143]
  ds_read_b64_tr_b16 a[206:207], v255 offset:2048
  buffer_load_dword v13, v15, s[20:23], s17 offen sc1
  s_waitcnt vmcnt(19)
  v_mfma_f32_16x16x32_bf16 v[80:83], a[80:83], v[32:35], v[80:83]
  buffer_load_dwordx4 a[172:175], v8, s[36:39], s57 offen offset:3072
  v_mfma_f32_16x16x32_bf16 v[84:87], a[84:87], v[32:35], v[84:87]
  ds_write_b128 v250, a[208:211] offset:17408
  v_mfma_f32_16x16x32_bf16 v[88:91], a[88:91], v[32:35], v[88:91]
  buffer_load_dwordx4 v[76:79], v0, s[20:23], s15 offen offset:1024 sc1
  v_mfma_f32_16x16x32_bf16 v[92:95], a[92:95], v[32:35], v[92:95]
  ds_write_b128 v250, a[212:215] offset:17536
  s_waitcnt vmcnt(19)
  v_mfma_f32_16x16x32_bf16 v[96:99], a[80:83], v[36:39], v[96:99]
  s_add_u32 s57, s27, s96
  buffer_load_dwordx4 a[176:179], v8, s[36:39], s57 offen offset:0
  v_mfma_f32_16x16x32_bf16 v[100:103], a[84:87], v[36:39], v[100:103]
  ds_write_b128 v251, a[216:219] offset:17664
  v_mfma_f32_16x16x32_bf16 v[104:107], a[88:91], v[36:39], v[104:107]
  v_mfma_f32_16x16x32_bf16 v[108:111], a[92:95], v[36:39], v[108:111]
  ds_write_b128 v251, a[220:223] offset:17792
  s_waitcnt vmcnt(19)
  v_mfma_f32_16x16x32_bf16 v[112:115], a[80:83], v[40:43], v[112:115]
  ds_read_b64_tr_b16 a[208:209], v252 offset:17408
  buffer_load_dwordx4 v[192:195], v244, s[20:23], s8 offen offset:0 sc1
  v_mfma_f32_16x16x32_bf16 v[116:119], a[84:87], v[40:43], v[116:119]
  ds_read_b64_tr_b16 a[210:211], v252 offset:19456
  v_mfma_f32_16x16x32_bf16 v[120:123], a[88:91], v[40:43], v[120:123]
  ds_read_b64_tr_b16 a[212:213], v253 offset:17408
  buffer_load_dwordx4 v[196:199], v244, s[20:23], s9 offen offset:0 sc1
  v_mfma_f32_16x16x32_bf16 v[124:127], a[92:95], v[40:43], v[124:127]
  ds_read_b64_tr_b16 a[214:215], v253 offset:19456
  s_waitcnt vmcnt(20)
  v_mfma_f32_16x16x32_bf16 v[128:131], a[80:83], v[44:47], v[128:131]
  ds_read_b64_tr_b16 a[216:217], v254 offset:17408
  v_mfma_f32_16x16x32_bf16 v[132:135], a[84:87], v[44:47], v[132:135]
  ds_read_b64_tr_b16 a[218:219], v254 offset:19456
  buffer_load_dwordx4 a[180:183], v8, s[36:39], s57 offen offset:1024
  v_mfma_f32_16x16x32_bf16 v[136:139], a[88:91], v[44:47], v[136:139]
  ds_read_b64_tr_b16 a[220:221], v255 offset:17408
  v_mfma_f32_16x16x32_bf16 v[140:143], a[92:95], v[44:47], v[140:143]
  ds_read_b64_tr_b16 a[222:223], v255 offset:19456
  s_waitcnt lgkmcnt(15)
  s_waitcnt vmcnt(19)
  v_mfma_f32_16x16x32_bf16 v[80:83], a[96:99], v[48:51], v[80:83]
  buffer_load_dwordx4 a[184:187], v8, s[36:39], s57 offen offset:2048
  v_mfma_f32_16x16x32_bf16 v[84:87], a[100:103], v[48:51], v[84:87]
  ds_write_b128 v250, a[128:131] offset:0
  v_mfma_f32_16x16x32_bf16 v[88:91], a[104:107], v[48:51], v[88:91]
  buffer_load_dwordx4 v[200:203], v244, s[20:23], s12 offen offset:0 sc1
  v_mfma_f32_16x16x32_bf16 v[92:95], a[108:111], v[48:51], v[92:95]
  ds_write_b128 v250, a[132:135] offset:128
  s_waitcnt vmcnt(19)
  v_mfma_f32_16x16x32_bf16 v[96:99], a[96:99], v[52:55], v[96:99]
  v_mfma_f32_16x16x32_bf16 v[100:103], a[100:103], v[52:55], v[100:103]
  ds_write_b128 v251, a[136:139] offset:256
  v_mfma_f32_16x16x32_bf16 v[104:107], a[104:107], v[52:55], v[104:107]
  buffer_load_dwordx4 v[204:207], v244, s[20:23], s13 offen offset:0 sc1
  v_mfma_f32_16x16x32_bf16 v[108:111], a[108:111], v[52:55], v[108:111]
  ds_write_b128 v251, a[140:143] offset:384
  s_waitcnt vmcnt(18)
  v_mfma_f32_16x16x32_bf16 v[112:115], a[96:99], v[56:59], v[112:115]
  ds_read_b64_tr_b16 a[128:129], v252 offset:0
  buffer_load_dwordx4 a[188:191], v8, s[36:39], s57 offen offset:3072
  v_mfma_f32_16x16x32_bf16 v[116:119], a[100:103], v[56:59], v[116:119]
  ds_read_b64_tr_b16 a[130:131], v252 offset:2048
  v_mfma_f32_16x16x32_bf16 v[120:123], a[104:107], v[56:59], v[120:123]
  ds_read_b64_tr_b16 a[132:133], v253 offset:0
  v_mfma_f32_16x16x32_bf16 v[124:127], a[108:111], v[56:59], v[124:127]
  ds_read_b64_tr_b16 a[134:135], v253 offset:2048
  s_waitcnt vmcnt(17)
  v_mfma_f32_16x16x32_bf16 v[128:131], a[96:99], v[60:63], v[128:131]
  ds_read_b64_tr_b16 a[136:137], v254 offset:0
  buffer_load_dwordx4 v[208:211], v244, s[20:23], s10 offen offset:0 sc1
  v_mfma_f32_16x16x32_bf16 v[132:135], a[100:103], v[60:63], v[132:135]
  ds_read_b64_tr_b16 a[138:139], v254 offset:2048
  v_mfma_f32_16x16x32_bf16 v[136:139], a[104:107], v[60:63], v[136:139]
  ds_read_b64_tr_b16 a[140:141], v255 offset:0
  buffer_load_dwordx4 v[212:215], v244, s[20:23], s11 offen offset:0 sc1
  v_mfma_f32_16x16x32_bf16 v[140:143], a[108:111], v[60:63], v[140:143]
  ds_read_b64_tr_b16 a[142:143], v255 offset:2048
  s_waitcnt vmcnt(12)
  v_cmp_gt_u32 vcc, 4, v13
  s_nop 4
  s_cbranch_vccz f_g2p4_ok
  s_mov_b32 s69, 0
f_g2p4:
  buffer_load_dword v13, v15, s[20:23], s17 offen offset:0 sc1
  s_add_u32 s69, s69, 1
  s_waitcnt vmcnt(0)
  v_cmp_gt_u32 vcc, 4, v13
  s_cmp_ge_u32 s69, 4000
  s_cbranch_scc1 f_g2p4_out
  s_nop 3
  s_cbranch_vccnz f_g2p4
f_g2p4_out:
f_g2p4_ok:
  v_mfma_f32_16x16x32_bf16 v[80:83], a[112:115], v[64:67], v[80:83]
  buffer_load_dwordx4 v[216:219], v244, s[20:23], s14 offen offset:0 sc1
  v_mfma_f32_16x16x32_bf16 v[84:87], a[116:119], v[64:67], v[84:87]
  ds_write_b128 v250, a[144:147] offset:17408
  v_mfma_f32_16x16x32_bf16 v[88:91], a[120:123], v[64:67], v[88:91]
  v_mfma_f32_16x16x32_bf16 v[92:95], a[124:127], v[64:67], v[92:95]
  ds_write_b128 v250, a[148:151] offset:17536
  v_mfma_f32_16x16x32_bf16 v[96:99], a[112:115], v[68:71], v[96:99]
  buffer_load_dwordx4 v[220:223], v244, s[20:23], s15 offen offset:0 sc1
  v_mfma_f32_16x16x32_bf16 v[100:103], a[116:119], v[68:71], v[100:103]
  ds_write_b128 v251, a[152:155] offset:17664
  v_mfma_f32_16x16x32_bf16 v[104:107], a[120:123], v[68:71], v[104:107]
  buffer_load_dwordx4 v[224:227], v3, s[20:23], s19 offen sc1
  v_mfma_f32_16x16x32_bf16 v[108:111], a[124:127], v[68:71], v[108:111]
  ds_write_b128 v251, a[156:159] offset:17792
  v_mfma_f32_16x16x32_bf16 v[112:115], a[112:115], v[72:75], v[112:115]
  ds_read_b64_tr_b16 a[144:145], v252 offset:17408
  v_mfma_f32_16x16x32_bf16 v[116:119], a[116:119], v[72:75], v[116:119]
  ds_read_b64_tr_b16 a[146:147], v252 offset:19456
  buffer_load_dwordx4 v[228:231], v3, s[20:23], s63 offen sc1
  v_mfma_f32_16x16x32_bf16 v[120:123], a[120:123], v[72:75], v[120:123]
  ds_read_b64_tr_b16 a[148:149], v253 offset:17408
  v_mfma_f32_16x16x32_bf16 v[124:127], a[124:127], v[72:75], v[124:127]
  ds_read_b64_tr_b16 a[150:151], v253 offset:19456
  s_waitcnt vmcnt(14)
  v_mfma_f32_16x16x32_bf16 v[128:131], a[112:115], v[76:79], v[128:131]
  ds_read_b64_tr_b16 a[152:153], v254 offset:17408
  buffer_load_dwordx2 v[232:233], v11, s[44:47], s18 offen
  v_mfma_f32_16x16x32_bf16 v[132:135], a[116:119], v[76:79], v[132:135]
  ds_read_b64_tr_b16 a[154:155], v254 offset:19456
  v_mfma_f32_16x16x32_bf16 v[136:139], a[120:123], v[76:79], v[136:139]
  ds_read_b64_tr_b16 a[156:157], v255 offset:17408
  buffer_load_dwordx4 a[224:227], v245, s[20:23], s8 offen offset:0 sc1
  v_mfma_f32_16x16x32_bf16 v[140:143], a[124:127], v[76:79], v[140:143]
  ds_read_b64_tr_b16 a[158:159], v255 offset:19456
  s_waitcnt lgkmcnt(15)
  s_waitcnt vmcnt(13)
  v_swap_b32 v194, v196
  v_swap_b32 v195, v197
  s_nop 1
  v_mfma_f32_16x16x32_bf16 v[80:83], a[192:195], v[192:195], v[80:83]
  v_mfma_f32_16x16x32_bf16 v[84:87], a[196:199], v[192:195], v[84:87]
  ds_write_b128 v250, a[160:163] offset:0
  v_mfma_f32_16x16x32_bf16 v[88:91], a[200:203], v[192:195], v[88:91]
  buffer_load_dwordx4 a[240:243], v245, s[20:23], s9 offen offset:0 sc1
  v_mfma_f32_16x16x32_bf16 v[92:95], a[204:207], v[192:195], v[92:95]
  ds_write_b128 v250, a[164:167] offset:128
  v_mfma_f32_16x16x32_bf16 v[96:99], a[192:195], v[196:199], v[96:99]
  buffer_load_dwordx4 v[144:147], v245, s[20:23], s10 offen offset:0 sc1
  v_mfma_f32_16x16x32_bf16 v[100:103], a[196:199], v[196:199], v[100:103]
  ds_write_b128 v251, a[168:171] offset:256
  v_mfma_f32_16x16x32_bf16 v[104:107], a[200:203], v[196:199], v[104:107]
  v_mfma_f32_16x16x32_bf16 v[108:111], a[204:207], v[196:199], v[108:111]
  ds_write_b128 v251, a[172:175] offset:384
  s_waitcnt vmcnt(11)
  v_swap_b32 v202, v204
  v_swap_b32 v203, v205
  s_nop 1
  v_mfma_f32_16x16x32_bf16 v[112:115], a[192:195], v[200:203], v[112:115]
  ds_read_b64_tr_b16 a[160:161], v252 offset:0
  buffer_load_dwordx4 v[160:163], v245, s[20:23], s11 offen offset:0 sc1
  v_mfma_f32_16x16x32_bf16 v[116:119], a[196:199], v[200:203], v[116:119]
  ds_read_b64_tr_b16 a[162:163], v252 offset:2048
  v_mfma_f32_16x16x32_bf16 v[120:123], a[200:203], v[200:203], v[120:123]
  ds_read_b64_tr_b16 a[164:165], v253 offset:0
  buffer_load_dwordx4 a[228:231], v245, s[20:23], s8 offen offset:1024 sc1
  v_mfma_f32_16x16x32_bf16 v[124:127], a[204:207], v[200:203], v[124:127]
  ds_read_b64_tr_b16 a[166:167], v253 offset:2048
  v_mfma_f32_16x16x32_bf16 v[128:131], a[192:195], v[204:207], v[128:131]
  ds_read_b64_tr_b16 a[168:169], v254 offset:0
  buffer_load_dwordx4 a[244:247], v245, s[20:23], s9 offen offset:1024 sc1
  v_mfma_f32_16x16x32_bf16 v[132:135], a[196:199], v[204:207], v[132:135]
  ds_read_b64_tr_b16 a[170:171], v254 offset:2048
  v_mfma_f32_16x16x32_bf16 v[136:139], a[200:203], v[204:207], v[136:139]
  ds_read_b64_tr_b16 a[172:173], v255 offset:0
  v_mfma_f32_16x16x32_bf16 v[140:143], a[204:207], v[204:207], v[140:143]
  ds_read_b64_tr_b16 a[174:175], v255 offset:2048
  s_waitcnt vmcnt(11)
  v_swap_b32 v210, v212
  v_swap_b32 v211, v213
  s_nop 1
  v_mfma_f32_16x16x32_bf16 v[80:83], a[208:211], v[208:211], v[80:83]
  buffer_load_dwordx4 v[148:151], v245, s[20:23], s10 offen offset:1024 sc1
  v_mfma_f32_16x16x32_bf16 v[84:87], a[212:215], v[208:211], v[84:87]
  ds_write_b128 v250, a[176:179] offset:17408
  v_mfma_f32_16x16x32_bf16 v[88:91], a[216:219], v[208:211], v[88:91]
  buffer_load_dwordx4 v[164:167], v245, s[20:23], s11 offen offset:1024 sc1
  v_mfma_f32_16x16x32_bf16 v[92:95], a[220:223], v[208:211], v[92:95]
  ds_write_b128 v250, a[180:183] offset:17536
  v_mfma_f32_16x16x32_bf16 v[96:99], a[208:211], v[212:215], v[96:99]
  v_mfma_f32_16x16x32_bf16 v[100:103], a[212:215], v[212:215], v[100:103]
  ds_write_b128 v251, a[184:187] offset:17664
  v_mfma_f32_16x16x32_bf16 v[104:107], a[216:219], v[212:215], v[104:107]
  buffer_load_dwordx4 a[232:235], v245, s[20:23], s12 offen offset:0 sc1
  v_mfma_f32_16x16x32_bf16 v[108:111], a[220:223], v[212:215], v[108:111]
  ds_write_b128 v251, a[188:191] offset:17792
  s_waitcnt vmcnt(12)
  v_swap_b32 v218, v220
  v_swap_b32 v219, v221
  s_nop 1
  v_mfma_f32_16x16x32_bf16 v[112:115], a[208:211], v[216:219], v[112:115]
  ds_read_b64_tr_b16 a[176:177], v252 offset:17408
  buffer_load_dwordx4 a[248:251], v245, s[20:23], s13 offen offset:0 sc1
  v_mfma_f32_16x16x32_bf16 v[116:119], a[212:215], v[216:219], v[116:119]
  ds_read_b64_tr_b16 a[178:179], v252 offset:19456
  v_mfma_f32_16x16x32_bf16 v[120:123], a[216:219], v[216:219], v[120:123]
  ds_read_b64_tr_b16 a[180:181], v253 offset:17408
  v_mfma_f32_16x16x32_bf16 v[124:127], a[220:223], v[216:219], v[124:127]
  ds_read_b64_tr_b16 a[182:183], v253 offset:19456
  v_mfma_f32_16x16x32_bf16 v[128:131], a[208:211], v[220:223], v[128:131]
  ds_read_b64_tr_b16 a[184:185], v254 offset:17408
  buffer_load_dwordx4 v[152:155], v245, s[20:23], s14 offen offset:0 sc1
  v_mfma_f32_16x16x32_bf16 v[132:135], a[212:215], v[220:223], v[132:135]
  ds_read_b64_tr_b16 a[186:187], v254 offset:19456
  buffer_load_dwordx4 v[168:171], v245, s[20:23], s15 offen offset:0 sc1
  v_mfma_f32_16x16x32_bf16 v[136:139], a[216:219], v[220:223], v[136:139]
  ds_read_b64_tr_b16 a[188:189], v255 offset:17408
  v_mfma_f32_16x16x32_bf16 v[140:143], a[220:223], v[220:223], v[140:143]
  ds_read_b64_tr_b16 a[190:191], v255 offset:19456
  s_waitcnt lgkmcnt(15)
  s_waitcnt vmcnt(11)
  v_mfma_f32_16x16x32_bf16 v[80:83], a[128:131], a[224:227], v[80:83]
  buffer_load_dwordx4 a[236:239], v245, s[20:23], s12 offen offset:1024 sc1
  v_lshlrev_b32 v16, 16, v232
  v_and_b32 v17, s6, v232
  v_mfma_f32_16x16x32_bf16 v[84:87], a[132:135], a[224:227], v[84:87]
  v_lshlrev_b32 v18, 16, v233
  v_and_b32 v19, s6, v233
  v_lshlrev_b32 v20, 16, v224
  v_mfma_f32_16x16x32_bf16 v[88:91], a[136:139], a[224:227], v[88:91]
  v_and_b32 v21, s6, v224
  v_lshlrev_b32 v22, 16, v225
  v_and_b32 v23, s6, v225
  v_mfma_f32_16x16x32_bf16 v[92:95], a[140:143], a[224:227], v[92:95]
  buffer_load_dwordx4 a[252:255], v245, s[20:23], s13 offen offset:1024 sc1
  v_lshlrev_b32 v24, 16, v226
  s_waitcnt vmcnt(12)
  v_mfma_f32_16x16x32_bf16 v[80:83], a[144:147], a[240:243], v[80:83]
  v_and_b32 v25, s6, v226
  v_lshlrev_b32 v26, 16, v227
  v_and_b32 v27, s6, v227
  v_mfma_f32_16x16x32_bf16 v[84:87], a[148:151], a[240:243], v[84:87]
  v_lshlrev_b32 v28, 16, v228
  v_and_b32 v29, s6, v228
  v_lshlrev_b32 v30, 16, v229
  v_mfma_f32_16x16x32_bf16 v[88:91], a[152:155], a[240:243], v[88:91]
  buffer_load_dwordx4 v[156:159], v245, s[20:23], s14 offen offset:1024 sc1
  v_and_b32 v31, s6, v229
  v_lshlrev_b32 v32, 16, v230
  v_mfma_f32_16x16x32_bf16 v[92:95], a[156:159], a[240:243], v[92:95]
  v_and_b32 v33, s6, v230
  v_lshlrev_b32 v34, 16, v231
  s_waitcnt lgkmcnt(12)
  s_waitcnt vmcnt(12)
  v_mfma_f32_16x16x32_bf16 v[80:83], a[160:163], v[144:147], v[80:83]
  v_and_b32 v35, s6, v231
  v_mfma_f32_16x16x32_bf16 v[84:87], a[164:167], v[144:147], v[84:87]
  buffer_load_dwordx4 v[172:175], v245, s[20:23], s15 offen offset:1024 sc1
  v_mfma_f32_16x16x32_bf16 v[88:91], a[168:171], v[144:147], v[88:91]
  v_mfma_f32_16x16x32_bf16 v[92:95], a[172:175], v[144:147], v[92:95]
  s_waitcnt lgkmcnt(0)
  s_waitcnt vmcnt(12)
  v_mfma_f32_16x16x32_bf16 v[80:83], a[176:179], v[160:163], v[80:83]
  v_mfma_f32_16x16x32_bf16 v[84:87], a[180:183], v[160:163], v[84:87]
  v_mfma_f32_16x16x32_bf16 v[88:91], a[184:187], v[160:163], v[88:91]
  v_mfma_f32_16x16x32_bf16 v[92:95], a[188:191], v[160:163], v[92:95]
  s_waitcnt vmcnt(11)
  v_mfma_f32_16x16x32_bf16 v[96:99], a[128:131], a[228:231], v[96:99]
  v_mfma_f32_16x16x32_bf16 v[100:103], a[132:135], a[228:231], v[100:103]
  s_nop 2
  ds_write_b128 v6, v[84:87] offset:0
  v_mfma_f32_16x16x32_bf16 v[104:107], a[136:139], a[228:231], v[104:107]
  ds_write_b128 v7, v[88:91] offset:2048
  v_mfma_f32_16x16x32_bf16 v[108:111], a[140:143], a[228:231], v[108:111]
  ds_write_b128 v14, v[92:95] offset:4096
  s_waitcnt vmcnt(10)
  v_mfma_f32_16x16x32_bf16 v[96:99], a[144:147], a[244:247], v[96:99]
  v_mfma_f32_16x16x32_bf16 v[100:103], a[148:151], a[244:247], v[100:103]
  v_mfma_f32_16x16x32_bf16 v[104:107], a[152:155], a[244:247], v[104:107]
  v_mfma_f32_16x16x32_bf16 v[108:111], a[156:159], a[244:247], v[108:111]
  s_waitcnt vmcnt(9)
  v_mfma_f32_16x16x32_bf16 v[96:99], a[160:163], v[148:151], v[96:99]
  v_mfma_f32_16x16x32_bf16 v[100:103], a[164:167], v[148:151], v[100:103]
  v_mfma_f32_16x16x32_bf16 v[104:107], a[168:171], v[148:151], v[104:107]
  v_mfma_f32_16x16x32_bf16 v[108:111], a[172:175], v[148:151], v[108:111]
  s_waitcnt vmcnt(8)
  v_mfma_f32_16x16x32_bf16 v[96:99], a[176:179], v[164:167], v[96:99]
  s_waitcnt lgkmcnt(0)
  s_barrier
  ds_read_b128 v[56:59], v12 offset:0
  v_mfma_f32_16x16x32_bf16 v[100:103], a[180:183], v[164:167], v[100:103]
  ds_read_b128 v[60:63], v12 offset:2048
  ds_read_b128 v[64:67], v12 offset:4096
  v_mfma_f32_16x16x32_bf16 v[104:107], a[184:187], v[164:167], v[104:107]
  v_mfma_f32_16x16x32_bf16 v[108:111], a[188:191], v[164:167], v[108:111]
  s_waitcnt vmcnt(7)
  v_mfma_f32_16x16x32_bf16 v[112:115], a[128:131], a[232:235], v[112:115]
  v_mfma_f32_16x16x32_bf16 v[116:119], a[132:135], a[232:235], v[116:119]
  s_nop 0
  ds_write_b128 v6, v[100:103] offset:1024
  v_mfma_f32_16x16x32_bf16 v[120:123], a[136:139], a[232:235], v[120:123]
  s_nop 0
  ds_write_b128 v7, v[104:107] offset:3072
  v_mfma_f32_16x16x32_bf16 v[124:127], a[140:143], a[232:235], v[124:127]
  ds_write_b128 v14, v[108:111] offset:5120
  s_waitcnt vmcnt(6)
  v_mfma_f32_16x16x32_bf16 v[112:115], a[144:147], a[248:251], v[112:115]
  s_waitcnt lgkmcnt(5)
  v_add_f32 v80, v80, v56
  v_add_f32 v81, v81, v57
  v_mfma_f32_16x16x32_bf16 v[116:119], a[148:151], a[248:251], v[116:119]
  v_add_f32 v82, v82, v58
  v_add_f32 v83, v83, v59
  v_mfma_f32_16x16x32_bf16 v[120:123], a[152:155], a[248:251], v[120:123]
  s_waitcnt lgkmcnt(4)
  v_add_f32 v80, v80, v60
  v_add_f32 v81, v81, v61
  v_mfma_f32_16x16x32_bf16 v[124:127], a[156:159], a[248:251], v[124:127]
  v_add_f32 v82, v82, v62
  v_add_f32 v83, v83, v63
  s_waitcnt vmcnt(5)
  v_mfma_f32_16x16x32_bf16 v[112:115], a[160:163], v[152:155], v[112:115]
  s_waitcnt lgkmcnt(3)
  v_add_f32 v80, v80, v64
  v_add_f32 v81, v81, v65
  v_mfma_f32_16x16x32_bf16 v[116:119], a[164:167], v[152:155], v[116:119]
  v_add_f32 v82, v82, v66
  v_add_f32 v83, v83, v67
  v_cvt_pk_bf16_f32 v80, v80, v81
  v_mfma_f32_16x16x32_bf16 v[120:123], a[168:171], v[152:155], v[120:123]
  v_cvt_pk_bf16_f32 v82, v82, v83
  v_and_b32 v81, s6, v80
  v_and_b32 v83, s6, v82
  v_mfma_f32_16x16x32_bf16 v[124:127], a[172:175], v[152:155], v[124:127]
  v_lshlrev_b32 v80, 16, v80
  v_lshlrev_b32 v82, 16, v82
  s_waitcnt vmcnt(4)
  v_mfma_f32_16x16x32_bf16 v[112:115], a[176:179], v[168:171], v[112:115]
  v_add_f32 v80, v80, v16
  v_add_f32 v81, v81, v17
  v_add_f32 v82, v82, v18
  v_mfma_f32_16x16x32_bf16 v[116:119], a[180:183], v[168:171], v[116:119]
  v_add_f32 v83, v83, v19
  v_cvt_pk_bf16_f32 v80, v80, v81
  v_cvt_pk_bf16_f32 v82, v82, v83
  v_mfma_f32_16x16x32_bf16 v[120:123], a[184:187], v[168:171], v[120:123]
  v_and_b32 v81, s6, v80
  v_and_b32 v83, s6, v82
  v_lshlrev_b32 v80, 16, v80
  v_mfma_f32_16x16x32_bf16 v[124:127], a[188:191], v[168:171], v[124:127]
  v_lshlrev_b32 v82, 16, v82
  v_add_f32 v80, v80, v20
  v_add_f32 v81, v81, v21
  v_add_f32 v82, v82, v22
  v_add_f32 v83, v83, v23
  v_cvt_pk_bf16_f32 v80, v80, v81
  v_cvt_pk_bf16_f32 v81, v82, v83
  buffer_store_dwordx2 v[80:81], v10, s[48:51], s60 offen offset:0
  s_waitcnt lgkmcnt(0)
  s_barrier
  ds_read_b128 v[68:71], v12 offset:1024
  ds_read_b128 v[72:75], v12 offset:3072
  ds_read_b128 v[76:79], v12 offset:5120
  s_waitcnt vmcnt(4)
  v_mfma_f32_16x16x32_bf16 v[128:131], a[128:131], a[236:239], v[128:131]
  v_mfma_f32_16x16x32_bf16 v[132:135], a[132:135], a[236:239], v[132:135]
  ds_write_b128 v6, v[116:119] offset:24576
  v_mfma_f32_16x16x32_bf16 v[136:139], a[136:139], a[236:239], v[136:139]
  ds_write_b128 v7, v[120:123] offset:26624
  v_mfma_f32_16x16x32_bf16 v[140:143], a[140:143], a[236:239], v[140:143]
  ds_write_b128 v14, v[124:127] offset:28672
  s_waitcnt vmcnt(3)
  v_mfma_f32_16x16x32_bf16 v[128:131], a[144:147], a[252:255], v[128:131]
  s_waitcnt lgkmcnt(5)
  v_add_f32 v96, v96, v68
  v_add_f32 v97, v97, v69
  v_mfma_f32_16x16x32_bf16 v[132:135], a[148:151], a[252:255], v[132:135]
  v_add_f32 v98, v98, v70
  v_add_f32 v99, v99, v71
  v_mfma_f32_16x16x32_bf16 v[136:139], a[152:155], a[252:255], v[136:139]
  s_waitcnt lgkmcnt(4)
  v_add_f32 v96, v96, v72
  v_add_f32 v97, v97, v73
  v_mfma_f32_16x16x32_bf16 v[140:143], a[156:159], a[252:255], v[140:143]
  v_add_f32 v98, v98, v74
  v_add_f32 v99, v99, v75
  s_waitcnt vmcnt(2)
  v_mfma_f32_16x16x32_bf16 v[128:131], a[160:163], v[156:159], v[128:131]
  s_waitcnt lgkmcnt(3)
  v_add_f32 v96, v96, v76
  v_add_f32 v97, v97, v77
  v_mfma_f32_16x16x32_bf16 v[132:135], a[164:167], v[156:159], v[132:135]
  v_add_f32 v98, v98, v78
  v_add_f32 v99, v99, v79
  v_cvt_pk_bf16_f32 v96, v96, v97
  v_mfma_f32_16x16x32_bf16 v[136:139], a[168:171], v[156:159], v[136:139]
  v_cvt_pk_bf16_f32 v98, v98, v99
  v_and_b32 v97, s6, v96
  v_and_b32 v99, s6, v98
  v_mfma_f32_16x16x32_bf16 v[140:143], a[172:175], v[156:159], v[140:143]
  v_lshlrev_b32 v96, 16, v96
  v_lshlrev_b32 v98, 16, v98
  s_waitcnt vmcnt(1)
  v_mfma_f32_16x16x32_bf16 v[128:131], a[176:179], v[172:175], v[128:131]
  v_add_f32 v96, v96, v16
  v_add_f32 v97, v97, v17
  v_add_f32 v98, v98, v18
  v_mfma_f32_16x16x32_bf16 v[132:135], a[180:183], v[172:175], v[132:135]
  v_add_f32 v99, v99, v19
  v_cvt_pk_bf16_f32 v96, v96, v97
  v_cvt_pk_bf16_f32 v98, v98, v99
  v_mfma_f32_16x16x32_bf16 v[136:139], a[184:187], v[172:175], v[136:139]
  v_and_b32 v97, s6, v96
  v_and_b32 v99, s6, v98
  v_lshlrev_b32 v96, 16, v96
  v_mfma_f32_16x16x32_bf16 v[140:143], a[188:191], v[172:175], v[140:143]
  v_lshlrev_b32 v98, 16, v98
  v_add_f32 v96, v96, v24
  v_add_f32 v97, v97, v25
  v_add_f32 v98, v98, v26
  v_add_f32 v99, v99, v27
  v_cvt_pk_bf16_f32 v96, v96, v97
  v_cvt_pk_bf16_f32 v97, v98, v99
  buffer_store_dwordx2 v[96:97], v10, s[48:51], s60 offen offset:1024
  s_waitcnt lgkmcnt(0)
  s_barrier
  ds_read_b128 v[56:59], v12 offset:24576
  ds_read_b128 v[60:63], v12 offset:26624
  ds_read_b128 v[64:67], v12 offset:28672
  s_waitcnt lgkmcnt(2)
  v_pk_add_f32 v[112:113], v[112:113], v[56:57]
  v_pk_add_f32 v[114:115], v[114:115], v[58:59]
  s_waitcnt lgkmcnt(1)
  v_pk_add_f32 v[112:113], v[112:113], v[60:61]
  v_pk_add_f32 v[114:115], v[114:115], v[62:63]
  ds_write_b128 v6, v[132:135] offset:25600
  ds_write_b128 v7, v[136:139] offset:27648
  ds_write_b128 v14, v[140:143] offset:29696
  s_waitcnt lgkmcnt(3)
  v_pk_add_f32 v[112:113], v[112:113], v[64:65]
  v_pk_add_f32 v[114:115], v[114:115], v[66:67]
  v_cvt_pk_bf16_f32 v112, v112, v113
  v_cvt_pk_bf16_f32 v114, v114, v115
  v_and_b32 v113, s6, v112
  v_and_b32 v115, s6, v114
  v_lshlrev_b32 v112, 16, v112
  v_lshlrev_b32 v114, 16, v114
  v_pk_add_f32 v[112:113], v[112:113], v[16:17]
  v_pk_add_f32 v[114:115], v[114:115], v[18:19]
  v_cvt_pk_bf16_f32 v112, v112, v113
  v_cvt_pk_bf16_f32 v114, v114, v115
  v_and_b32 v113, s6, v112
  v_and_b32 v115, s6, v114
  v_lshlrev_b32 v112, 16, v112
  v_lshlrev_b32 v114, 16, v114
  v_pk_add_f32 v[112:113], v[112:113], v[28:29]
  v_pk_add_f32 v[114:115], v[114:115], v[30:31]
  v_cvt_pk_bf16_f32 v112, v112, v113
  v_cvt_pk_bf16_f32 v113, v114, v115
  buffer_store_dwordx2 v[112:113], v10, s[48:51], s61 offen offset:0
  s_waitcnt lgkmcnt(0)
  s_barrier
  ds_read_b128 v[68:71], v12 offset:25600
  ds_read_b128 v[72:75], v12 offset:27648
  ds_read_b128 v[76:79], v12 offset:29696
  s_waitcnt lgkmcnt(2)
  v_pk_add_f32 v[128:129], v[128:129], v[68:69]
  v_pk_add_f32 v[130:131], v[130:131], v[70:71]
  s_waitcnt lgkmcnt(1)
  v_pk_add_f32 v[128:129], v[128:129], v[72:73]
  v_pk_add_f32 v[130:131], v[130:131], v[74:75]
  s_waitcnt lgkmcnt(0)
  v_pk_add_f32 v[128:129], v[128:129], v[76:77]
  v_pk_add_f32 v[130:131], v[130:131], v[78:79]
  v_cvt_pk_bf16_f32 v128, v128, v129
  v_cvt_pk_bf16_f32 v130, v130, v131
  v_and_b32 v129, s6, v128
  v_and_b32 v131, s6, v130
  v_lshlrev_b32 v128, 16, v128
  v_lshlrev_b32 v130, 16, v130
  v_pk_add_f32 v[128:129], v[128:129], v[16:17]
  v_pk_add_f32 v[130:131], v[130:131], v[18:19]
  v_cvt_pk_bf16_f32 v128, v128, v129
  v_cvt_pk_bf16_f32 v130, v130, v131
  v_and_b32 v129, s6, v128
  v_and_b32 v131, s6, v130
  v_lshlrev_b32 v128, 16, v128
  v_lshlrev_b32 v130, 16, v130
  v_pk_add_f32 v[128:129], v[128:129], v[32:33]
  v_pk_add_f32 v[130:131], v[130:131], v[34:35]
  v_cvt_pk_bf16_f32 v128, v128, v129
  v_cvt_pk_bf16_f32 v129, v130, v131
  buffer_store_dwordx2 v[128:129], v10, s[48:51], s61 offen offset:1024
k_exit:
  s_endpgm
code_end:
slow_entry:
  s_waitcnt vmcnt(0) lgkmcnt(0)
  buffer_load_dwordx4 v157, s[20:23], s15 offen offset:0 sc1 lds
  s_add_u32 s15, s15, 64512
  buffer_load_dwordx4 v157, s[20:23], s15 offen offset:1024 sc1 lds
  s_add_u32 s15, s15, 64512
  buffer_load_dwordx4 v157, s[20:23], s15 offen offset:2048 sc1 lds
  s_add_u32 s15, s15, 64512
  buffer_load_dwordx4 v157, s[20:23], s15 offen offset:3072 sc1 lds
  s_and_b32 s61, s5, 15
  s_or_b32 s61, s61, s3
  s_cbranch_scc1 s_nosig
  v_mov_b32 v17, 1
  s_lshl_b32 s61, s4, 2
  s_lshl_b32 s62, s5, 1
  s_add_u32 s61, s61, s62
  s_mov_b64 exec, 1
  buffer_store_dword v17, v66, s[52:55], s61 offen sc1
  s_mov_b64 exec, -1
s_nosig:
  buffer_load_dwordx2 v[16:17], v24, s[16:19], 0 offen offset:0 nt
  s_and_b32 s62, s5, 1
  v_lshlrev_b32 v10, 4, v0
  v_add_u32 v10, 149504, v10
  s_mov_b32 s14, 0
  s_mov_b32 s15, 0x80000000
  v_mov_b32 v12, 0
  v_mov_b32 v13, 0
  s_lshr_b32 s60, s5, 4
  s_lshl_b32 s60, s60, 2
  s_add_u32 s60, s60, s3
  s_lshl_b32 s61, s4, 3
  s_add_u32 s58, s60, s61
  s_cmp_lg_u32 s62, 0
  s_cbranch_scc1 s_cv_h1
s_cv_h0:
  s_waitcnt vmcnt(4)
  ds_read_b64_tr_b16 v[64:65], v4 offset:0
  ds_read_b64_tr_b16 v[66:67], v4 offset:32
  ds_read_b64_tr_b16 v[68:69], v4 offset:128
  ds_read_b64_tr_b16 v[70:71], v4 offset:160
  ds_read_b64_tr_b16 v[72:73], v4 offset:256
  ds_read_b64_tr_b16 v[74:75], v4 offset:288
  ds_read_b64_tr_b16 v[76:77], v4 offset:384
  ds_read_b64_tr_b16 v[78:79], v4 offset:416
  ds_read_b64_tr_b16 v[80:81], v4 offset:512
  ds_read_b64_tr_b16 v[82:83], v4 offset:544
  s_waitcnt lgkmcnt(8)
  v_mfma_f32_16x16x32_bf16 v[32:35], v[64:67], v[192:195], 0
  ds_read_b64_tr_b16 v[84:85], v4 offset:640
  s_waitcnt lgkmcnt(7)
  v_mfma_f32_16x16x32_bf16 v[36:39], v[68:71], v[192:195], 0
  ds_read_b64_tr_b16 v[86:87], v4 offset:672
  ds_read_b64_tr_b16 v[88:89], v4 offset:768
  v_mfma_f32_16x16x32_bf16 v[40:43], v[64:67], v[196:199], 0
  ds_read_b64_tr_b16 v[90:91], v4 offset:800
  ds_read_u16_d16_hi v12, v7 offset:0
  v_mfma_f32_16x16x32_bf16 v[44:47], v[68:71], v[196:199], 0
  ds_read_u16_d16_hi v13, v7 offset:128
  s_waitcnt lgkmcnt(10)
  v_mfma_f32_16x16x32_bf16 v[40:43], v[72:75], v[192:195], v[40:43]
  ds_read_b64_tr_b16 v[92:93], v4 offset:896
  s_waitcnt lgkmcnt(7)
  v_mfma_f32_16x16x32_bf16 v[44:47], v[76:79], v[192:195], v[44:47]
  ds_read_b64_tr_b16 v[94:95], v4 offset:928
  s_waitcnt vmcnt(3)
  ds_read_b64_tr_b16 v[100:101], v4 offset:1152
  v_mfma_f32_16x16x32_bf16 v[48:51], v[64:67], v[200:203], 0
  ds_read_b64_tr_b16 v[102:103], v4 offset:1184
  buffer_load_dwordx2 v[18:19], v24, s[16:19], 0 offen offset:1024 nt
  v_mfma_f32_16x16x32_bf16 v[52:55], v[68:71], v[200:203], 0
  v_cndmask_b32 v57, v39, v35, s[14:15]
  v_add_f32_dpp v34, v35, v34 wave_shr:1 row_mask:0xf bank_mask:0xf bound_ctrl:0
  v_mfma_f32_16x16x32_bf16 v[48:51], v[72:75], v[196:199], v[48:51]
  v_add_f32_dpp v38, v57, v38 wave_ror:1 row_mask:0xf bank_mask:0xf
  v_cndmask_b32 v57, v38, v34, s[14:15]
  v_mfma_f32_16x16x32_bf16 v[52:55], v[76:79], v[196:199], v[52:55]
  v_add_f32_dpp v33, v34, v33 wave_shr:1 row_mask:0xf bank_mask:0xf bound_ctrl:0
  v_add_f32_dpp v37, v57, v37 wave_ror:1 row_mask:0xf bank_mask:0xf
  v_mfma_f32_16x16x32_bf16 v[48:51], v[80:83], v[192:195], v[48:51]
  ds_read_b64_tr_b16 v[108:109], v4 offset:1408
  s_waitcnt lgkmcnt(3)
  v_mfma_f32_16x16x32_bf16 v[52:55], v[84:87], v[192:195], v[52:55]
  ds_read_b64_tr_b16 v[110:111], v4 offset:1440
  ds_read_b64_tr_b16 v[116:117], v4 offset:1664
  v_mfma_f32_16x16x32_bf16 v[224:227], v[64:67], v[204:207], 0
  ds_read_b64_tr_b16 v[118:119], v4 offset:1696
  buffer_load_dwordx2 v[20:21], v24, s[16:19], 0 offen offset:128 nt
  v_mfma_f32_16x16x32_bf16 v[228:231], v[68:71], v[204:207], 0
  v_cndmask_b32 v57, v37, v33, s[14:15]
  v_add_f32_dpp v32, v33, v32 wave_shr:1 row_mask:0xf bank_mask:0xf bound_ctrl:0
  v_mfma_f32_16x16x32_bf16 v[224:227], v[72:75], v[200:203], v[224:227]
  v_add_f32_dpp v36, v57, v36 wave_ror:1 row_mask:0xf bank_mask:0xf
  v_fma_f32 v58, v12, s59, v32
  v_mfma_f32_16x16x32_bf16 v[228:231], v[76:79], v[200:203], v[228:231]
  v_fma_f32 v59, v13, s59, v36
  v_cvt_pk_bf16_f32 v58, v58, v59
  v_mfma_f32_16x16x32_bf16 v[224:227], v[80:83], v[196:199], v[224:227]
  ds_write_b16 v6, v58 offset:0
  ds_write_b16_d16_hi v6, v58 offset:512
  v_mfma_f32_16x16x32_bf16 v[228:231], v[84:87], v[196:199], v[228:231]
  ds_read_u16_d16_hi v12, v7 offset:256
  ds_read_u16_d16_hi v13, v7 offset:384
  v_mfma_f32_16x16x32_bf16 v[224:227], v[88:91], v[192:195], v[224:227]
  ds_read_b64_tr_b16 v[124:125], v4 offset:1920
  ds_read_b64_tr_b16 v[126:127], v4 offset:1952
  v_mfma_f32_16x16x32_bf16 v[228:231], v[92:95], v[192:195], v[228:231]
  s_waitcnt vmcnt(4)
  ds_read_b64_tr_b16 v[132:133], v4 offset:2176
  v_mfma_f32_16x16x32_bf16 v[232:235], v[68:71], a[236:239], 0
  buffer_load_dwordx2 v[22:23], v24, s[16:19], 0 offen offset:1152 nt
  v_cndmask_b32 v56, v43, v39, s[14:15]
  v_mfma_f32_16x16x32_bf16 v[232:235], v[76:79], a[232:235], v[232:235]
  v_cndmask_b32 v57, v47, v43, s[14:15]
  v_add_f32_dpp v42, v56, v42 wave_ror:1 row_mask:0xf bank_mask:0xf
  v_mfma_f32_16x16x32_bf16 v[232:235], v[84:87], a[228:231], v[232:235]
  v_add_f32_dpp v46, v57, v46 wave_ror:1 row_mask:0xf bank_mask:0xf
  v_cndmask_b32 v56, v42, v38, s[14:15]
  v_mfma_f32_16x16x32_bf16 v[232:235], v[92:95], a[224:227], v[232:235]
  v_cndmask_b32 v57, v46, v42, s[14:15]
  s_waitcnt lgkmcnt(1)
  v_mfma_f32_16x16x32_bf16 v[232:235], v[100:103], v[220:223], v[232:235]
  ds_read_b64_tr_b16 v[134:135], v4 offset:2208
  ds_read_b64_tr_b16 v[140:141], v4 offset:2432
  v_mfma_f32_16x16x32_bf16 v[232:235], v[108:111], v[216:219], v[232:235]
  ds_read_b64_tr_b16 v[142:143], v4 offset:2464
  ds_read_b64_tr_b16 v[148:149], v4 offset:2688
  v_mfma_f32_16x16x32_bf16 v[232:235], v[116:119], v[212:215], v[232:235]
  ds_read_b64_tr_b16 v[150:151], v4 offset:2720
  ds_read_b64_tr_b16 v[156:157], v4 offset:2944
  v_mfma_f32_16x16x32_bf16 v[232:235], v[124:127], v[208:211], v[232:235]
  ds_read_b64_tr_b16 v[158:159], v4 offset:2976
  s_waitcnt lgkmcnt(6)
  v_mfma_f32_16x16x32_bf16 v[232:235], v[132:135], v[204:207], v[232:235]
  ds_read_b64_tr_b16 v[96:97], v4 offset:1024
  s_waitcnt lgkmcnt(5)
  v_mfma_f32_16x16x32_bf16 v[232:235], v[140:143], v[200:203], v[232:235]
  ds_read_b64_tr_b16 v[98:99], v4 offset:1056
  s_waitcnt lgkmcnt(4)
  v_mfma_f32_16x16x32_bf16 v[232:235], v[148:151], v[196:199], v[232:235]
  ds_read_b64_tr_b16 v[104:105], v4 offset:1280
  s_waitcnt lgkmcnt(3)
  v_mfma_f32_16x16x32_bf16 v[232:235], v[156:159], v[192:195], v[232:235]
  ds_read_b64_tr_b16 v[106:107], v4 offset:1312
  ds_read_b64_tr_b16 v[112:113], v4 offset:1536
  v_mfma_f32_16x16x32_bf16 v[236:239], v[64:67], a[240:243], 0
  ds_read_b64_tr_b16 v[114:115], v4 offset:1568
  ds_read_b64_tr_b16 v[120:121], v4 offset:1792
  v_mfma_f32_16x16x32_bf16 v[240:243], v[68:71], a[240:243], 0
  ds_read_b64_tr_b16 v[122:123], v4 offset:1824
  ds_read_b64_tr_b16 v[128:129], v4 offset:2048
  v_mfma_f32_16x16x32_bf16 v[236:239], v[72:75], a[236:239], v[236:239]
  ds_read_b64_tr_b16 v[130:131], v4 offset:2080
  buffer_load_dword v25, v25, s[20:23], 0 offen
  v_mfma_f32_16x16x32_bf16 v[240:243], v[76:79], a[236:239], v[240:243]
  v_add_f32_dpp v41, v56, v41 wave_ror:1 row_mask:0xf bank_mask:0xf
  v_add_f32_dpp v45, v57, v45 wave_ror:1 row_mask:0xf bank_mask:0xf
  v_mfma_f32_16x16x32_bf16 v[236:239], v[80:83], a[232:235], v[236:239]
  buffer_load_dword v28, v26, s[36:39], 0 offen
  v_cndmask_b32 v56, v41, v37, s[14:15]
  v_mfma_f32_16x16x32_bf16 v[240:243], v[84:87], a[232:235], v[240:243]
  v_cndmask_b32 v57, v45, v41, s[14:15]
  v_add_f32_dpp v40, v56, v40 wave_ror:1 row_mask:0xf bank_mask:0xf
  v_mfma_f32_16x16x32_bf16 v[236:239], v[88:91], a[228:231], v[236:239]
  v_add_f32_dpp v44, v57, v44 wave_ror:1 row_mask:0xf bank_mask:0xf
  v_fma_f32 v58, v12, s59, v40
  v_mfma_f32_16x16x32_bf16 v[240:243], v[92:95], a[228:231], v[240:243]
  v_fma_f32 v59, v13, s59, v44
  s_waitcnt lgkmcnt(0)
  v_mfma_f32_16x16x32_bf16 v[236:239], v[96:99], a[224:227], v[236:239]
  ds_read_b64_tr_b16 v[136:137], v4 offset:2304
  ds_read_b64_tr_b16 v[138:139], v4 offset:2336
  v_mfma_f32_16x16x32_bf16 v[240:243], v[100:103], a[224:227], v[240:243]
  v_cvt_pk_bf16_f32 v58, v58, v59
  ds_write_b16 v6, v58 offset:1024
  v_mfma_f32_16x16x32_bf16 v[236:239], v[104:107], v[220:223], v[236:239]
  ds_read_b64_tr_b16 v[144:145], v4 offset:2560
  ds_read_b64_tr_b16 v[146:147], v4 offset:2592
  v_mfma_f32_16x16x32_bf16 v[240:243], v[108:111], v[220:223], v[240:243]
  ds_write_b16_d16_hi v6, v58 offset:1536
  ds_read_u16_d16_hi v12, v7 offset:512
  v_mfma_f32_16x16x32_bf16 v[236:239], v[112:115], v[216:219], v[236:239]
  ds_read_b64_tr_b16 v[152:153], v4 offset:2816
  ds_read_b64_tr_b16 v[154:155], v4 offset:2848
  v_mfma_f32_16x16x32_bf16 v[240:243], v[116:119], v[216:219], v[240:243]
  buffer_load_dword v29, v29, s[36:39], 0 offen
  ds_read_u16_d16_hi v13, v7 offset:640
  v_mfma_f32_16x16x32_bf16 v[236:239], v[120:123], v[212:215], v[236:239]
  s_waitcnt vmcnt(7)
  ds_read_b64_tr_b16 v[160:161], v4 offset:3072
  v_mfma_f32_16x16x32_bf16 v[240:243], v[124:127], v[212:215], v[240:243]
  ds_read_b64_tr_b16 v[162:163], v4 offset:3104
  v_cndmask_b32 v56, v51, v47, s[14:15]
  v_mfma_f32_16x16x32_bf16 v[236:239], v[128:131], v[208:211], v[236:239]
  ds_read_b64_tr_b16 v[164:165], v4 offset:3200
  v_cndmask_b32 v57, v55, v51, s[14:15]
  v_mfma_f32_16x16x32_bf16 v[240:243], v[132:135], v[208:211], v[240:243]
  v_add_f32_dpp v50, v56, v50 wave_ror:1 row_mask:0xf bank_mask:0xf
  s_waitcnt lgkmcnt(4)
  v_mfma_f32_16x16x32_bf16 v[236:239], v[136:139], v[204:207], v[236:239]
  ds_read_b64_tr_b16 v[166:167], v4 offset:3232
  ds_read_b64_tr_b16 v[168:169], v4 offset:3328
  v_mfma_f32_16x16x32_bf16 v[240:243], v[140:143], v[204:207], v[240:243]
  ds_read_b64_tr_b16 v[170:171], v4 offset:3360
  v_add_f32_dpp v54, v57, v54 wave_ror:1 row_mask:0xf bank_mask:0xf
  v_mfma_f32_16x16x32_bf16 v[236:239], v[144:147], v[200:203], v[236:239]
  ds_read_b64_tr_b16 v[172:173], v4 offset:3456
  ds_read_b64_tr_b16 v[174:175], v4 offset:3488
  v_mfma_f32_16x16x32_bf16 v[240:243], v[148:151], v[200:203], v[240:243]
  s_add_u32 s31, s31, 1
  s_and_b32 s31, s31, 7
  v_mfma_f32_16x16x32_bf16 v[236:239], v[152:155], v[196:199], v[236:239]
  ds_read_b64_tr_b16 v[176:177], v4 offset:3584
  ds_read_b64_tr_b16 v[178:179], v4 offset:3616
  v_mfma_f32_16x16x32_bf16 v[240:243], v[156:159], v[196:199], v[240:243]
  s_mul_i32 s30, s31, 3584
  s_waitcnt lgkmcnt(6)
  v_mfma_f32_16x16x32_bf16 v[236:239], v[160:163], v[192:195], v[236:239]
  ds_read_b64_tr_b16 v[180:181], v4 offset:3712
  ds_read_b64_tr_b16 v[182:183], v4 offset:3744
  v_mfma_f32_16x16x32_bf16 v[240:243], v[164:167], v[192:195], v[240:243]
  ds_read_b64_tr_b16 v[184:185], v4 offset:3840
  ds_read_b64_tr_b16 v[186:187], v4 offset:3872
  v_mfma_f32_16x16x32_bf16 v[244:247], v[64:67], a[244:247], 0
  s_add_u32 m0, s30, s29
  s_lshl4_add_u32 s30, s30, s28
  v_mfma_f32_16x16x32_bf16 v[248:251], v[68:71], a[244:247], 0
  buffer_load_dwordx4 v15, s[32:35], s30 offen offset:0 lds
  v_cndmask_b32 v56, v50, v46, s[14:15]
  v_mfma_f32_16x16x32_bf16 v[244:247], v[72:75], a[240:243], v[244:247]
  s_add_u32 s30, s30, 13440
  buffer_load_dwordx4 v15, s[32:35], s30 offen offset:896 lds
  v_mfma_f32_16x16x32_bf16 v[248:251], v[76:79], a[240:243], v[248:251]
  v_cndmask_b32 v57, v54, v50, s[14:15]
  v_add_f32_dpp v49, v56, v49 wave_ror:1 row_mask:0xf bank_mask:0xf
  v_mfma_f32_16x16x32_bf16 v[244:247], v[80:83], a[236:239], v[244:247]
  v_add_f32_dpp v53, v57, v53 wave_ror:1 row_mask:0xf bank_mask:0xf
  v_cndmask_b32 v56, v49, v45, s[14:15]
  v_mfma_f32_16x16x32_bf16 v[248:251], v[84:87], a[236:239], v[248:251]
  v_cndmask_b32 v57, v53, v49, s[14:15]
  v_add_f32_dpp v48, v56, v48 wave_ror:1 row_mask:0xf bank_mask:0xf
  v_mfma_f32_16x16x32_bf16 v[244:247], v[88:91], a[232:235], v[244:247]
  v_add_f32_dpp v52, v57, v52 wave_ror:1 row_mask:0xf bank_mask:0xf
  v_fma_f32 v58, v12, s59, v48
  v_mfma_f32_16x16x32_bf16 v[248:251], v[92:95], a[232:235], v[248:251]
  v_fma_f32 v59, v13, s59, v52
  v_cvt_pk_bf16_f32 v58, v58, v59
  v_mfma_f32_16x16x32_bf16 v[244:247], v[96:99], a[228:231], v[244:247]
  ds_write_b16 v6, v58 offset:2048
  ds_write_b16_d16_hi v6, v58 offset:2560
  v_mfma_f32_16x16x32_bf16 v[248:251], v[100:103], a[228:231], v[248:251]
  ds_read_u16_d16_hi v12, v7 offset:768
  ds_read_u16_d16_hi v13, v7 offset:896
  v_mfma_f32_16x16x32_bf16 v[244:247], v[104:107], a[224:227], v[244:247]
  s_add_u32 s30, s30, 13440
  buffer_load_dwordx4 v15, s[32:35], s30 offen offset:1792 lds
  v_mfma_f32_16x16x32_bf16 v[248:251], v[108:111], a[224:227], v[248:251]
  v_cndmask_b32 v56, v227, v55, s[14:15]
  v_cndmask_b32 v57, v231, v227, s[14:15]
  v_mfma_f32_16x16x32_bf16 v[244:247], v[112:115], v[220:223], v[244:247]
  v_add_f32_dpp v226, v56, v226 wave_ror:1 row_mask:0xf bank_mask:0xf
  v_add_f32_dpp v230, v57, v230 wave_ror:1 row_mask:0xf bank_mask:0xf
  v_mfma_f32_16x16x32_bf16 v[248:251], v[116:119], v[220:223], v[248:251]
  v_cndmask_b32 v56, v226, v54, s[14:15]
  v_cndmask_b32 v57, v230, v226, s[14:15]
  v_mfma_f32_16x16x32_bf16 v[244:247], v[120:123], v[216:219], v[244:247]
  v_add_f32_dpp v225, v56, v225 wave_ror:1 row_mask:0xf bank_mask:0xf
  v_add_f32_dpp v229, v57, v229 wave_ror:1 row_mask:0xf bank_mask:0xf
  v_mfma_f32_16x16x32_bf16 v[248:251], v[124:127], v[216:219], v[248:251]
  v_cndmask_b32 v56, v225, v53, s[14:15]
  v_cndmask_b32 v57, v229, v225, s[14:15]
  v_mfma_f32_16x16x32_bf16 v[244:247], v[128:131], v[212:215], v[244:247]
  v_add_f32_dpp v224, v56, v224 wave_ror:1 row_mask:0xf bank_mask:0xf
  v_add_f32_dpp v228, v57, v228 wave_ror:1 row_mask:0xf bank_mask:0xf
  v_mfma_f32_16x16x32_bf16 v[248:251], v[132:135], v[212:215], v[248:251]
  s_waitcnt lgkmcnt(1)
  v_fma_f32 v58, v12, s59, v224
  v_mfma_f32_16x16x32_bf16 v[244:247], v[136:139], v[208:211], v[244:247]
  s_add_u32 s30, s30, 13440
  ds_read_b64_tr_b16 v[188:189], v4 offset:3968
  v_mfma_f32_16x16x32_bf16 v[248:251], v[140:143], v[208:211], v[248:251]
  s_mov_b32 exec_hi, 0x00ffffff
  buffer_load_dwordx4 v15, s[32:35], s30 offen offset:2688 lds
  s_mov_b32 exec_hi, -1
  v_mfma_f32_16x16x32_bf16 v[244:247], v[144:147], v[204:207], v[244:247]
  s_waitcnt lgkmcnt(1)
  v_fma_f32 v59, v13, s59, v228
  v_mfma_f32_16x16x32_bf16 v[248:251], v[148:151], v[204:207], v[248:251]
  v_cvt_pk_bf16_f32 v58, v58, v59
  ds_write_b16 v6, v58 offset:3072
  v_mfma_f32_16x16x32_bf16 v[244:247], v[152:155], v[200:203], v[244:247]
  ds_write_b16_d16_hi v6, v58 offset:3584
  v_add_f32_dpp v234, v235, v234 wave_shr:1 row_mask:0xf bank_mask:0xf bound_ctrl:0
  v_mfma_f32_16x16x32_bf16 v[248:251], v[156:159], v[200:203], v[248:251]
  s_nop 0
  v_add_f32_dpp v233, v234, v233 wave_shr:1 row_mask:0xf bank_mask:0xf bound_ctrl:0
  v_mfma_f32_16x16x32_bf16 v[244:247], v[160:163], v[196:199], v[244:247]
  ds_read_u16_d16_hi v12, v7 offset:3072
  ds_read_u16_d16_hi v13, v7 offset:3200
  v_mfma_f32_16x16x32_bf16 v[248:251], v[164:167], v[196:199], v[248:251]
  v_cndmask_b32 v56, v239, v235, s[14:15]
  v_cndmask_b32 v57, v243, v239, s[14:15]
  v_mfma_f32_16x16x32_bf16 v[244:247], v[168:171], v[192:195], v[244:247]
  ds_read_b64_tr_b16 v[190:191], v4 offset:4000
  buffer_load_dword v30, v11, s[52:55], 0 offen sc1
  v_mfma_f32_16x16x32_bf16 v[248:251], v[172:175], v[192:195], v[248:251]
  v_add_f32_dpp v238, v56, v238 wave_ror:1 row_mask:0xf bank_mask:0xf
  v_add_f32_dpp v242, v57, v242 wave_ror:1 row_mask:0xf bank_mask:0xf
  v_mfma_f32_16x16x32_bf16 v[252:255], v[64:67], a[248:251], 0
  v_cndmask_b32 v56, v238, v234, s[14:15]
  v_cndmask_b32 v57, v242, v238, s[14:15]
  v_mfma_f32_16x16x32_bf16 v[32:35], v[68:71], a[248:251], 0
  v_add_f32_dpp v237, v56, v237 wave_ror:1 row_mask:0xf bank_mask:0xf
  v_add_f32_dpp v241, v57, v241 wave_ror:1 row_mask:0xf bank_mask:0xf
  v_mfma_f32_16x16x32_bf16 v[252:255], v[72:75], a[244:247], v[252:255]
  v_cndmask_b32 v56, v237, v233, s[14:15]
  v_cndmask_b32 v57, v241, v237, s[14:15]
  v_mfma_f32_16x16x32_bf16 v[32:35], v[76:79], a[244:247], v[32:35]
  v_add_f32_dpp v236, v56, v236 wave_ror:1 row_mask:0xf bank_mask:0xf
  v_add_f32_dpp v240, v57, v240 wave_ror:1 row_mask:0xf bank_mask:0xf
  v_mfma_f32_16x16x32_bf16 v[252:255], v[80:83], a[240:243], v[252:255]
  s_waitcnt lgkmcnt(2)
  v_fma_f32 v58, v12, s59, v236
  v_mfma_f32_16x16x32_bf16 v[32:35], v[84:87], a[240:243], v[32:35]
  s_waitcnt lgkmcnt(1)
  v_fma_f32 v59, v13, s59, v240
  v_mfma_f32_16x16x32_bf16 v[252:255], v[88:91], a[236:239], v[252:255]
  s_add_u32 s31, s31, 1
  s_and_b32 s31, s31, 7
  v_mfma_f32_16x16x32_bf16 v[32:35], v[92:95], a[236:239], v[32:35]
  s_mul_i32 s30, s31, 3584
  s_add_u32 m0, s30, s29
  v_mfma_f32_16x16x32_bf16 v[252:255], v[96:99], a[232:235], v[252:255]
  s_lshl4_add_u32 s30, s30, s28
  buffer_load_dwordx4 v15, s[32:35], s30 offen offset:0 lds
  v_mfma_f32_16x16x32_bf16 v[32:35], v[100:103], a[232:235], v[32:35]
  v_cvt_pk_bf16_f32 v58, v58, v59
  ds_write_b16 v6, v58 offset:4096
  v_mfma_f32_16x16x32_bf16 v[252:255], v[104:107], a[228:231], v[252:255]
  ds_write_b16_d16_hi v6, v58 offset:4608
  ds_read_u16_d16_hi v12, v7 offset:3328
  v_mfma_f32_16x16x32_bf16 v[32:35], v[108:111], a[228:231], v[32:35]
  ds_read_u16_d16_hi v13, v7 offset:3456
  v_cndmask_b32 v56, v247, v243, s[14:15]
  v_mfma_f32_16x16x32_bf16 v[252:255], v[112:115], a[224:227], v[252:255]
  v_cndmask_b32 v57, v251, v247, s[14:15]
  v_add_f32_dpp v246, v56, v246 wave_ror:1 row_mask:0xf bank_mask:0xf
  v_mfma_f32_16x16x32_bf16 v[32:35], v[116:119], a[224:227], v[32:35]
  v_add_f32_dpp v250, v57, v250 wave_ror:1 row_mask:0xf bank_mask:0xf
  v_cndmask_b32 v56, v246, v242, s[14:15]
  v_mfma_f32_16x16x32_bf16 v[252:255], v[120:123], v[220:223], v[252:255]
  s_add_u32 s30, s30, 13440
  buffer_load_dwordx4 v15, s[32:35], s30 offen offset:896 lds
  v_mfma_f32_16x16x32_bf16 v[32:35], v[124:127], v[220:223], v[32:35]
  v_cndmask_b32 v57, v250, v246, s[14:15]
  v_add_f32_dpp v245, v56, v245 wave_ror:1 row_mask:0xf bank_mask:0xf
  v_mfma_f32_16x16x32_bf16 v[252:255], v[128:131], v[216:219], v[252:255]
  v_add_f32_dpp v249, v57, v249 wave_ror:1 row_mask:0xf bank_mask:0xf
  v_cndmask_b32 v56, v245, v241, s[14:15]
  v_mfma_f32_16x16x32_bf16 v[32:35], v[132:135], v[216:219], v[32:35]
  v_cndmask_b32 v57, v249, v245, s[14:15]
  v_add_f32_dpp v244, v56, v244 wave_ror:1 row_mask:0xf bank_mask:0xf
  v_mfma_f32_16x16x32_bf16 v[252:255], v[136:139], v[212:215], v[252:255]
  v_add_f32_dpp v248, v57, v248 wave_ror:1 row_mask:0xf bank_mask:0xf
  v_mfma_f32_16x16x32_bf16 v[32:35], v[140:143], v[212:215], v[32:35]
  s_waitcnt lgkmcnt(1)
  v_fma_f32 v58, v12, s59, v244
  v_mfma_f32_16x16x32_bf16 v[252:255], v[144:147], v[208:211], v[252:255]
  s_waitcnt lgkmcnt(0)
  v_fma_f32 v59, v13, s59, v248
  v_mfma_f32_16x16x32_bf16 v[32:35], v[148:151], v[208:211], v[32:35]
  v_cvt_pk_bf16_f32 v58, v58, v59
  ds_write_b16 v6, v58 offset:5120
  v_mfma_f32_16x16x32_bf16 v[252:255], v[152:155], v[204:207], v[252:255]
  s_add_u32 s30, s30, 13440
  buffer_load_dwordx4 v15, s[32:35], s30 offen offset:1792 lds
  v_mfma_f32_16x16x32_bf16 v[32:35], v[156:159], v[204:207], v[32:35]
  ds_write_b16_d16_hi v6, v58 offset:5632
  v_mfma_f32_16x16x32_bf16 v[252:255], v[160:163], v[200:203], v[252:255]
  v_mfma_f32_16x16x32_bf16 v[32:35], v[164:167], v[200:203], v[32:35]
  v_mfma_f32_16x16x32_bf16 v[252:255], v[168:171], v[196:199], v[252:255]
  v_mfma_f32_16x16x32_bf16 v[32:35], v[172:175], v[196:199], v[32:35]
  v_mfma_f32_16x16x32_bf16 v[252:255], v[176:179], v[192:195], v[252:255]
  v_mfma_f32_16x16x32_bf16 v[32:35], v[180:183], v[192:195], v[32:35]
  v_mfma_f32_16x16x32_bf16 v[36:39], v[64:67], a[252:255], 0
  s_add_u32 s30, s30, 13440
  ds_read_u16_d16_hi v12, v7 offset:3584
  v_mfma_f32_16x16x32_bf16 v[40:43], v[68:71], a[252:255], 0
  s_mov_b32 exec_hi, 0x00ffffff
  buffer_load_dwordx4 v15, s[32:35], s30 offen offset:2688 lds
  s_mov_b32 exec_hi, -1
  v_mfma_f32_16x16x32_bf16 v[36:39], v[72:75], a[248:251], v[36:39]
  ds_read_u16_d16_hi v13, v7 offset:3712
  v_mfma_f32_16x16x32_bf16 v[40:43], v[76:79], a[248:251], v[40:43]
  v_cndmask_b32 v56, v255, v251, s[14:15]
  v_cndmask_b32 v57, v35, v255, s[14:15]
  v_mfma_f32_16x16x32_bf16 v[36:39], v[80:83], a[244:247], v[36:39]
  v_add_f32_dpp v254, v56, v254 wave_ror:1 row_mask:0xf bank_mask:0xf
  v_add_f32_dpp v34, v57, v34 wave_ror:1 row_mask:0xf bank_mask:0xf
  v_mfma_f32_16x16x32_bf16 v[40:43], v[84:87], a[244:247], v[40:43]
  v_cndmask_b32 v56, v254, v250, s[14:15]
  v_cndmask_b32 v57, v34, v254, s[14:15]
  v_mfma_f32_16x16x32_bf16 v[36:39], v[88:91], a[240:243], v[36:39]
  v_add_f32_dpp v253, v56, v253 wave_ror:1 row_mask:0xf bank_mask:0xf
  v_add_f32_dpp v33, v57, v33 wave_ror:1 row_mask:0xf bank_mask:0xf
  v_mfma_f32_16x16x32_bf16 v[40:43], v[92:95], a[240:243], v[40:43]
  v_cndmask_b32 v56, v253, v249, s[14:15]
  v_cndmask_b32 v57, v33, v253, s[14:15]
  v_mfma_f32_16x16x32_bf16 v[36:39], v[96:99], a[236:239], v[36:39]
  v_add_f32_dpp v252, v56, v252 wave_ror:1 row_mask:0xf bank_mask:0xf
  v_add_f32_dpp v32, v57, v32 wave_ror:1 row_mask:0xf bank_mask:0xf
  v_mfma_f32_16x16x32_bf16 v[40:43], v[100:103], a[236:239], v[40:43]
  s_waitcnt lgkmcnt(1)
  v_fma_f32 v58, v12, s59, v252
  v_mfma_f32_16x16x32_bf16 v[36:39], v[104:107], a[232:235], v[36:39]
  s_waitcnt lgkmcnt(0)
  v_fma_f32 v59, v13, s59, v32
  v_mfma_f32_16x16x32_bf16 v[40:43], v[108:111], a[232:235], v[40:43]
  v_cvt_pk_bf16_f32 v58, v58, v59
  ds_write_b16 v6, v58 offset:6144
  v_mfma_f32_16x16x32_bf16 v[36:39], v[112:115], a[228:231], v[36:39]
  ds_write_b16_d16_hi v6, v58 offset:6656
  v_mfma_f32_16x16x32_bf16 v[40:43], v[116:119], a[228:231], v[40:43]
  v_mfma_f32_16x16x32_bf16 v[36:39], v[120:123], a[224:227], v[36:39]
  v_mfma_f32_16x16x32_bf16 v[40:43], v[124:127], a[224:227], v[40:43]
  v_mfma_f32_16x16x32_bf16 v[36:39], v[128:131], v[220:223], v[36:39]
  v_mfma_f32_16x16x32_bf16 v[40:43], v[132:135], v[220:223], v[40:43]
  v_mfma_f32_16x16x32_bf16 v[36:39], v[136:139], v[216:219], v[36:39]
  v_mfma_f32_16x16x32_bf16 v[40:43], v[140:143], v[216:219], v[40:43]
  v_mfma_f32_16x16x32_bf16 v[36:39], v[144:147], v[212:215], v[36:39]
  v_mfma_f32_16x16x32_bf16 v[40:43], v[148:151], v[212:215], v[40:43]
  v_mfma_f32_16x16x32_bf16 v[36:39], v[152:155], v[208:211], v[36:39]
  v_mfma_f32_16x16x32_bf16 v[40:43], v[156:159], v[208:211], v[40:43]
  v_mfma_f32_16x16x32_bf16 v[36:39], v[160:163], v[204:207], v[36:39]
  v_mfma_f32_16x16x32_bf16 v[40:43], v[164:167], v[204:207], v[40:43]
  v_mfma_f32_16x16x32_bf16 v[36:39], v[168:171], v[200:203], v[36:39]
  v_mfma_f32_16x16x32_bf16 v[40:43], v[172:175], v[200:203], v[40:43]
  v_mfma_f32_16x16x32_bf16 v[36:39], v[176:179], v[196:199], v[36:39]
  v_mfma_f32_16x16x32_bf16 v[40:43], v[180:183], v[196:199], v[40:43]
  v_mfma_f32_16x16x32_bf16 v[36:39], v[184:187], v[192:195], v[36:39]
  v_mfma_f32_16x16x32_bf16 v[40:43], v[188:191], v[192:195], v[40:43]
  ds_read_u16_d16_hi v12, v7 offset:3840
  ds_read_u16_d16_hi v13, v7 offset:3968
  s_nop 4
  v_cndmask_b32 v56, v39, v35, s[14:15]
  v_cndmask_b32 v57, v43, v39, s[14:15]
  s_nop 0
  v_add_f32_dpp v38, v56, v38 wave_ror:1 row_mask:0xf bank_mask:0xf
  v_add_f32_dpp v42, v57, v42 wave_ror:1 row_mask:0xf bank_mask:0xf
  v_cndmask_b32 v56, v38, v34, s[14:15]
  v_cndmask_b32 v57, v42, v38, s[14:15]
  s_nop 0
  v_add_f32_dpp v37, v56, v37 wave_ror:1 row_mask:0xf bank_mask:0xf
  v_add_f32_dpp v41, v57, v41 wave_ror:1 row_mask:0xf bank_mask:0xf
  v_cndmask_b32 v56, v37, v33, s[14:15]
  v_cndmask_b32 v57, v41, v37, s[14:15]
  s_nop 0
  v_add_f32_dpp v36, v56, v36 wave_ror:1 row_mask:0xf bank_mask:0xf
  v_add_f32_dpp v40, v57, v40 wave_ror:1 row_mask:0xf bank_mask:0xf
  s_waitcnt lgkmcnt(1)
  v_fma_f32 v58, v12, s59, v36
  s_waitcnt lgkmcnt(0)
  v_fma_f32 v59, v13, s59, v40
  v_cvt_pk_bf16_f32 v58, v58, v59
  ds_write_b16 v6, v58 offset:7168
  ds_write_b16_d16_hi v6, v58 offset:7680
  s_branch s_cv_join
s_cv_h1:
  s_waitcnt vmcnt(4)
  ds_read_b64_tr_b16 v[68:69], v4 offset:128
  ds_read_b64_tr_b16 v[70:71], v4 offset:160
  ds_read_b64_tr_b16 v[76:77], v4 offset:384
  ds_read_b64_tr_b16 v[78:79], v4 offset:416
  ds_read_b64_tr_b16 v[84:85], v4 offset:640
  ds_read_b64_tr_b16 v[86:87], v4 offset:672
  ds_read_b64_tr_b16 v[92:93], v4 offset:896
  ds_read_b64_tr_b16 v[94:95], v4 offset:928
  ds_read_b64_tr_b16 v[64:65], v4 offset:0
  ds_read_b64_tr_b16 v[66:67], v4 offset:32
  s_waitcnt lgkmcnt(8)
  v_mfma_f32_16x16x32_bf16 v[32:35], v[68:71], v[204:207], 0
  ds_read_b64_tr_b16 v[72:73], v4 offset:256
  s_waitcnt lgkmcnt(7)
  v_mfma_f32_16x16x32_bf16 v[32:35], v[76:79], v[200:203], v[32:35]
  ds_read_b64_tr_b16 v[74:75], v4 offset:288
  s_waitcnt lgkmcnt(6)
  v_mfma_f32_16x16x32_bf16 v[32:35], v[84:87], v[196:199], v[32:35]
  ds_read_b64_tr_b16 v[80:81], v4 offset:512
  s_waitcnt lgkmcnt(5)
  v_mfma_f32_16x16x32_bf16 v[32:35], v[92:95], v[192:195], v[32:35]
  ds_read_b64_tr_b16 v[82:83], v4 offset:544
  s_waitcnt lgkmcnt(4)
  v_mfma_f32_16x16x32_bf16 v[36:39], v[64:67], v[208:211], 0
  ds_read_b64_tr_b16 v[88:89], v4 offset:768
  ds_read_b64_tr_b16 v[90:91], v4 offset:800
  v_mfma_f32_16x16x32_bf16 v[40:43], v[68:71], v[208:211], 0
  s_waitcnt vmcnt(3)
  ds_read_b64_tr_b16 v[96:97], v4 offset:1024
  s_waitcnt lgkmcnt(5)
  v_mfma_f32_16x16x32_bf16 v[36:39], v[72:75], v[204:207], v[36:39]
  ds_read_b64_tr_b16 v[98:99], v4 offset:1056
  ds_read_b64_tr_b16 v[100:101], v4 offset:1152
  v_mfma_f32_16x16x32_bf16 v[40:43], v[76:79], v[204:207], v[40:43]
  ds_read_b64_tr_b16 v[102:103], v4 offset:1184
  s_waitcnt lgkmcnt(6)
  v_mfma_f32_16x16x32_bf16 v[36:39], v[80:83], v[200:203], v[36:39]
  ds_read_b64_tr_b16 v[104:105], v4 offset:1280
  ds_read_b64_tr_b16 v[106:107], v4 offset:1312
  v_mfma_f32_16x16x32_bf16 v[40:43], v[84:87], v[200:203], v[40:43]
  ds_read_b64_tr_b16 v[108:109], v4 offset:1408
  s_waitcnt lgkmcnt(7)
  v_mfma_f32_16x16x32_bf16 v[36:39], v[88:91], v[196:199], v[36:39]
  ds_read_b64_tr_b16 v[110:111], v4 offset:1440
  ds_read_b64_tr_b16 v[112:113], v4 offset:1536
  v_mfma_f32_16x16x32_bf16 v[40:43], v[92:95], v[196:199], v[40:43]
  ds_read_b64_tr_b16 v[114:115], v4 offset:1568
  s_waitcnt lgkmcnt(8)
  v_mfma_f32_16x16x32_bf16 v[36:39], v[96:99], v[192:195], v[36:39]
  ds_read_b64_tr_b16 v[116:117], v4 offset:1664
  s_waitcnt lgkmcnt(7)
  v_mfma_f32_16x16x32_bf16 v[40:43], v[100:103], v[192:195], v[40:43]
  ds_read_b64_tr_b16 v[118:119], v4 offset:1696
  ds_read_b64_tr_b16 v[120:121], v4 offset:1792
  v_mfma_f32_16x16x32_bf16 v[44:47], v[64:67], v[212:215], 0
  ds_read_b64_tr_b16 v[122:123], v4 offset:1824
  buffer_load_dwordx2 v[18:19], v24, s[16:19], 0 offen offset:1024 nt
  v_mfma_f32_16x16x32_bf16 v[48:51], v[68:71], v[212:215], 0
  buffer_load_dwordx2 v[20:21], v24, s[16:19], 0 offen offset:128 nt
  v_add_f32_dpp v34, v35, v34 wave_shr:1 row_mask:0xf bank_mask:0xf bound_ctrl:0
  v_mfma_f32_16x16x32_bf16 v[44:47], v[72:75], v[208:211], v[44:47]
  s_nop 0
  v_add_f32_dpp v33, v34, v33 wave_shr:1 row_mask:0xf bank_mask:0xf bound_ctrl:0
  v_mfma_f32_16x16x32_bf16 v[48:51], v[76:79], v[208:211], v[48:51]
  ds_read_u16_d16_hi v12, v7 offset:1024
  ds_read_u16_d16_hi v13, v7 offset:1152
  v_mfma_f32_16x16x32_bf16 v[44:47], v[80:83], v[204:207], v[44:47]
  v_cndmask_b32 v56, v39, v35, s[14:15]
  v_cndmask_b32 v57, v43, v39, s[14:15]
  v_mfma_f32_16x16x32_bf16 v[48:51], v[84:87], v[204:207], v[48:51]
  v_add_f32_dpp v38, v56, v38 wave_ror:1 row_mask:0xf bank_mask:0xf
  v_add_f32_dpp v42, v57, v42 wave_ror:1 row_mask:0xf bank_mask:0xf
  v_mfma_f32_16x16x32_bf16 v[44:47], v[88:91], v[200:203], v[44:47]
  buffer_load_dwordx2 v[22:23], v24, s[16:19], 0 offen offset:1152 nt
  v_cndmask_b32 v56, v38, v34, s[14:15]
  v_mfma_f32_16x16x32_bf16 v[48:51], v[92:95], v[200:203], v[48:51]
  v_cndmask_b32 v57, v42, v38, s[14:15]
  v_add_f32_dpp v37, v56, v37 wave_ror:1 row_mask:0xf bank_mask:0xf
  v_mfma_f32_16x16x32_bf16 v[44:47], v[96:99], v[196:199], v[44:47]
  v_add_f32_dpp v41, v57, v41 wave_ror:1 row_mask:0xf bank_mask:0xf
  v_cndmask_b32 v56, v37, v33, s[14:15]
  v_mfma_f32_16x16x32_bf16 v[48:51], v[100:103], v[196:199], v[48:51]
  v_cndmask_b32 v57, v41, v37, s[14:15]
  s_waitcnt lgkmcnt(2)
  v_mfma_f32_16x16x32_bf16 v[44:47], v[104:107], v[192:195], v[44:47]
  ds_read_b64_tr_b16 v[124:125], v4 offset:1920
  ds_read_b64_tr_b16 v[126:127], v4 offset:1952
  v_mfma_f32_16x16x32_bf16 v[48:51], v[108:111], v[192:195], v[48:51]
  s_waitcnt vmcnt(5)
  ds_read_b64_tr_b16 v[128:129], v4 offset:2048
  v_mfma_f32_16x16x32_bf16 v[52:55], v[64:67], v[216:219], 0
  ds_read_b64_tr_b16 v[130:131], v4 offset:2080
  v_add_f32_dpp v36, v56, v36 wave_ror:1 row_mask:0xf bank_mask:0xf
  v_mfma_f32_16x16x32_bf16 v[224:227], v[68:71], v[216:219], 0
  v_add_f32_dpp v40, v57, v40 wave_ror:1 row_mask:0xf bank_mask:0xf
  ds_read_b64_tr_b16 v[132:133], v4 offset:2176
  v_mfma_f32_16x16x32_bf16 v[52:55], v[72:75], v[212:215], v[52:55]
  buffer_load_dword v25, v25, s[20:23], 0 offen
  ds_read_b64_tr_b16 v[134:135], v4 offset:2208
  v_mfma_f32_16x16x32_bf16 v[224:227], v[76:79], v[212:215], v[224:227]
  s_waitcnt lgkmcnt(7)
  v_fma_f32 v58, v12, s59, v36
  v_mfma_f32_16x16x32_bf16 v[52:55], v[80:83], v[208:211], v[52:55]
  s_waitcnt lgkmcnt(6)
  v_fma_f32 v59, v13, s59, v40
  v_mfma_f32_16x16x32_bf16 v[224:227], v[84:87], v[208:211], v[224:227]
  v_cvt_pk_bf16_f32 v58, v58, v59
  ds_write_b16 v6, v58 offset:0
  v_mfma_f32_16x16x32_bf16 v[52:55], v[88:91], v[204:207], v[52:55]
  ds_write_b16_d16_hi v6, v58 offset:512
  ds_read_u16_d16_hi v12, v7 offset:1280
  v_mfma_f32_16x16x32_bf16 v[224:227], v[92:95], v[204:207], v[224:227]
  ds_read_u16_d16_hi v13, v7 offset:1408
  v_cndmask_b32 v56, v47, v43, s[14:15]
  v_mfma_f32_16x16x32_bf16 v[52:55], v[96:99], v[200:203], v[52:55]
  v_cndmask_b32 v57, v51, v47, s[14:15]
  v_add_f32_dpp v46, v56, v46 wave_ror:1 row_mask:0xf bank_mask:0xf
  v_mfma_f32_16x16x32_bf16 v[224:227], v[100:103], v[200:203], v[224:227]
  v_add_f32_dpp v50, v57, v50 wave_ror:1 row_mask:0xf bank_mask:0xf
  v_cndmask_b32 v56, v46, v42, s[14:15]
  v_mfma_f32_16x16x32_bf16 v[52:55], v[104:107], v[196:199], v[52:55]
  buffer_load_dword v28, v26, s[36:39], 0 offen
  v_cndmask_b32 v57, v50, v46, s[14:15]
  v_mfma_f32_16x16x32_bf16 v[224:227], v[108:111], v[196:199], v[224:227]
  v_add_f32_dpp v45, v56, v45 wave_ror:1 row_mask:0xf bank_mask:0xf
  v_add_f32_dpp v49, v57, v49 wave_ror:1 row_mask:0xf bank_mask:0xf
  v_mfma_f32_16x16x32_bf16 v[52:55], v[112:115], v[192:195], v[52:55]
  v_cndmask_b32 v56, v45, v41, s[14:15]
  v_cndmask_b32 v57, v49, v45, s[14:15]
  v_mfma_f32_16x16x32_bf16 v[224:227], v[116:119], v[192:195], v[224:227]
  ds_read_b64_tr_b16 v[136:137], v4 offset:2304
  ds_read_b64_tr_b16 v[138:139], v4 offset:2336
  v_mfma_f32_16x16x32_bf16 v[228:231], v[64:67], v[220:223], 0
  v_add_f32_dpp v44, v56, v44 wave_ror:1 row_mask:0xf bank_mask:0xf
  v_add_f32_dpp v48, v57, v48 wave_ror:1 row_mask:0xf bank_mask:0xf
  v_mfma_f32_16x16x32_bf16 v[232:235], v[68:71], v[220:223], 0
  s_waitcnt lgkmcnt(3)
  v_fma_f32 v58, v12, s59, v44
  v_mfma_f32_16x16x32_bf16 v[228:231], v[72:75], v[216:219], v[228:231]
  s_waitcnt lgkmcnt(2)
  v_fma_f32 v59, v13, s59, v48
  v_mfma_f32_16x16x32_bf16 v[232:235], v[76:79], v[216:219], v[232:235]
  v_cvt_pk_bf16_f32 v58, v58, v59
  ds_write_b16 v6, v58 offset:1024
  v_mfma_f32_16x16x32_bf16 v[228:231], v[80:83], v[212:215], v[228:231]
  buffer_load_dword v29, v29, s[36:39], 0 offen
  ds_write_b16_d16_hi v6, v58 offset:1536
  v_mfma_f32_16x16x32_bf16 v[232:235], v[84:87], v[212:215], v[232:235]
  ds_read_u16_d16_hi v12, v7 offset:1536
  ds_read_u16_d16_hi v13, v7 offset:1664
  v_mfma_f32_16x16x32_bf16 v[228:231], v[88:91], v[208:211], v[228:231]
  v_cndmask_b32 v56, v55, v51, s[14:15]
  v_cndmask_b32 v57, v227, v55, s[14:15]
  v_mfma_f32_16x16x32_bf16 v[232:235], v[92:95], v[208:211], v[232:235]
  v_add_f32_dpp v54, v56, v54 wave_ror:1 row_mask:0xf bank_mask:0xf
  v_add_f32_dpp v226, v57, v226 wave_ror:1 row_mask:0xf bank_mask:0xf
  v_mfma_f32_16x16x32_bf16 v[228:231], v[96:99], v[204:207], v[228:231]
  v_cndmask_b32 v56, v54, v50, s[14:15]
  v_cndmask_b32 v57, v226, v54, s[14:15]
  v_mfma_f32_16x16x32_bf16 v[232:235], v[100:103], v[204:207], v[232:235]
  v_add_f32_dpp v53, v56, v53 wave_ror:1 row_mask:0xf bank_mask:0xf
  v_add_f32_dpp v225, v57, v225 wave_ror:1 row_mask:0xf bank_mask:0xf
  v_mfma_f32_16x16x32_bf16 v[228:231], v[104:107], v[200:203], v[228:231]
  v_cndmask_b32 v56, v53, v49, s[14:15]
  v_cndmask_b32 v57, v225, v53, s[14:15]
  v_mfma_f32_16x16x32_bf16 v[232:235], v[108:111], v[200:203], v[232:235]
  v_add_f32_dpp v52, v56, v52 wave_ror:1 row_mask:0xf bank_mask:0xf
  v_add_f32_dpp v224, v57, v224 wave_ror:1 row_mask:0xf bank_mask:0xf
  v_mfma_f32_16x16x32_bf16 v[228:231], v[112:115], v[196:199], v[228:231]
  s_add_u32 s31, s31, 1
  s_and_b32 s31, s31, 7
  v_mfma_f32_16x16x32_bf16 v[232:235], v[116:119], v[196:199], v[232:235]
  s_mul_i32 s30, s31, 3584
  s_add_u32 m0, s30, s29
  v_mfma_f32_16x16x32_bf16 v[228:231], v[120:123], v[192:195], v[228:231]
  ds_read_b64_tr_b16 v[140:141], v4 offset:2432
  ds_read_b64_tr_b16 v[142:143], v4 offset:2464
  v_mfma_f32_16x16x32_bf16 v[232:235], v[124:127], v[192:195], v[232:235]
  ds_read_b64_tr_b16 v[144:145], v4 offset:2560
  ds_read_b64_tr_b16 v[146:147], v4 offset:2592
  v_mfma_f32_16x16x32_bf16 v[236:239], v[64:67], a[224:227], 0
  s_lshl4_add_u32 s30, s30, s28
  buffer_load_dwordx4 v15, s[32:35], s30 offen offset:0 lds
  v_mfma_f32_16x16x32_bf16 v[240:243], v[68:71], a[224:227], 0
  s_waitcnt lgkmcnt(5)
  v_fma_f32 v58, v12, s59, v52
  v_mfma_f32_16x16x32_bf16 v[236:239], v[72:75], v[220:223], v[236:239]
  s_waitcnt lgkmcnt(4)
  v_fma_f32 v59, v13, s59, v224
  v_mfma_f32_16x16x32_bf16 v[240:243], v[76:79], v[220:223], v[240:243]
  v_cvt_pk_bf16_f32 v58, v58, v59
  ds_write_b16 v6, v58 offset:2048
  v_mfma_f32_16x16x32_bf16 v[236:239], v[80:83], v[216:219], v[236:239]
  s_add_u32 s30, s30, 13440
  buffer_load_dwordx4 v15, s[32:35], s30 offen offset:896 lds
  v_mfma_f32_16x16x32_bf16 v[240:243], v[84:87], v[216:219], v[240:243]
  ds_write_b16_d16_hi v6, v58 offset:2560
  ds_read_u16_d16_hi v12, v7 offset:1792
  v_mfma_f32_16x16x32_bf16 v[236:239], v[88:91], v[212:215], v[236:239]
  ds_read_u16_d16_hi v13, v7 offset:1920
  v_cndmask_b32 v56, v231, v227, s[14:15]
  v_mfma_f32_16x16x32_bf16 v[240:243], v[92:95], v[212:215], v[240:243]
  v_cndmask_b32 v57, v235, v231, s[14:15]
  v_add_f32_dpp v230, v56, v230 wave_ror:1 row_mask:0xf bank_mask:0xf
  v_mfma_f32_16x16x32_bf16 v[236:239], v[96:99], v[208:211], v[236:239]
  v_add_f32_dpp v234, v57, v234 wave_ror:1 row_mask:0xf bank_mask:0xf
  v_cndmask_b32 v56, v230, v226, s[14:15]
  v_mfma_f32_16x16x32_bf16 v[240:243], v[100:103], v[208:211], v[240:243]
  v_cndmask_b32 v57, v234, v230, s[14:15]
  v_add_f32_dpp v229, v56, v229 wave_ror:1 row_mask:0xf bank_mask:0xf
  v_mfma_f32_16x16x32_bf16 v[236:239], v[104:107], v[204:207], v[236:239]
  v_add_f32_dpp v233, v57, v233 wave_ror:1 row_mask:0xf bank_mask:0xf
  v_cndmask_b32 v56, v229, v225, s[14:15]
  v_mfma_f32_16x16x32_bf16 v[240:243], v[108:111], v[204:207], v[240:243]
  v_cndmask_b32 v57, v233, v229, s[14:15]
  v_add_f32_dpp v228, v56, v228 wave_ror:1 row_mask:0xf bank_mask:0xf
  v_mfma_f32_16x16x32_bf16 v[236:239], v[112:115], v[200:203], v[236:239]
  s_add_u32 s30, s30, 13440
  buffer_load_dwordx4 v15, s[32:35], s30 offen offset:1792 lds
  v_mfma_f32_16x16x32_bf16 v[240:243], v[116:119], v[200:203], v[240:243]
  v_add_f32_dpp v232, v57, v232 wave_ror:1 row_mask:0xf bank_mask:0xf
  ds_read_b64_tr_b16 v[148:149], v4 offset:2688
  v_mfma_f32_16x16x32_bf16 v[236:239], v[120:123], v[196:199], v[236:239]
  s_waitcnt lgkmcnt(2)
  v_fma_f32 v58, v12, s59, v228
  v_mfma_f32_16x16x32_bf16 v[240:243], v[124:127], v[196:199], v[240:243]
  s_waitcnt lgkmcnt(1)
  v_fma_f32 v59, v13, s59, v232
  v_mfma_f32_16x16x32_bf16 v[236:239], v[128:131], v[192:195], v[236:239]
  ds_read_b64_tr_b16 v[150:151], v4 offset:2720
  v_cvt_pk_bf16_f32 v58, v58, v59
  v_mfma_f32_16x16x32_bf16 v[240:243], v[132:135], v[192:195], v[240:243]
  ds_read_b64_tr_b16 v[152:153], v4 offset:2816
  ds_read_b64_tr_b16 v[154:155], v4 offset:2848
  v_mfma_f32_16x16x32_bf16 v[244:247], v[64:67], a[228:231], 0
  ds_write_b16 v6, v58 offset:3072
  ds_write_b16_d16_hi v6, v58 offset:3584
  v_mfma_f32_16x16x32_bf16 v[248:251], v[68:71], a[228:231], 0
  ds_read_u16_d16_hi v12, v7 offset:2048
  ds_read_u16_d16_hi v13, v7 offset:2176
  v_mfma_f32_16x16x32_bf16 v[244:247], v[72:75], a[224:227], v[244:247]
  s_add_u32 s30, s30, 13440
  ds_read_b64_tr_b16 v[156:157], v4 offset:2944
  v_mfma_f32_16x16x32_bf16 v[248:251], v[76:79], a[224:227], v[248:251]
  s_mov_b32 exec_hi, 0x00ffffff
  buffer_load_dwordx4 v15, s[32:35], s30 offen offset:2688 lds
  s_mov_b32 exec_hi, -1
  v_mfma_f32_16x16x32_bf16 v[244:247], v[80:83], v[220:223], v[244:247]
  v_cndmask_b32 v56, v239, v235, s[14:15]
  v_cndmask_b32 v57, v243, v239, s[14:15]
  v_mfma_f32_16x16x32_bf16 v[248:251], v[84:87], v[220:223], v[248:251]
  v_add_f32_dpp v238, v56, v238 wave_ror:1 row_mask:0xf bank_mask:0xf
  v_add_f32_dpp v242, v57, v242 wave_ror:1 row_mask:0xf bank_mask:0xf
  v_mfma_f32_16x16x32_bf16 v[244:247], v[88:91], v[216:219], v[244:247]
  v_cndmask_b32 v56, v238, v234, s[14:15]
  v_cndmask_b32 v57, v242, v238, s[14:15]
  v_mfma_f32_16x16x32_bf16 v[248:251], v[92:95], v[216:219], v[248:251]
  v_add_f32_dpp v237, v56, v237 wave_ror:1 row_mask:0xf bank_mask:0xf
  v_add_f32_dpp v241, v57, v241 wave_ror:1 row_mask:0xf bank_mask:0xf
  v_mfma_f32_16x16x32_bf16 v[244:247], v[96:99], v[212:215], v[244:247]
  v_cndmask_b32 v56, v237, v233, s[14:15]
  v_cndmask_b32 v57, v241, v237, s[14:15]
  v_mfma_f32_16x16x32_bf16 v[248:251], v[100:103], v[212:215], v[248:251]
  v_add_f32_dpp v236, v56, v236 wave_ror:1 row_mask:0xf bank_mask:0xf
  v_add_f32_dpp v240, v57, v240 wave_ror:1 row_mask:0xf bank_mask:0xf
  v_mfma_f32_16x16x32_bf16 v[244:247], v[104:107], v[208:211], v[244:247]
  buffer_load_dword v30, v11, s[52:55], 0 offen sc1
  ds_read_b64_tr_b16 v[158:159], v4 offset:2976
  v_mfma_f32_16x16x32_bf16 v[248:251], v[108:111], v[208:211], v[248:251]
  s_waitcnt lgkmcnt(3)
  v_fma_f32 v58, v12, s59, v236
  v_mfma_f32_16x16x32_bf16 v[244:247], v[112:115], v[204:207], v[244:247]
  s_waitcnt lgkmcnt(2)
  v_fma_f32 v59, v13, s59, v240
  v_mfma_f32_16x16x32_bf16 v[248:251], v[116:119], v[204:207], v[248:251]
  v_cvt_pk_bf16_f32 v58, v58, v59
  ds_write_b16 v6, v58 offset:4096
  v_mfma_f32_16x16x32_bf16 v[244:247], v[120:123], v[200:203], v[244:247]
  ds_write_b16_d16_hi v6, v58 offset:4608
  v_mfma_f32_16x16x32_bf16 v[248:251], v[124:127], v[200:203], v[248:251]
  v_mfma_f32_16x16x32_bf16 v[244:247], v[128:131], v[196:199], v[244:247]
  v_mfma_f32_16x16x32_bf16 v[248:251], v[132:135], v[196:199], v[248:251]
  v_mfma_f32_16x16x32_bf16 v[244:247], v[136:139], v[192:195], v[244:247]
  s_add_u32 s31, s31, 1
  s_and_b32 s31, s31, 7
  v_mfma_f32_16x16x32_bf16 v[248:251], v[140:143], v[192:195], v[248:251]
  s_mul_i32 s30, s31, 3584
  s_add_u32 m0, s30, s29
  v_mfma_f32_16x16x32_bf16 v[252:255], v[64:67], a[232:235], 0
  s_lshl4_add_u32 s30, s30, s28
  buffer_load_dwordx4 v15, s[32:35], s30 offen offset:0 lds
  v_mfma_f32_16x16x32_bf16 v[32:35], v[68:71], a[232:235], 0
  ds_read_u16_d16_hi v12, v7 offset:2304
  ds_read_u16_d16_hi v13, v7 offset:2432
  v_mfma_f32_16x16x32_bf16 v[252:255], v[72:75], a[228:231], v[252:255]
  v_mfma_f32_16x16x32_bf16 v[32:35], v[76:79], a[228:231], v[32:35]
  v_cndmask_b32 v56, v247, v243, s[14:15]
  v_cndmask_b32 v57, v251, v247, s[14:15]
  v_mfma_f32_16x16x32_bf16 v[252:255], v[80:83], a[224:227], v[252:255]
  v_add_f32_dpp v246, v56, v246 wave_ror:1 row_mask:0xf bank_mask:0xf
  v_add_f32_dpp v250, v57, v250 wave_ror:1 row_mask:0xf bank_mask:0xf
  v_mfma_f32_16x16x32_bf16 v[32:35], v[84:87], a[224:227], v[32:35]
  v_cndmask_b32 v56, v246, v242, s[14:15]
  v_cndmask_b32 v57, v250, v246, s[14:15]
  v_mfma_f32_16x16x32_bf16 v[252:255], v[88:91], v[220:223], v[252:255]
  s_add_u32 s30, s30, 13440
  buffer_load_dwordx4 v15, s[32:35], s30 offen offset:896 lds
  v_mfma_f32_16x16x32_bf16 v[32:35], v[92:95], v[220:223], v[32:35]
  v_add_f32_dpp v245, v56, v245 wave_ror:1 row_mask:0xf bank_mask:0xf
  v_add_f32_dpp v249, v57, v249 wave_ror:1 row_mask:0xf bank_mask:0xf
  v_mfma_f32_16x16x32_bf16 v[252:255], v[96:99], v[216:219], v[252:255]
  v_cndmask_b32 v56, v245, v241, s[14:15]
  v_cndmask_b32 v57, v249, v245, s[14:15]
  v_mfma_f32_16x16x32_bf16 v[32:35], v[100:103], v[216:219], v[32:35]
  v_add_f32_dpp v244, v56, v244 wave_ror:1 row_mask:0xf bank_mask:0xf
  v_add_f32_dpp v248, v57, v248 wave_ror:1 row_mask:0xf bank_mask:0xf
  v_mfma_f32_16x16x32_bf16 v[252:255], v[104:107], v[212:215], v[252:255]
  s_waitcnt lgkmcnt(1)
  v_fma_f32 v58, v12, s59, v244
  v_mfma_f32_16x16x32_bf16 v[32:35], v[108:111], v[212:215], v[32:35]
  s_waitcnt lgkmcnt(0)
  v_fma_f32 v59, v13, s59, v248
  v_mfma_f32_16x16x32_bf16 v[252:255], v[112:115], v[208:211], v[252:255]
  v_cvt_pk_bf16_f32 v58, v58, v59
  ds_write_b16 v6, v58 offset:5120
  v_mfma_f32_16x16x32_bf16 v[32:35], v[116:119], v[208:211], v[32:35]
  ds_write_b16_d16_hi v6, v58 offset:5632
  v_mfma_f32_16x16x32_bf16 v[252:255], v[120:123], v[204:207], v[252:255]
  s_add_u32 s30, s30, 13440
  buffer_load_dwordx4 v15, s[32:35], s30 offen offset:1792 lds
  v_mfma_f32_16x16x32_bf16 v[32:35], v[124:127], v[204:207], v[32:35]
  v_mfma_f32_16x16x32_bf16 v[252:255], v[128:131], v[200:203], v[252:255]
  v_mfma_f32_16x16x32_bf16 v[32:35], v[132:135], v[200:203], v[32:35]
  v_mfma_f32_16x16x32_bf16 v[252:255], v[136:139], v[196:199], v[252:255]
  v_mfma_f32_16x16x32_bf16 v[32:35], v[140:143], v[196:199], v[32:35]
  v_mfma_f32_16x16x32_bf16 v[252:255], v[144:147], v[192:195], v[252:255]
  v_mfma_f32_16x16x32_bf16 v[32:35], v[148:151], v[192:195], v[32:35]
  v_mfma_f32_16x16x32_bf16 v[36:39], v[64:67], a[236:239], 0
  s_add_u32 s30, s30, 13440
  ds_read_u16_d16_hi v12, v7 offset:2560
  v_mfma_f32_16x16x32_bf16 v[40:43], v[68:71], a[236:239], 0
  s_mov_b32 exec_hi, 0x00ffffff
  buffer_load_dwordx4 v15, s[32:35], s30 offen offset:2688 lds
  s_mov_b32 exec_hi, -1
  v_mfma_f32_16x16x32_bf16 v[36:39], v[72:75], a[232:235], v[36:39]
  ds_read_u16_d16_hi v13, v7 offset:2688
  v_mfma_f32_16x16x32_bf16 v[40:43], v[76:79], a[232:235], v[40:43]
  v_cndmask_b32 v56, v255, v251, s[14:15]
  v_cndmask_b32 v57, v35, v255, s[14:15]
  v_mfma_f32_16x16x32_bf16 v[36:39], v[80:83], a[228:231], v[36:39]
  v_add_f32_dpp v254, v56, v254 wave_ror:1 row_mask:0xf bank_mask:0xf
  v_add_f32_dpp v34, v57, v34 wave_ror:1 row_mask:0xf bank_mask:0xf
  v_mfma_f32_16x16x32_bf16 v[40:43], v[84:87], a[228:231], v[40:43]
  v_cndmask_b32 v56, v254, v250, s[14:15]
  v_cndmask_b32 v57, v34, v254, s[14:15]
  v_mfma_f32_16x16x32_bf16 v[36:39], v[88:91], a[224:227], v[36:39]
  v_add_f32_dpp v253, v56, v253 wave_ror:1 row_mask:0xf bank_mask:0xf
  v_add_f32_dpp v33, v57, v33 wave_ror:1 row_mask:0xf bank_mask:0xf
  v_mfma_f32_16x16x32_bf16 v[40:43], v[92:95], a[224:227], v[40:43]
  v_cndmask_b32 v56, v253, v249, s[14:15]
  v_cndmask_b32 v57, v33, v253, s[14:15]
  v_mfma_f32_16x16x32_bf16 v[36:39], v[96:99], v[220:223], v[36:39]
  v_add_f32_dpp v252, v56, v252 wave_ror:1 row_mask:0xf bank_mask:0xf
  v_add_f32_dpp v32, v57, v32 wave_ror:1 row_mask:0xf bank_mask:0xf
  v_mfma_f32_16x16x32_bf16 v[40:43], v[100:103], v[220:223], v[40:43]
  s_waitcnt lgkmcnt(1)
  v_fma_f32 v58, v12, s59, v252
  v_mfma_f32_16x16x32_bf16 v[36:39], v[104:107], v[216:219], v[36:39]
  s_waitcnt lgkmcnt(0)
  v_fma_f32 v59, v13, s59, v32
  v_mfma_f32_16x16x32_bf16 v[40:43], v[108:111], v[216:219], v[40:43]
  v_cvt_pk_bf16_f32 v58, v58, v59
  ds_write_b16 v6, v58 offset:6144
  v_mfma_f32_16x16x32_bf16 v[36:39], v[112:115], v[212:215], v[36:39]
  ds_write_b16_d16_hi v6, v58 offset:6656
  v_mfma_f32_16x16x32_bf16 v[40:43], v[116:119], v[212:215], v[40:43]
  v_mfma_f32_16x16x32_bf16 v[36:39], v[120:123], v[208:211], v[36:39]
  v_mfma_f32_16x16x32_bf16 v[40:43], v[124:127], v[208:211], v[40:43]
  v_mfma_f32_16x16x32_bf16 v[36:39], v[128:131], v[204:207], v[36:39]
  v_mfma_f32_16x16x32_bf16 v[40:43], v[132:135], v[204:207], v[40:43]
  v_mfma_f32_16x16x32_bf16 v[36:39], v[136:139], v[200:203], v[36:39]
  v_mfma_f32_16x16x32_bf16 v[40:43], v[140:143], v[200:203], v[40:43]
  v_mfma_f32_16x16x32_bf16 v[36:39], v[144:147], v[196:199], v[36:39]
  v_mfma_f32_16x16x32_bf16 v[40:43], v[148:151], v[196:199], v[40:43]
  v_mfma_f32_16x16x32_bf16 v[36:39], v[152:155], v[192:195], v[36:39]
  v_mfma_f32_16x16x32_bf16 v[40:43], v[156:159], v[192:195], v[40:43]
  ds_read_u16_d16_hi v12, v7 offset:2816
  ds_read_u16_d16_hi v13, v7 offset:2944
  s_nop 4
  v_cndmask_b32 v56, v39, v35, s[14:15]
  v_cndmask_b32 v57, v43, v39, s[14:15]
  s_nop 0
  v_add_f32_dpp v38, v56, v38 wave_ror:1 row_mask:0xf bank_mask:0xf
  v_add_f32_dpp v42, v57, v42 wave_ror:1 row_mask:0xf bank_mask:0xf
  v_cndmask_b32 v56, v38, v34, s[14:15]
  v_cndmask_b32 v57, v42, v38, s[14:15]
  s_nop 0
  v_add_f32_dpp v37, v56, v37 wave_ror:1 row_mask:0xf bank_mask:0xf
  v_add_f32_dpp v41, v57, v41 wave_ror:1 row_mask:0xf bank_mask:0xf
  v_cndmask_b32 v56, v37, v33, s[14:15]
  v_cndmask_b32 v57, v41, v37, s[14:15]
  s_nop 0
  v_add_f32_dpp v36, v56, v36 wave_ror:1 row_mask:0xf bank_mask:0xf
  v_add_f32_dpp v40, v57, v40 wave_ror:1 row_mask:0xf bank_mask:0xf
  s_waitcnt lgkmcnt(1)
  v_fma_f32 v58, v12, s59, v36
  s_waitcnt lgkmcnt(0)
  v_fma_f32 v59, v13, s59, v40
  v_cvt_pk_bf16_f32 v58, v58, v59
  ds_write_b16 v6, v58 offset:7168
  ds_write_b16_d16_hi v6, v58 offset:7680
s_cv_join:
  s_waitcnt vmcnt(4)
  v_cmp_gt_u32 vcc, s97, v30
  s_nop 4
  s_cbranch_vccz s_fb_ok
  s_mov_b32 s69, 0
s_fb:
  buffer_load_dword v30, v11, s[52:55], 0 offen offset:0 sc1
  s_add_u32 s69, s69, 1
  s_waitcnt vmcnt(0)
  v_cmp_gt_u32 vcc, s97, v30
  s_cmp_ge_u32 s69, 4000
  s_cbranch_scc1 s_fb_out
  s_nop 3
  s_cbranch_vccnz s_fb
s_fb_out:
s_fb_ok:
  s_waitcnt lgkmcnt(0)
  s_barrier
  ds_read_b128 v[200:203], v10 offset:0
  ds_read_b128 v[204:207], v10 offset:4096
  s_waitcnt lgkmcnt(1)
  buffer_store_dwordx4 v[200:203], v3, s[20:23], s66 offen sc1
  s_waitcnt lgkmcnt(0)
  buffer_store_dwordx4 v[204:207], v3, s[20:23], s67 offen sc1
  s_lshl_b32 s60, s4, 5
  s_add_u32 s60, s60, s5
  s_lshl_b32 s60, s60, 13
  s_lshl_b32 s61, s3, 11
  s_add_u32 s60, s60, s61
  s_add_u32 s52, s60, 4194304
  s_add_u32 s53, s60, 2097152
  s_lshl_b32 s61, s4, 11
  s_add_u32 s61, s61, 6292480
  s_lshl_b32 s54, s5, 4
  s_lshl_b32 s63, s3, 2
  s_add_u32 s54, s54, s63
  s_add_u32 s54, s54, s61
  s_and_b32 s60, s58, 7
  s_lshl_b32 s60, s60, 6
  s_add_u32 s55, s60, s61
  v_lshrrev_b32 v38, 3, v1
  s_add_u32 s31, s31, 1
  s_and_b32 s31, s31, 7
  s_mul_i32 s30, s31, 3584
  s_add_u32 m0, s30, s29
  s_lshl4_add_u32 s30, s30, s28
  buffer_load_dwordx4 v15, s[32:35], s30 offen offset:0 lds
  v_and_b32 v39, 7, v1
  v_and_b32 v40, 1, v38
  v_lshlrev_b32 v40, 2, v40
  v_xor_b32 v39, v39, v40
  v_lshlrev_b32 v38, 9, v38
  v_add_u32 v38, s68, v38
  v_lshl_add_u32 v250, v39, 4, v38
  v_xor_b32 v39, 2, v39
  v_lshl_add_u32 v251, v39, 4, v38
  v_lshrrev_b32 v38, 2, v1
  s_add_u32 s30, s30, 13440
  buffer_load_dwordx4 v15, s[32:35], s30 offen offset:896 lds
  v_bfe_u32 v39, v38, 1, 2
  v_and_b32 v40, 3, v1
  v_lshlrev_b32 v38, 7, v38
  v_lshl_add_u32 v38, v40, 3, v38
  v_add_u32 v38, s68, v38
  s_add_u32 s60, s3, 0
  s_and_b32 s60, s60, 3
  v_xor_b32 v40, s60, v39
  v_lshl_add_u32 v252, v40, 5, v38
  s_add_u32 s60, s3, 1
  s_and_b32 s60, s60, 3
  v_xor_b32 v40, s60, v39
  v_lshl_add_u32 v253, v40, 5, v38
  s_add_u32 s60, s3, 2
  s_and_b32 s60, s60, 3
  v_xor_b32 v40, s60, v39
  s_add_u32 s30, s30, 13440
  buffer_load_dwordx4 v15, s[32:35], s30 offen offset:1792 lds
  v_lshl_add_u32 v254, v40, 5, v38
  s_add_u32 s60, s3, 3
  s_and_b32 s60, s60, 3
  v_xor_b32 v40, s60, v39
  v_lshl_add_u32 v255, v40, 5, v38
  v_mov_b32 v12, v25
  v_lshrrev_b32 v38, 4, v1
  v_and_b32 v39, 3, v1
  v_lshl_add_u32 v40, v38, 2, v39
  v_lshlrev_b32 v43, 4, v40
  v_add_u32 v43, 161792, v43
  s_lshl_b32 s60, s3, 2
  v_add_u32 v42, s60, v43
  s_add_u32 s30, s30, 13440
  s_mov_b32 exec_hi, 0x00ffffff
  buffer_load_dwordx4 v15, s[32:35], s30 offen offset:2688 lds
  s_mov_b32 exec_hi, -1
  v_bfe_u32 v40, v1, 2, 2
  v_lshlrev_b32 v3, 13, v40
  v_lshl_add_u32 v3, v38, 6, v3
  v_lshl_add_u32 v3, v39, 4, v3
  v_mov_b32 v4, 0
  v_and_b32 v11, 15, v1
  v_lshlrev_b32 v11, 2, v11
  v_dot2_f32_bf16 v120, v16, s7, 0
  v_dot2_f32_bf16 v122, v16, v16, 0
  v_dot2_f32_bf16 v121, v18, s7, 0
  s_add_u32 s31, s31, 1
  s_and_b32 s31, s31, 7
  s_mul_i32 s30, s31, 3584
  s_add_u32 m0, s30, s29
  s_lshl4_add_u32 s30, s30, s28
  buffer_load_dwordx4 v15, s[32:35], s30 offen offset:0 lds
  v_dot2_f32_bf16 v123, v18, v18, 0
  v_dot2_f32_bf16 v120, v17, s7, v120
  v_dot2_f32_bf16 v122, v17, v17, v122
  v_dot2_f32_bf16 v121, v19, s7, v121
  v_dot2_f32_bf16 v123, v19, v19, v123
  v_dot2_f32_bf16 v120, v20, s7, v120
  v_dot2_f32_bf16 v122, v20, v20, v122
  v_dot2_f32_bf16 v121, v22, s7, v121
  v_dot2_f32_bf16 v123, v22, v22, v123
  v_dot2_f32_bf16 v120, v21, s7, v120
  s_add_u32 s30, s30, 13440
  buffer_load_dwordx4 v15, s[32:35], s30 offen offset:896 lds
  v_dot2_f32_bf16 v122, v21, v21, v122
  v_dot2_f32_bf16 v121, v23, s7, v121
  v_dot2_f32_bf16 v123, v23, v23, v123
  s_nop 1
  v_permlane32_swap_b32 v120, v121
  v_permlane32_swap_b32 v122, v123
  v_add_f32 v120, v120, v121
  v_add_f32 v122, v122, v123
  s_nop 1
  v_permlane16_swap_b32 v120, v122
  v_add_f32 v120, v120, v122
  s_nop 1
  v_add_f32_dpp v120, v120, v120 row_ror:4 row_mask:0xf bank_mask:0xf
  s_add_u32 s30, s30, 13440
  buffer_load_dwordx4 v15, s[32:35], s30 offen offset:1792 lds
  v_add_f32_dpp v120, v120, v120 row_ror:8 row_mask:0xf bank_mask:0xf
  ds_write_b32 v42, v120 offset:0
  s_and_b32 s60, s5, 15
  s_mul_i32 s60, s60, 224
  v_lshrrev_b32 v10, 4, v1
  v_lshl_add_u32 v10, v10, 3, s60
  s_lshr_b32 s61, s94, 9
  buffer_load_dwordx2 v[148:149], v10, s[40:43], s61 offen offset:0
  buffer_load_dwordx2 v[156:157], v10, s[40:43], s61 offen offset:32
  s_lshr_b32 s62, s95, 9
  buffer_load_dwordx2 v[164:165], v10, s[40:43], s62 offen offset:0
  buffer_load_dwordx2 v[172:173], v10, s[40:43], s62 offen offset:32
  s_lshr_b32 s63, s96, 9
  buffer_load_dwordx2 v[180:181], v10, s[40:43], s63 offen offset:0
  buffer_load_dwordx2 v[188:189], v10, s[40:43], s63 offen offset:32
  buffer_load_dwordx2 v[196:197], v10, s[40:43], 0 offen offset:192
  s_waitcnt lgkmcnt(0)
  s_barrier
  ds_read_b128 v[120:123], v43 offset:0
  s_waitcnt lgkmcnt(0)
  v_pk_add_f32 v[120:121], v[120:121], v[122:123]
  v_add_f32 v120, v120, v121
  v_mov_b32 v121, v120
  s_nop 1
  v_permlane16_swap_b32 v120, v121
  v_mul_f32 v120, 0x3b000000, v120
  v_mul_f32 v121, 0x3b000000, v121
  v_fma_f32 v121, -v120, v120, v121
  s_add_u32 s30, s30, 13440
  s_mov_b32 exec_hi, 0x00ffffff
  buffer_load_dwordx4 v15, s[32:35], s30 offen offset:2688 lds
  s_mov_b32 exec_hi, -1
  v_cvt_pk_bf16_f32 v120, v120, v120
  v_lshlrev_b32 v120, 16, v120
  v_cvt_pk_bf16_f32 v121, v121, v121
  v_lshlrev_b32 v121, 16, v121
  v_add_f32 v121, 0x3727c5ac, v121
  v_cvt_pk_bf16_f32 v121, v121, v121
  v_lshlrev_b32 v121, 16, v121
  v_sqrt_f32 v121, v121
  v_lshlrev_b32 v64, 16, v16
  v_and_b32 v65, s6, v16
  s_add_u32 s31, s31, 1
  s_and_b32 s31, s31, 7
  s_mul_i32 s30, s31, 3584
  s_add_u32 m0, s30, s29
  s_lshl4_add_u32 s30, s30, s28
  buffer_load_dwordx4 v15, s[32:35], s30 offen offset:0 lds
  v_lshlrev_b32 v66, 16, v17
  v_and_b32 v67, s6, v17
  v_lshlrev_b32 v68, 16, v18
  v_and_b32 v69, s6, v18
  v_lshlrev_b32 v70, 16, v19
  v_and_b32 v71, s6, v19
  v_cvt_pk_bf16_f32 v121, v121, v121
  v_lshlrev_b32 v121, 16, v121
  v_rcp_f32 v124, v121
  v_lshlrev_b32 v72, 16, v20
  s_add_u32 s30, s30, 13440
  buffer_load_dwordx4 v15, s[32:35], s30 offen offset:896 lds
  v_and_b32 v73, s6, v20
  v_lshlrev_b32 v74, 16, v21
  v_and_b32 v75, s6, v21
  v_lshlrev_b32 v76, 16, v22
  v_and_b32 v77, s6, v22
  v_lshlrev_b32 v78, 16, v23
  v_and_b32 v79, s6, v23
  v_mul_f32 v125, v120, v124
  v_sub_f32 v125, 0, v125
  v_mov_b32 v126, v124
  s_add_u32 s30, s30, 13440
  buffer_load_dwordx4 v15, s[32:35], s30 offen offset:1792 lds
  v_mov_b32 v127, v125
  v_permlane32_swap_b32 v124, v126
  s_nop 0
  v_permlane32_swap_b32 v125, v127
  v_pk_fma_f32 v[80:81], v[64:65], v[124:125], v[124:125] op_sel:[0,0,1] op_sel_hi:[1,0,1]
  v_pk_fma_f32 v[82:83], v[66:67], v[124:125], v[124:125] op_sel:[0,0,1] op_sel_hi:[1,0,1]
  v_pk_fma_f32 v[84:85], v[68:69], v[126:127], v[126:127] op_sel:[0,0,1] op_sel_hi:[1,0,1]
  v_pk_fma_f32 v[86:87], v[70:71], v[126:127], v[126:127] op_sel:[0,0,1] op_sel_hi:[1,0,1]
  v_pk_fma_f32 v[88:89], v[72:73], v[124:125], v[124:125] op_sel:[0,0,1] op_sel_hi:[1,0,1]
  v_pk_fma_f32 v[90:91], v[74:75], v[124:125], v[124:125] op_sel:[0,0,1] op_sel_hi:[1,0,1]
  v_pk_fma_f32 v[92:93], v[76:77], v[126:127], v[126:127] op_sel:[0,0,1] op_sel_hi:[1,0,1]
  s_add_u32 s30, s30, 13440
  s_mov_b32 exec_hi, 0x00ffffff
  buffer_load_dwordx4 v15, s[32:35], s30 offen offset:2688 lds
  s_mov_b32 exec_hi, -1
  v_pk_fma_f32 v[94:95], v[78:79], v[126:127], v[126:127] op_sel:[0,0,1] op_sel_hi:[1,0,1]
  v_lshrrev_b32 v6, 2, v1
  v_mul_u32_u24 v6, 224, v6
  v_and_b32 v10, 3, v1
  v_lshl_add_u32 v6, v10, 3, v6
  v_add_u32 v7, 57344, v6
  v_mov_b32 v240, 3222493025
  v_mov_b32 v241, 3184710632
  v_mov_b32 v242, 1.0
  s_and_b32 s61, s5, 15
  s_lshl_b32 s64, s58, 4
  s_add_u32 s64, s64, s61
  s_lshl_b32 s64, s64, 11
  s_lshl_b32 s67, s58, 15
  s_add_u32 s67, s67, 4194304
  s_add_u32 s59, s67, 4096
  s_bfe_u32 s65, s58, 0x20001
  s_lshl_b32 s65, s65, 7
  s_lshr_b32 s60, s61, 2
  s_lshl_b32 s60, s60, 5
  s_add_u32 s65, s65, s60
  s_and_b32 s60, s3, 1
  s_lshl_b32 s60, s60, 4
  s_add_u32 s65, s65, s60
  s_and_b32 s60, s61, 3
  s_lshl_b32 s60, s60, 2
  s_add_u32 s65, s65, s60
  s_lshl_b32 s60, s4, 11
  s_add_u32 s65, s65, s60
  s_add_u32 s65, s65, 6292992
  s_add_u32 s66, s60, 6292480
  v_add_u32 v14, 8388608, v2
  v_add_u32 v0, 10485760, v2
  v_add_u32 v244, 16777216, v2
  v_add_u32 v245, 4194304, v2
  s_andn2_b32 s60, s65, 0x6c
  s_sub_u32 s60, s60, s66
  v_bfe_u32 v247, v1, 2, 2
  v_lshl_add_u32 v247, v247, 5, s60
  v_and_b32 v10, 3, v1
  v_lshl_add_u32 v247, v10, 2, v247
  buffer_load_dwordx4 v[96:99], v2, s[20:23], s52 offen offset:0 sc1
  buffer_load_dwordx4 v[100:103], v2, s[20:23], s52 offen offset:1024 sc1
  s_waitcnt vmcnt(1)
  v_max3_u32 v120, v96, v97, v98
  s_waitcnt vmcnt(0)
  v_max3_u32 v121, v100, v101, v102
  v_max3_u32 v120, v120, v99, v103
  v_max_u32 v120, v120, v121
  v_cmp_eq_u32 vcc, -1, v120
  s_mov_b32 s69, 0
  v_lshlrev_b32 v104, 16, v96
  v_and_b32 v105, s6, v96
  v_lshlrev_b32 v106, 16, v97
  v_and_b32 v107, s6, v97
  s_cbranch_vccz s_y_ok
s_y_l:
  s_mov_b64 exec, vcc
  buffer_load_dwordx4 v[96:99], v2, s[20:23], s52 offen offset:0 sc1
  buffer_load_dwordx4 v[100:103], v2, s[20:23], s52 offen offset:1024 sc1
  s_mov_b64 exec, -1
  s_add_u32 s69, s69, 1
  s_waitcnt vmcnt(1)
  v_max3_u32 v120, v96, v97, v98
  s_waitcnt vmcnt(0)
  v_max3_u32 v121, v100, v101, v102
  v_max3_u32 v120, v120, v99, v103
  v_max_u32 v120, v120, v121
  v_cmp_eq_u32 vcc, -1, v120
  s_cmp_ge_u32 s69, 4000
  v_lshlrev_b32 v104, 16, v96
  v_and_b32 v105, s6, v96
  v_lshlrev_b32 v106, 16, v97
  v_and_b32 v107, s6, v97
  s_cbranch_scc1 s_y_ok
  s_cbranch_vccnz s_y_l
s_y_ok:
  v_lshlrev_b32 v108, 16, v98
  s_add_u32 s31, s31, 1
  s_and_b32 s31, s31, 7
  s_mul_i32 s30, s31, 3584
  s_add_u32 m0, s30, s29
  s_lshl4_add_u32 s30, s30, s28
  buffer_load_dwordx4 v15, s[32:35], s30 offen offset:0 lds
  v_and_b32 v109, s6, v98
  v_lshlrev_b32 v110, 16, v99
  v_and_b32 v111, s6, v99
  v_pk_fma_f32 v[104:105], v[80:81], v[104:105], v[64:65]
  v_pk_fma_f32 v[106:107], v[82:83], v[106:107], v[66:67]
  v_pk_fma_f32 v[108:109], v[84:85], v[108:109], v[68:69]
  v_pk_fma_f32 v[110:111], v[86:87], v[110:111], v[70:71]
  v_cvt_pk_bf16_f32 v96, v104, v105
  v_cvt_pk_bf16_f32 v97, v106, v107
  v_cvt_pk_bf16_f32 v98, v108, v109
  s_add_u32 s30, s30, 13440
  buffer_load_dwordx4 v15, s[32:35], s30 offen offset:896 lds
  v_cvt_pk_bf16_f32 v99, v110, v111
  v_lshlrev_b32 v112, 16, v100
  v_and_b32 v113, s6, v100
  v_lshlrev_b32 v114, 16, v101
  v_and_b32 v115, s6, v101
  v_lshlrev_b32 v116, 16, v102
  v_and_b32 v117, s6, v102
  v_lshlrev_b32 v118, 16, v103
  v_and_b32 v119, s6, v103
  v_pk_fma_f32 v[112:113], v[88:89], v[112:113], v[72:73]
  s_add_u32 s30, s30, 13440
  buffer_load_dwordx4 v15, s[32:35], s30 offen offset:1792 lds
  v_pk_fma_f32 v[114:115], v[90:91], v[114:115], v[74:75]
  v_pk_fma_f32 v[116:117], v[92:93], v[116:117], v[76:77]
  v_pk_fma_f32 v[118:119], v[94:95], v[118:119], v[78:79]
  v_cvt_pk_bf16_f32 v100, v112, v113
  v_cvt_pk_bf16_f32 v101, v114, v115
  v_cvt_pk_bf16_f32 v102, v116, v117
  v_cvt_pk_bf16_f32 v103, v118, v119
  v_dot2_f32_bf16 v120, v96, s7, 0
  v_dot2_f32_bf16 v122, v96, v96, 0
  v_dot2_f32_bf16 v121, v98, s7, 0
  s_add_u32 s30, s30, 13440
  s_mov_b32 exec_hi, 0x00ffffff
  buffer_load_dwordx4 v15, s[32:35], s30 offen offset:2688 lds
  s_mov_b32 exec_hi, -1
  v_dot2_f32_bf16 v123, v98, v98, 0
  v_dot2_f32_bf16 v120, v97, s7, v120
  v_dot2_f32_bf16 v122, v97, v97, v122
  v_dot2_f32_bf16 v121, v99, s7, v121
  v_dot2_f32_bf16 v123, v99, v99, v123
  v_dot2_f32_bf16 v120, v100, s7, v120
  v_dot2_f32_bf16 v122, v100, v100, v122
  v_dot2_f32_bf16 v121, v102, s7, v121
  v_dot2_f32_bf16 v123, v102, v102, v123
  v_dot2_f32_bf16 v120, v101, s7, v120
  s_add_u32 s31, s31, 1
  s_and_b32 s31, s31, 7
  s_mul_i32 s30, s31, 3584
  s_add_u32 m0, s30, s29
  s_lshl4_add_u32 s30, s30, s28
  buffer_load_dwordx4 v15, s[32:35], s30 offen offset:0 lds
  v_dot2_f32_bf16 v122, v101, v101, v122
  v_dot2_f32_bf16 v121, v103, s7, v121
  v_dot2_f32_bf16 v123, v103, v103, v123
  s_nop 1
  v_permlane32_swap_b32 v120, v121
  v_permlane32_swap_b32 v122, v123
  v_add_f32 v120, v120, v121
  v_add_f32 v122, v122, v123
  s_nop 1
  v_permlane16_swap_b32 v120, v122
  v_add_f32 v120, v120, v122
  s_nop 1
  v_add_f32_dpp v120, v120, v120 row_ror:4 row_mask:0xf bank_mask:0xf
  s_add_u32 s30, s30, 13440
  buffer_load_dwordx4 v15, s[32:35], s30 offen offset:896 lds
  v_add_f32_dpp v120, v120, v120 row_ror:8 row_mask:0xf bank_mask:0xf
  ds_write_b32 v42, v120 offset:256
  buffer_store_dwordx4 v[96:99], v2, s[20:23], s53 offen offset:0 sc1
  buffer_store_dwordx4 v[100:103], v2, s[20:23], s53 offen offset:1024 sc1
  s_waitcnt lgkmcnt(0)
  s_barrier
  ds_read_b128 v[120:123], v43 offset:256
  v_lshlrev_b32 v104, 16, v96
  v_and_b32 v105, s6, v96
  v_lshlrev_b32 v106, 16, v97
  v_and_b32 v107, s6, v97
  v_lshlrev_b32 v108, 16, v98
  v_and_b32 v109, s6, v98
  v_lshlrev_b32 v110, 16, v99
  v_and_b32 v111, s6, v99
  v_lshlrev_b32 v112, 16, v100
  s_add_u32 s30, s30, 13440
  buffer_load_dwordx4 v15, s[32:35], s30 offen offset:1792 lds
  v_and_b32 v113, s6, v100
  v_lshlrev_b32 v114, 16, v101
  v_and_b32 v115, s6, v101
  v_lshlrev_b32 v116, 16, v102
  v_and_b32 v117, s6, v102
  v_lshlrev_b32 v118, 16, v103
  v_and_b32 v119, s6, v103
  s_waitcnt lgkmcnt(0)
  v_pk_add_f32 v[120:121], v[120:121], v[122:123]
  v_add_f32 v120, v120, v121
  v_mov_b32 v121, v120
  s_add_u32 s30, s30, 13440
  s_mov_b32 exec_hi, 0x00ffffff
  buffer_load_dwordx4 v15, s[32:35], s30 offen offset:2688 lds
  s_mov_b32 exec_hi, -1
  v_permlane16_swap_b32 v120, v121
  v_mul_f32 v120, 0xbb000000, v120
  v_mul_f32 v121, 0x3b000000, v121
  v_fma_f32 v121, -v120, v120, v121
  v_cvt_pk_bf16_f32 v122, v121, v121
  v_lshlrev_b32 v122, 16, v122
  v_add_f32 v122, 0x3727c5ac, v122
  v_cvt_pk_bf16_f32 v122, v122, v122
  v_lshlrev_b32 v122, 16, v122
  v_sqrt_f32 v122, v122
  s_nop 0
  v_cvt_pk_bf16_f32 v122, v122, v122
  v_lshlrev_b32 v122, 16, v122
  v_rcp_f32 v122, v122
  s_nop 0
  v_mul_f32 v121, v121, v122
  v_mul_f32 v121, v121, v122
  v_cvt_pk_bf16_f32 v121, v121, v121
  v_lshlrev_b32 v121, 16, v121
  v_add_f32 v121, 0x3727c5ac, v121
  v_cvt_pk_bf16_f32 v121, v121, v121
  v_lshlrev_b32 v121, 16, v121
  v_sqrt_f32 v121, v121
  s_nop 0
  v_cvt_pk_bf16_f32 v121, v121, v121
  v_lshlrev_b32 v121, 16, v121
  v_rcp_f32 v121, v121
  s_nop 0
  v_mul_f32 v124, v122, v121
  v_mul_f32 v125, v120, v124
  v_mov_b32 v126, v124
  v_mov_b32 v127, v125
  s_nop 0
  v_permlane32_swap_b32 v124, v126
  v_permlane32_swap_b32 v125, v127
  v_pk_fma_f32 v[104:105], v[104:105], v[124:125], v[124:125] op_sel:[0,0,1] op_sel_hi:[1,0,1]
  v_pk_fma_f32 v[106:107], v[106:107], v[124:125], v[124:125] op_sel:[0,0,1] op_sel_hi:[1,0,1]
  v_pk_fma_f32 v[108:109], v[108:109], v[126:127], v[126:127] op_sel:[0,0,1] op_sel_hi:[1,0,1]
  v_pk_fma_f32 v[110:111], v[110:111], v[126:127], v[126:127] op_sel:[0,0,1] op_sel_hi:[1,0,1]
  v_cvt_pk_bf16_f32 v64, v104, v105
  v_cvt_pk_bf16_f32 v65, v106, v107
  v_cvt_pk_bf16_f32 v66, v108, v109
  v_cvt_pk_bf16_f32 v67, v110, v111
  buffer_store_dwordx4 v[64:67], v2, s[20:23], s52 offen offset:0 sc1
  v_pk_fma_f32 v[112:113], v[112:113], v[124:125], v[124:125] op_sel:[0,0,1] op_sel_hi:[1,0,1]
  v_pk_fma_f32 v[114:115], v[114:115], v[124:125], v[124:125] op_sel:[0,0,1] op_sel_hi:[1,0,1]
  v_pk_fma_f32 v[116:117], v[116:117], v[126:127], v[126:127] op_sel:[0,0,1] op_sel_hi:[1,0,1]
  v_pk_fma_f32 v[118:119], v[118:119], v[126:127], v[126:127] op_sel:[0,0,1] op_sel_hi:[1,0,1]
  v_cvt_pk_bf16_f32 v68, v112, v113
  v_cvt_pk_bf16_f32 v69, v114, v115
  v_cvt_pk_bf16_f32 v70, v116, v117
  v_cvt_pk_bf16_f32 v71, v118, v119
  buffer_store_dwordx4 v[68:71], v2, s[20:23], s52 offen offset:1024 sc1
  v_lshlrev_b32 v144, 16, v148
  v_and_b32 v145, s6, v148
  v_lshlrev_b32 v146, 16, v149
  v_and_b32 v147, s6, v149
  v_lshlrev_b32 v152, 16, v156
  v_and_b32 v153, s6, v156
  v_lshlrev_b32 v154, 16, v157
  v_and_b32 v155, s6, v157
  v_lshlrev_b32 v160, 16, v164
  v_and_b32 v161, s6, v164
  v_lshlrev_b32 v162, 16, v165
  v_and_b32 v163, s6, v165
  v_lshlrev_b32 v168, 16, v172
  v_and_b32 v169, s6, v172
  v_lshlrev_b32 v170, 16, v173
  v_and_b32 v171, s6, v173
  v_lshlrev_b32 v176, 16, v180
  v_and_b32 v177, s6, v180
  v_lshlrev_b32 v178, 16, v181
  v_and_b32 v179, s6, v181
  v_lshlrev_b32 v184, 16, v188
  v_and_b32 v185, s6, v188
  v_lshlrev_b32 v186, 16, v189
  v_and_b32 v187, s6, v189
  v_lshlrev_b32 v192, 16, v196
  v_and_b32 v193, s6, v196
  v_lshlrev_b32 v194, 16, v197
  v_and_b32 v195, s6, v197
  s_waitcnt vmcnt(0)
  v_mov_b32 v5, 1
  s_mov_b64 exec, 1
  buffer_store_dword v5, v4, s[20:23], s54 offen sc1
  s_mov_b64 exec, -1
  buffer_load_dword v13, v11, s[20:23], s55 offen sc1
  s_lshl_b32 s16, s4, 2
  s_lshr_b32 s17, s5, 3
  s_add_u32 s16, s16, s17
  s_lshl_b32 s16, s16, 1
  s_lshl_b32 s17, s16, 4
  s_lshl_b32 s18, s3, 2
  s_add_u32 s17, s17, s18
  s_xor_b32 s19, s56, 0
  s_add_u32 s19, s19, s17
  s_lshl_b32 s8, s19, 11
  s_add_u32 s12, s8, 32768
  s_xor_b32 s19, s56, 1
  s_add_u32 s19, s19, s17
  s_lshl_b32 s9, s19, 11
  s_add_u32 s13, s9, 32768
  s_xor_b32 s19, s56, 2
  s_add_u32 s19, s19, s17
  s_lshl_b32 s10, s19, 11
  s_add_u32 s14, s10, 32768
  s_xor_b32 s19, s56, 3
  s_add_u32 s19, s19, s17
  s_lshl_b32 s11, s19, 11
  s_add_u32 s15, s11, 32768
  s_lshr_b32 s17, s5, 3
  s_lshl_b32 s17, s17, 7
  s_lshl_b32 s18, s3, 5
  s_add_u32 s17, s17, s18
  s_lshl_b32 s18, s4, 11
  s_add_u32 s17, s17, s18
  s_add_u32 s17, s17, 6292992
  v_and_b32 v15, 7, v1
  v_lshlrev_b32 v15, 2, v15
  s_barrier
  ds_read_b64_tr_b16 v[200:201], v6 offset:0
  ds_read_b64_tr_b16 v[202:203], v6 offset:3584
  ds_read_b64_tr_b16 v[204:205], v6 offset:32
  ds_read_b64_tr_b16 v[206:207], v6 offset:3616
  ds_read_b64_tr_b16 v[208:209], v6 offset:64
  ds_read_b64_tr_b16 v[210:211], v6 offset:3648
  ds_read_b64_tr_b16 v[212:213], v6 offset:96
  ds_read_b64_tr_b16 v[214:215], v6 offset:3680
  s_waitcnt vmcnt(0)
  v_cmp_gt_u32 vcc, 1, v13
  s_nop 4
  s_cbranch_vccz s_hp_ok
  s_mov_b32 s69, 0
s_hp:
  buffer_load_dword v13, v11, s[20:23], s55 offen offset:0 sc1
  s_add_u32 s69, s69, 1
  s_waitcnt vmcnt(0)
  v_cmp_gt_u32 vcc, 1, v13
  s_cmp_ge_u32 s69, 4000
  s_cbranch_scc1 s_hp_out
  s_nop 3
  s_cbranch_vccnz s_hp
s_hp_out:
s_hp_ok:
  buffer_load_dwordx4 v[16:19], v3, s[20:23], s67 offen offset:0 sc1
  buffer_load_dwordx4 v[20:23], v3, s[20:23], s67 offen offset:256 sc1
  buffer_load_dwordx4 v[24:27], v3, s[20:23], s67 offen offset:512 sc1
  buffer_load_dwordx4 v[28:31], v3, s[20:23], s67 offen offset:768 sc1
  buffer_load_dwordx4 v[32:35], v3, s[20:23], s67 offen offset:1024 sc1
  buffer_load_dwordx4 v[36:39], v3, s[20:23], s67 offen offset:1280 sc1
  buffer_load_dwordx4 v[40:43], v3, s[20:23], s67 offen offset:1536 sc1
  buffer_load_dwordx4 v[44:47], v3, s[20:23], s67 offen offset:1792 sc1
  buffer_load_dwordx4 v[48:51], v3, s[20:23], s67 offen offset:2048 sc1
  buffer_load_dwordx4 v[52:55], v3, s[20:23], s67 offen offset:2304 sc1
  buffer_load_dwordx4 v[56:59], v3, s[20:23], s67 offen offset:2560 sc1
  buffer_load_dwordx4 v[60:63], v3, s[20:23], s67 offen offset:2816 sc1
  s_waitcnt vmcnt(10)
  v_swap_b32 v18, v20
  v_swap_b32 v19, v21
  s_waitcnt lgkmcnt(6)
  s_nop 0
  v_mfma_f32_16x16x32_bf16 v[148:151], v[200:203], v[20:23], v[144:147]
  buffer_load_dwordx4 v[64:67], v3, s[20:23], s67 offen offset:3072 sc1
  buffer_load_dwordx4 v[68:71], v3, s[20:23], s67 offen offset:3328 sc1
  v_mfma_f32_16x16x32_bf16 v[144:147], v[200:203], v[16:19], v[144:147]
  ds_read_b64_tr_b16 v[216:217], v6 offset:192
  s_waitcnt lgkmcnt(5)
  v_mfma_f32_16x16x32_bf16 v[156:159], v[204:207], v[20:23], v[152:155]
  ds_read_b64_tr_b16 v[218:219], v6 offset:3776
  ds_read_b64_tr_b16 v[220:221], v6 offset:7168
  v_mfma_f32_16x16x32_bf16 v[152:155], v[204:207], v[16:19], v[152:155]
  ds_read_b64_tr_b16 v[222:223], v6 offset:10752
  s_waitcnt lgkmcnt(6)
  v_mfma_f32_16x16x32_bf16 v[164:167], v[208:211], v[20:23], v[160:163]
  ds_read_b64_tr_b16 v[200:201], v6 offset:7200
  ds_read_b64_tr_b16 v[202:203], v6 offset:10784
  v_mfma_f32_16x16x32_bf16 v[160:163], v[208:211], v[16:19], v[160:163]
  ds_read_b64_tr_b16 v[204:205], v6 offset:7232
  s_waitcnt lgkmcnt(7)
  v_mfma_f32_16x16x32_bf16 v[172:175], v[212:215], v[20:23], v[168:171]
  s_waitcnt vmcnt(10)
  ds_read_b64_tr_b16 v[206:207], v6 offset:10816
  v_mfma_f32_16x16x32_bf16 v[168:171], v[212:215], v[16:19], v[168:171]
  v_swap_b32 v26, v28
  s_waitcnt lgkmcnt(6)
  v_mfma_f32_16x16x32_bf16 v[196:199], v[216:219], v[20:23], v[192:195]
  v_swap_b32 v27, v29
  v_mfma_f32_16x16x32_bf16 v[192:195], v[216:219], v[16:19], v[192:195]
  ds_read_b64_tr_b16 v[208:209], v6 offset:7264
  s_waitcnt lgkmcnt(3)
  v_mfma_f32_16x16x32_bf16 v[148:151], v[220:223], v[28:31], v[148:151]
  ds_read_b64_tr_b16 v[210:211], v6 offset:10848
  buffer_load_dwordx4 v[72:75], v3, s[20:23], s67 offen offset:3584 sc1
  v_mfma_f32_16x16x32_bf16 v[144:147], v[220:223], v[24:27], v[144:147]
  ds_read_b64_tr_b16 v[212:213], v6 offset:7360
  ds_read_b64_tr_b16 v[214:215], v6 offset:10944
  v_mfma_f32_16x16x32_bf16 v[156:159], v[200:203], v[28:31], v[156:159]
  buffer_load_dwordx4 v[76:79], v3, s[20:23], s67 offen offset:3840 sc1
  ds_read_b64_tr_b16 v[216:217], v6 offset:14336
  v_mfma_f32_16x16x32_bf16 v[152:155], v[200:203], v[24:27], v[152:155]
  ds_read_b64_tr_b16 v[218:219], v6 offset:17920
  s_waitcnt lgkmcnt(6)
  v_mfma_f32_16x16x32_bf16 v[164:167], v[204:207], v[28:31], v[164:167]
  ds_read_b64_tr_b16 v[220:221], v6 offset:14368
  ds_read_b64_tr_b16 v[222:223], v6 offset:17952
  v_mfma_f32_16x16x32_bf16 v[160:163], v[204:207], v[24:27], v[160:163]
  ds_read_b64_tr_b16 v[200:201], v6 offset:14400
  s_waitcnt lgkmcnt(7)
  v_mfma_f32_16x16x32_bf16 v[172:175], v[208:211], v[28:31], v[172:175]
  s_waitcnt vmcnt(10)
  ds_read_b64_tr_b16 v[202:203], v6 offset:17984
  v_mfma_f32_16x16x32_bf16 v[168:171], v[208:211], v[24:27], v[168:171]
  v_swap_b32 v34, v36
  s_waitcnt lgkmcnt(6)
  v_mfma_f32_16x16x32_bf16 v[196:199], v[212:215], v[28:31], v[196:199]
  v_swap_b32 v35, v37
  v_mfma_f32_16x16x32_bf16 v[192:195], v[212:215], v[24:27], v[192:195]
  ds_read_b64_tr_b16 v[204:205], v6 offset:14432
  s_waitcnt lgkmcnt(3)
  v_mfma_f32_16x16x32_bf16 v[148:151], v[216:219], v[36:39], v[148:151]
  ds_read_b64_tr_b16 v[206:207], v6 offset:18016
  buffer_load_dwordx4 v[80:83], v3, s[20:23], s59 offen offset:0 sc1
  v_mfma_f32_16x16x32_bf16 v[144:147], v[216:219], v[32:35], v[144:147]
  ds_read_b64_tr_b16 v[208:209], v6 offset:14528
  ds_read_b64_tr_b16 v[210:211], v6 offset:18112
  v_mfma_f32_16x16x32_bf16 v[156:159], v[220:223], v[36:39], v[156:159]
  buffer_load_dwordx4 v[84:87], v3, s[20:23], s59 offen offset:256 sc1
  ds_read_b64_tr_b16 v[212:213], v6 offset:21504
  v_mfma_f32_16x16x32_bf16 v[152:155], v[220:223], v[32:35], v[152:155]
  ds_read_b64_tr_b16 v[214:215], v6 offset:25088
  s_waitcnt lgkmcnt(6)
  v_mfma_f32_16x16x32_bf16 v[164:167], v[200:203], v[36:39], v[164:167]
  buffer_load_dwordx4 v[88:91], v3, s[20:23], s59 offen offset:512 sc1
  buffer_load_dwordx4 v[92:95], v3, s[20:23], s59 offen offset:768 sc1
  v_mfma_f32_16x16x32_bf16 v[160:163], v[200:203], v[32:35], v[160:163]
  ds_read_b64_tr_b16 v[216:217], v6 offset:21536
  s_waitcnt lgkmcnt(5)
  v_mfma_f32_16x16x32_bf16 v[172:175], v[204:207], v[36:39], v[172:175]
  ds_read_b64_tr_b16 v[218:219], v6 offset:25120
  s_waitcnt vmcnt(12)
  v_mfma_f32_16x16x32_bf16 v[168:171], v[204:207], v[32:35], v[168:171]
  ds_read_b64_tr_b16 v[220:221], v6 offset:21568
  s_waitcnt lgkmcnt(5)
  v_mfma_f32_16x16x32_bf16 v[196:199], v[208:211], v[36:39], v[196:199]
  ds_read_b64_tr_b16 v[222:223], v6 offset:25152
  ds_read_b64_tr_b16 v[200:201], v6 offset:21600
  v_mfma_f32_16x16x32_bf16 v[192:195], v[208:211], v[32:35], v[192:195]
  ds_read_b64_tr_b16 v[202:203], v6 offset:25184
  s_waitcnt lgkmcnt(6)
  v_swap_b32 v42, v44
  v_swap_b32 v43, v45
  s_nop 1
  v_mfma_f32_16x16x32_bf16 v[148:151], v[212:215], v[44:47], v[148:151]
  ds_read_b64_tr_b16 v[204:205], v6 offset:21696
  ds_read_b64_tr_b16 v[206:207], v6 offset:25280
  v_mfma_f32_16x16x32_bf16 v[144:147], v[212:215], v[40:43], v[144:147]
  ds_read_b64_tr_b16 v[208:209], v6 offset:28672
  s_waitcnt lgkmcnt(7)
  v_mfma_f32_16x16x32_bf16 v[156:159], v[216:219], v[44:47], v[156:159]
  buffer_load_dwordx4 v[96:99], v3, s[20:23], s59 offen offset:1024 sc1
  buffer_load_dwordx4 v[100:103], v3, s[20:23], s59 offen offset:1280 sc1
  v_mfma_f32_16x16x32_bf16 v[152:155], v[216:219], v[40:43], v[152:155]
  ds_read_b64_tr_b16 v[210:211], v6 offset:32256
  s_waitcnt lgkmcnt(6)
  v_mfma_f32_16x16x32_bf16 v[164:167], v[220:223], v[44:47], v[164:167]
  ds_read_b64_tr_b16 v[212:213], v6 offset:28704
  ds_read_b64_tr_b16 v[214:215], v6 offset:32288
  v_mfma_f32_16x16x32_bf16 v[160:163], v[220:223], v[40:43], v[160:163]
  ds_read_b64_tr_b16 v[216:217], v6 offset:28736
  s_waitcnt lgkmcnt(5)
  v_mfma_f32_16x16x32_bf16 v[172:175], v[200:203], v[44:47], v[172:175]
  s_waitcnt vmcnt(12)
  ds_read_b64_tr_b16 v[218:219], v6 offset:32320
  v_mfma_f32_16x16x32_bf16 v[168:171], v[200:203], v[40:43], v[168:171]
  v_swap_b32 v50, v52
  v_mfma_f32_16x16x32_bf16 v[196:199], v[204:207], v[44:47], v[196:199]
  v_swap_b32 v51, v53
  v_mfma_f32_16x16x32_bf16 v[192:195], v[204:207], v[40:43], v[192:195]
  ds_read_b64_tr_b16 v[220:221], v6 offset:28768
  s_waitcnt lgkmcnt(3)
  v_mfma_f32_16x16x32_bf16 v[148:151], v[208:211], v[52:55], v[148:151]
  ds_read_b64_tr_b16 v[222:223], v6 offset:32352
  buffer_load_dwordx4 v[104:107], v3, s[20:23], s59 offen offset:1536 sc1
  v_mfma_f32_16x16x32_bf16 v[144:147], v[208:211], v[48:51], v[144:147]
  ds_read_b64_tr_b16 v[200:201], v6 offset:28864
  ds_read_b64_tr_b16 v[202:203], v6 offset:32448
  v_mfma_f32_16x16x32_bf16 v[156:159], v[212:215], v[52:55], v[156:159]
  buffer_load_dwordx4 v[108:111], v3, s[20:23], s59 offen offset:1792 sc1
  ds_read_b64_tr_b16 v[204:205], v6 offset:35840
  v_mfma_f32_16x16x32_bf16 v[152:155], v[212:215], v[48:51], v[152:155]
  ds_read_b64_tr_b16 v[206:207], v6 offset:39424
  s_waitcnt lgkmcnt(6)
  v_mfma_f32_16x16x32_bf16 v[164:167], v[216:219], v[52:55], v[164:167]
  ds_read_b64_tr_b16 v[208:209], v6 offset:35872
  ds_read_b64_tr_b16 v[210:211], v6 offset:39456
  v_mfma_f32_16x16x32_bf16 v[160:163], v[216:219], v[48:51], v[160:163]
  ds_read_b64_tr_b16 v[212:213], v6 offset:35904
  s_waitcnt lgkmcnt(7)
  v_mfma_f32_16x16x32_bf16 v[172:175], v[220:223], v[52:55], v[172:175]
  s_waitcnt vmcnt(12)
  ds_read_b64_tr_b16 v[214:215], v6 offset:39488
  v_mfma_f32_16x16x32_bf16 v[168:171], v[220:223], v[48:51], v[168:171]
  v_swap_b32 v58, v60
  s_waitcnt lgkmcnt(6)
  v_mfma_f32_16x16x32_bf16 v[196:199], v[200:203], v[52:55], v[196:199]
  v_swap_b32 v59, v61
  v_mfma_f32_16x16x32_bf16 v[192:195], v[200:203], v[48:51], v[192:195]
  ds_read_b64_tr_b16 v[216:217], v6 offset:35936
  s_waitcnt lgkmcnt(3)
  v_mfma_f32_16x16x32_bf16 v[148:151], v[204:207], v[60:63], v[148:151]
  ds_read_b64_tr_b16 v[218:219], v6 offset:39520
  buffer_load_dwordx4 v[112:115], v3, s[20:23], s59 offen offset:2048 sc1
  v_mfma_f32_16x16x32_bf16 v[144:147], v[204:207], v[56:59], v[144:147]
  ds_read_b64_tr_b16 v[220:221], v6 offset:36032
  ds_read_b64_tr_b16 v[222:223], v6 offset:39616
  v_mfma_f32_16x16x32_bf16 v[156:159], v[208:211], v[60:63], v[156:159]
  buffer_load_dwordx4 v[116:119], v3, s[20:23], s59 offen offset:2304 sc1
  ds_read_b64_tr_b16 v[200:201], v6 offset:43008
  v_mfma_f32_16x16x32_bf16 v[152:155], v[208:211], v[56:59], v[152:155]
  ds_read_b64_tr_b16 v[202:203], v6 offset:46592
  s_waitcnt lgkmcnt(6)
  v_mfma_f32_16x16x32_bf16 v[164:167], v[212:215], v[60:63], v[164:167]
  ds_read_b64_tr_b16 v[204:205], v6 offset:43040
  ds_read_b64_tr_b16 v[206:207], v6 offset:46624
  v_mfma_f32_16x16x32_bf16 v[160:163], v[212:215], v[56:59], v[160:163]
  ds_read_b64_tr_b16 v[208:209], v6 offset:43072
  s_waitcnt lgkmcnt(7)
  v_mfma_f32_16x16x32_bf16 v[172:175], v[216:219], v[60:63], v[172:175]
  s_waitcnt vmcnt(12)
  ds_read_b64_tr_b16 v[210:211], v6 offset:46656
  v_mfma_f32_16x16x32_bf16 v[168:171], v[216:219], v[56:59], v[168:171]
  v_swap_b32 v66, v68
  s_waitcnt lgkmcnt(6)
  v_mfma_f32_16x16x32_bf16 v[196:199], v[220:223], v[60:63], v[196:199]
  v_swap_b32 v67, v69
  v_mfma_f32_16x16x32_bf16 v[192:195], v[220:223], v[56:59], v[192:195]
  ds_read_b64_tr_b16 v[212:213], v6 offset:43104
  s_waitcnt lgkmcnt(3)
  v_mfma_f32_16x16x32_bf16 v[148:151], v[200:203], v[68:71], v[148:151]
  ds_read_b64_tr_b16 v[214:215], v6 offset:46688
  buffer_load_dwordx4 v[120:123], v3, s[20:23], s59 offen offset:2560 sc1
  v_mfma_f32_16x16x32_bf16 v[144:147], v[200:203], v[64:67], v[144:147]
  ds_read_b64_tr_b16 v[216:217], v6 offset:43200
  ds_read_b64_tr_b16 v[218:219], v6 offset:46784
  v_mfma_f32_16x16x32_bf16 v[156:159], v[204:207], v[68:71], v[156:159]
  buffer_load_dwordx4 v[124:127], v3, s[20:23], s59 offen offset:2816 sc1
  ds_read_b64_tr_b16 v[220:221], v6 offset:50176
  v_mfma_f32_16x16x32_bf16 v[152:155], v[204:207], v[64:67], v[152:155]
  ds_read_b64_tr_b16 v[222:223], v6 offset:53760
  s_waitcnt lgkmcnt(6)
  v_mfma_f32_16x16x32_bf16 v[164:167], v[208:211], v[68:71], v[164:167]
  buffer_load_dwordx4 v[128:131], v3, s[20:23], s59 offen offset:3072 sc1
  buffer_load_dwordx4 v[132:135], v3, s[20:23], s59 offen offset:3328 sc1
  v_mfma_f32_16x16x32_bf16 v[160:163], v[208:211], v[64:67], v[160:163]
  ds_read_b64_tr_b16 v[200:201], v6 offset:50208
  s_waitcnt lgkmcnt(5)
  v_mfma_f32_16x16x32_bf16 v[172:175], v[212:215], v[68:71], v[172:175]
  ds_read_b64_tr_b16 v[202:203], v6 offset:53792
  s_waitcnt vmcnt(14)
  v_mfma_f32_16x16x32_bf16 v[168:171], v[212:215], v[64:67], v[168:171]
  ds_read_b64_tr_b16 v[204:205], v6 offset:50240
  s_waitcnt lgkmcnt(5)
  v_mfma_f32_16x16x32_bf16 v[196:199], v[216:219], v[68:71], v[196:199]
  ds_read_b64_tr_b16 v[206:207], v6 offset:53824
  ds_read_b64_tr_b16 v[208:209], v6 offset:50272
  v_mfma_f32_16x16x32_bf16 v[192:195], v[216:219], v[64:67], v[192:195]
  ds_read_b64_tr_b16 v[210:211], v6 offset:53856
  s_waitcnt lgkmcnt(6)
  v_swap_b32 v74, v76
  v_swap_b32 v75, v77
  s_nop 1
  v_mfma_f32_16x16x32_bf16 v[148:151], v[220:223], v[76:79], v[148:151]
  ds_read_b64_tr_b16 v[212:213], v6 offset:50368
  ds_read_b64_tr_b16 v[214:215], v6 offset:53952
  v_mfma_f32_16x16x32_bf16 v[144:147], v[220:223], v[72:75], v[144:147]
  ds_read_b64_tr_b16 v[216:217], v7 offset:0
  s_waitcnt lgkmcnt(7)
  v_mfma_f32_16x16x32_bf16 v[156:159], v[200:203], v[76:79], v[156:159]
  buffer_load_dwordx4 v[136:139], v3, s[20:23], s59 offen offset:3584 sc1
  buffer_load_dwordx4 v[140:143], v3, s[20:23], s59 offen offset:3840 sc1
  v_mfma_f32_16x16x32_bf16 v[152:155], v[200:203], v[72:75], v[152:155]
  ds_read_b64_tr_b16 v[218:219], v7 offset:3584
  s_waitcnt lgkmcnt(6)
  v_mfma_f32_16x16x32_bf16 v[164:167], v[204:207], v[76:79], v[164:167]
  ds_read_b64_tr_b16 v[220:221], v7 offset:32
  ds_read_b64_tr_b16 v[222:223], v7 offset:3616
  v_mfma_f32_16x16x32_bf16 v[160:163], v[204:207], v[72:75], v[160:163]
  ds_read_b64_tr_b16 v[200:201], v7 offset:64
  s_waitcnt lgkmcnt(5)
  v_mfma_f32_16x16x32_bf16 v[172:175], v[208:211], v[76:79], v[172:175]
  s_waitcnt vmcnt(14)
  ds_read_b64_tr_b16 v[202:203], v7 offset:3648
  v_mfma_f32_16x16x32_bf16 v[168:171], v[208:211], v[72:75], v[168:171]
  v_swap_b32 v82, v84
  v_mfma_f32_16x16x32_bf16 v[196:199], v[212:215], v[76:79], v[196:199]
  v_swap_b32 v83, v85
  v_mfma_f32_16x16x32_bf16 v[192:195], v[212:215], v[72:75], v[192:195]
  ds_read_b64_tr_b16 v[204:205], v7 offset:96
  s_waitcnt lgkmcnt(3)
  v_mfma_f32_16x16x32_bf16 v[148:151], v[216:219], v[84:87], v[148:151]
  ds_read_b64_tr_b16 v[206:207], v7 offset:3680
  ds_read_b64_tr_b16 v[208:209], v7 offset:192
  v_mfma_f32_16x16x32_bf16 v[144:147], v[216:219], v[80:83], v[144:147]
  ds_read_b64_tr_b16 v[210:211], v7 offset:3776
  ds_read_b64_tr_b16 v[212:213], v7 offset:7168
  v_mfma_f32_16x16x32_bf16 v[156:159], v[220:223], v[84:87], v[156:159]
  ds_read_b64_tr_b16 v[214:215], v7 offset:10752
  ds_read_b64_tr_b16 v[216:217], v7 offset:7200
  v_mfma_f32_16x16x32_bf16 v[152:155], v[220:223], v[80:83], v[152:155]
  ds_read_b64_tr_b16 v[218:219], v7 offset:10784
  s_waitcnt lgkmcnt(8)
  v_mfma_f32_16x16x32_bf16 v[164:167], v[200:203], v[84:87], v[164:167]
  s_add_u32 s57, s24, s94
  buffer_load_dwordx4 a[0:3], v8, s[36:39], s57 offen offset:0
  v_mfma_f32_16x16x32_bf16 v[160:163], v[200:203], v[80:83], v[160:163]
  ds_read_b64_tr_b16 v[220:221], v7 offset:7232
  s_waitcnt lgkmcnt(7)
  v_mfma_f32_16x16x32_bf16 v[172:175], v[204:207], v[84:87], v[172:175]
  s_waitcnt vmcnt(13)
  ds_read_b64_tr_b16 v[222:223], v7 offset:10816
  v_mfma_f32_16x16x32_bf16 v[168:171], v[204:207], v[80:83], v[168:171]
  v_swap_b32 v90, v92
  s_waitcnt lgkmcnt(4)
  v_mfma_f32_16x16x32_bf16 v[196:199], v[208:211], v[84:87], v[196:199]
  v_swap_b32 v91, v93
  v_mfma_f32_16x16x32_bf16 v[192:195], v[208:211], v[80:83], v[192:195]
  ds_read_b64_tr_b16 v[200:201], v7 offset:7264
  ds_read_b64_tr_b16 v[202:203], v7 offset:10848
  v_mfma_f32_16x16x32_bf16 v[148:151], v[212:215], v[92:95], v[148:151]
  buffer_load_dwordx4 a[4:7], v8, s[36:39], s57 offen offset:1024
  ds_read_b64_tr_b16 v[204:205], v7 offset:7360
  v_mfma_f32_16x16x32_bf16 v[144:147], v[212:215], v[88:91], v[144:147]
  ds_read_b64_tr_b16 v[206:207], v7 offset:10944
  s_waitcnt lgkmcnt(4)
  v_mfma_f32_16x16x32_bf16 v[156:159], v[216:219], v[92:95], v[156:159]
  buffer_load_dwordx4 a[8:11], v8, s[36:39], s57 offen offset:2048
  ds_read_b64_tr_b16 v[208:209], v7 offset:14336
  v_mfma_f32_16x16x32_bf16 v[152:155], v[216:219], v[88:91], v[152:155]
  ds_read_b64_tr_b16 v[210:211], v7 offset:17920
  ds_read_b64_tr_b16 v[212:213], v7 offset:14368
  v_mfma_f32_16x16x32_bf16 v[164:167], v[220:223], v[92:95], v[164:167]
  ds_read_b64_tr_b16 v[214:215], v7 offset:17952
  ds_read_b64_tr_b16 v[216:217], v7 offset:14400
  v_mfma_f32_16x16x32_bf16 v[160:163], v[220:223], v[88:91], v[160:163]
  ds_read_b64_tr_b16 v[218:219], v7 offset:17984
  s_waitcnt lgkmcnt(8)
  v_mfma_f32_16x16x32_bf16 v[172:175], v[200:203], v[92:95], v[172:175]
  s_waitcnt vmcnt(13)
  ds_read_b64_tr_b16 v[220:221], v7 offset:14432
  v_mfma_f32_16x16x32_bf16 v[168:171], v[200:203], v[88:91], v[168:171]
  v_swap_b32 v98, v100
  s_waitcnt lgkmcnt(7)
  v_mfma_f32_16x16x32_bf16 v[196:199], v[204:207], v[92:95], v[196:199]
  v_swap_b32 v99, v101
  v_mfma_f32_16x16x32_bf16 v[192:195], v[204:207], v[88:91], v[192:195]
  ds_read_b64_tr_b16 v[222:223], v7 offset:18016
  s_waitcnt lgkmcnt(4)
  v_mfma_f32_16x16x32_bf16 v[148:151], v[208:211], v[100:103], v[148:151]
  buffer_load_dwordx4 a[12:15], v8, s[36:39], s57 offen offset:3072
  s_add_u32 s57, s25, s94
  v_mfma_f32_16x16x32_bf16 v[144:147], v[208:211], v[96:99], v[144:147]
  ds_read_b64_tr_b16 v[200:201], v7 offset:14528
  ds_read_b64_tr_b16 v[202:203], v7 offset:18112
  v_mfma_f32_16x16x32_bf16 v[156:159], v[212:215], v[100:103], v[156:159]
  buffer_load_dwordx4 a[16:19], v8, s[36:39], s57 offen offset:0
  ds_read_b64_tr_b16 v[204:205], v7 offset:21504
  v_mfma_f32_16x16x32_bf16 v[152:155], v[212:215], v[96:99], v[152:155]
  ds_read_b64_tr_b16 v[206:207], v7 offset:25088
  s_waitcnt lgkmcnt(6)
  v_mfma_f32_16x16x32_bf16 v[164:167], v[216:219], v[100:103], v[164:167]
  buffer_load_dwordx4 a[20:23], v8, s[36:39], s57 offen offset:1024
  ds_read_b64_tr_b16 v[208:209], v7 offset:21536
  v_mfma_f32_16x16x32_bf16 v[160:163], v[216:219], v[96:99], v[160:163]
  ds_read_b64_tr_b16 v[210:211], v7 offset:25120
  s_waitcnt lgkmcnt(6)
  v_mfma_f32_16x16x32_bf16 v[172:175], v[220:223], v[100:103], v[172:175]
  s_waitcnt vmcnt(14)
  ds_read_b64_tr_b16 v[212:213], v7 offset:21568
  v_mfma_f32_16x16x32_bf16 v[168:171], v[220:223], v[96:99], v[168:171]
  ds_read_b64_tr_b16 v[214:215], v7 offset:25152
  s_waitcnt lgkmcnt(6)
  v_mfma_f32_16x16x32_bf16 v[196:199], v[200:203], v[100:103], v[196:199]
  v_swap_b32 v106, v108
  v_mfma_f32_16x16x32_bf16 v[192:195], v[200:203], v[96:99], v[192:195]
  ds_read_b64_tr_b16 v[216:217], v7 offset:21600
  s_waitcnt lgkmcnt(5)
  v_swap_b32 v107, v109
  s_nop 1
  v_mfma_f32_16x16x32_bf16 v[148:151], v[204:207], v[108:111], v[148:151]
  ds_read_b64_tr_b16 v[218:219], v7 offset:25184
  buffer_load_dwordx4 a[24:27], v8, s[36:39], s57 offen offset:2048
  v_mfma_f32_16x16x32_bf16 v[144:147], v[204:207], v[104:107], v[144:147]
  ds_read_b64_tr_b16 v[220:221], v7 offset:21696
  s_waitcnt lgkmcnt(5)
  v_mfma_f32_16x16x32_bf16 v[156:159], v[208:211], v[108:111], v[156:159]
  ds_read_b64_tr_b16 v[222:223], v7 offset:25280
  buffer_load_dwordx4 a[28:31], v8, s[36:39], s57 offen offset:3072
  v_mfma_f32_16x16x32_bf16 v[152:155], v[208:211], v[104:107], v[152:155]
  ds_read_b64_tr_b16 v[200:201], v7 offset:28672
  s_waitcnt lgkmcnt(5)
  v_mfma_f32_16x16x32_bf16 v[164:167], v[212:215], v[108:111], v[164:167]
  ds_read_b64_tr_b16 v[202:203], v7 offset:32256
  ds_read_b64_tr_b16 v[204:205], v7 offset:28704
  v_mfma_f32_16x16x32_bf16 v[160:163], v[212:215], v[104:107], v[160:163]
  ds_read_b64_tr_b16 v[206:207], v7 offset:32288
  s_waitcnt lgkmcnt(6)
  v_mfma_f32_16x16x32_bf16 v[172:175], v[216:219], v[108:111], v[172:175]
  s_waitcnt vmcnt(14)
  ds_read_b64_tr_b16 v[208:209], v7 offset:28736
  v_mfma_f32_16x16x32_bf16 v[168:171], v[216:219], v[104:107], v[168:171]
  ds_read_b64_tr_b16 v[210:211], v7 offset:32320
  s_waitcnt lgkmcnt(6)
  v_mfma_f32_16x16x32_bf16 v[196:199], v[220:223], v[108:111], v[196:199]
  v_swap_b32 v114, v116
  v_mfma_f32_16x16x32_bf16 v[192:195], v[220:223], v[104:107], v[192:195]
  ds_read_b64_tr_b16 v[212:213], v7 offset:28768
  s_waitcnt lgkmcnt(5)
  v_swap_b32 v115, v117
  s_nop 1
  v_mfma_f32_16x16x32_bf16 v[148:151], v[200:203], v[116:119], v[148:151]
  ds_read_b64_tr_b16 v[214:215], v7 offset:32352
  s_add_u32 s57, s26, s94
  v_mfma_f32_16x16x32_bf16 v[144:147], v[200:203], v[112:115], v[144:147]
  ds_read_b64_tr_b16 v[216:217], v7 offset:28864
  s_waitcnt lgkmcnt(5)
  v_mfma_f32_16x16x32_bf16 v[156:159], v[204:207], v[116:119], v[156:159]
  ds_read_b64_tr_b16 v[218:219], v7 offset:32448
  buffer_load_dwordx4 a[32:35], v8, s[36:39], s57 offen offset:0
  v_mfma_f32_16x16x32_bf16 v[152:155], v[204:207], v[112:115], v[152:155]
  ds_read_b64_tr_b16 v[220:221], v7 offset:35840
  s_waitcnt lgkmcnt(5)
  v_mfma_f32_16x16x32_bf16 v[164:167], v[208:211], v[116:119], v[164:167]
  ds_read_b64_tr_b16 v[222:223], v7 offset:39424
  buffer_load_dwordx4 a[36:39], v8, s[36:39], s57 offen offset:1024
  v_mfma_f32_16x16x32_bf16 v[160:163], v[208:211], v[112:115], v[160:163]
  ds_read_b64_tr_b16 v[200:201], v7 offset:35872
  s_waitcnt lgkmcnt(5)
  v_mfma_f32_16x16x32_bf16 v[172:175], v[212:215], v[116:119], v[172:175]
  ds_read_b64_tr_b16 v[202:203], v7 offset:39456
  buffer_load_dwordx4 a[40:43], v8, s[36:39], s57 offen offset:2048
  v_mfma_f32_16x16x32_bf16 v[168:171], v[212:215], v[112:115], v[168:171]
  ds_read_b64_tr_b16 v[204:205], v7 offset:35904
  s_waitcnt lgkmcnt(5)
  v_mfma_f32_16x16x32_bf16 v[196:199], v[216:219], v[116:119], v[196:199]
  ds_read_b64_tr_b16 v[206:207], v7 offset:39488
  s_waitcnt vmcnt(15)
  v_mfma_f32_16x16x32_bf16 v[192:195], v[216:219], v[112:115], v[192:195]
  ds_read_b64_tr_b16 v[208:209], v7 offset:35936
  s_waitcnt lgkmcnt(5)
  v_swap_b32 v122, v124
  v_swap_b32 v123, v125
  s_nop 1
  v_mfma_f32_16x16x32_bf16 v[148:151], v[220:223], v[124:127], v[148:151]
  ds_read_b64_tr_b16 v[210:211], v7 offset:39520
  buffer_load_dwordx4 a[44:47], v8, s[36:39], s57 offen offset:3072
  v_mfma_f32_16x16x32_bf16 v[144:147], v[220:223], v[120:123], v[144:147]
  ds_read_b64_tr_b16 v[212:213], v7 offset:36032
  s_waitcnt lgkmcnt(5)
  v_mfma_f32_16x16x32_bf16 v[156:159], v[200:203], v[124:127], v[156:159]
  ds_read_b64_tr_b16 v[214:215], v7 offset:39616
  s_add_u32 s57, s27, s94
  v_mfma_f32_16x16x32_bf16 v[152:155], v[200:203], v[120:123], v[152:155]
  ds_read_b64_tr_b16 v[216:217], v7 offset:43008
  s_waitcnt lgkmcnt(5)
  v_mfma_f32_16x16x32_bf16 v[164:167], v[204:207], v[124:127], v[164:167]
  ds_read_b64_tr_b16 v[218:219], v7 offset:46592
  buffer_load_dwordx4 a[48:51], v8, s[36:39], s57 offen offset:0
  v_mfma_f32_16x16x32_bf16 v[160:163], v[204:207], v[120:123], v[160:163]
  ds_read_b64_tr_b16 v[220:221], v7 offset:43040
  s_waitcnt lgkmcnt(5)
  v_mfma_f32_16x16x32_bf16 v[172:175], v[208:211], v[124:127], v[172:175]
  ds_read_b64_tr_b16 v[222:223], v7 offset:46624
  s_waitcnt vmcnt(15)
  v_mfma_f32_16x16x32_bf16 v[168:171], v[208:211], v[120:123], v[168:171]
  ds_read_b64_tr_b16 v[200:201], v7 offset:43072
  s_waitcnt lgkmcnt(5)
  v_mfma_f32_16x16x32_bf16 v[196:199], v[212:215], v[124:127], v[196:199]
  ds_read_b64_tr_b16 v[202:203], v7 offset:46656
  ds_read_b64_tr_b16 v[204:205], v7 offset:43104
  v_mfma_f32_16x16x32_bf16 v[192:195], v[212:215], v[120:123], v[192:195]
  ds_read_b64_tr_b16 v[206:207], v7 offset:46688
  s_waitcnt lgkmcnt(6)
  v_swap_b32 v130, v132
  v_swap_b32 v131, v133
  s_nop 1
  v_mfma_f32_16x16x32_bf16 v[148:151], v[216:219], v[132:135], v[148:151]
  buffer_load_dwordx4 a[52:55], v8, s[36:39], s57 offen offset:1024
  buffer_load_dwordx4 a[56:59], v8, s[36:39], s57 offen offset:2048
  v_mfma_f32_16x16x32_bf16 v[144:147], v[216:219], v[128:131], v[144:147]
  ds_read_b64_tr_b16 v[208:209], v7 offset:43200
  s_waitcnt lgkmcnt(5)
  v_mfma_f32_16x16x32_bf16 v[156:159], v[220:223], v[132:135], v[156:159]
  ds_read_b64_tr_b16 v[210:211], v7 offset:46784
  ds_read_b64_tr_b16 v[212:213], v7 offset:50176
  v_mfma_f32_16x16x32_bf16 v[152:155], v[220:223], v[128:131], v[152:155]
  ds_read_b64_tr_b16 v[214:215], v7 offset:53760
  s_waitcnt lgkmcnt(6)
  v_mfma_f32_16x16x32_bf16 v[164:167], v[200:203], v[132:135], v[164:167]
  buffer_load_dwordx4 a[60:63], v8, s[36:39], s57 offen offset:3072
  ds_read_b64_tr_b16 v[216:217], v7 offset:50208
  v_mfma_f32_16x16x32_bf16 v[160:163], v[200:203], v[128:131], v[160:163]
  ds_read_b64_tr_b16 v[218:219], v7 offset:53792
  s_waitcnt lgkmcnt(6)
  v_mfma_f32_16x16x32_bf16 v[172:175], v[204:207], v[132:135], v[172:175]
  s_waitcnt vmcnt(16)
  ds_read_b64_tr_b16 v[220:221], v7 offset:50240
  v_mfma_f32_16x16x32_bf16 v[168:171], v[204:207], v[128:131], v[168:171]
  ds_read_b64_tr_b16 v[222:223], v7 offset:53824
  s_waitcnt lgkmcnt(6)
  v_mfma_f32_16x16x32_bf16 v[196:199], v[208:211], v[132:135], v[196:199]
  v_swap_b32 v138, v140
  v_mfma_f32_16x16x32_bf16 v[192:195], v[208:211], v[128:131], v[192:195]
  ds_read_b64_tr_b16 v[200:201], v7 offset:50272
  s_waitcnt lgkmcnt(5)
  v_swap_b32 v139, v141
  s_nop 1
  v_mfma_f32_16x16x32_bf16 v[148:151], v[212:215], v[140:143], v[148:151]
  ds_read_b64_tr_b16 v[202:203], v7 offset:53856
  s_add_u32 s57, s24, s95
  v_mfma_f32_16x16x32_bf16 v[144:147], v[212:215], v[136:139], v[144:147]
  ds_read_b64_tr_b16 v[204:205], v7 offset:50368
  s_waitcnt lgkmcnt(5)
  v_mfma_f32_16x16x32_bf16 v[156:159], v[216:219], v[140:143], v[156:159]
  ds_read_b64_tr_b16 v[206:207], v7 offset:53952
  buffer_load_dwordx4 a[64:67], v8, s[36:39], s57 offen offset:0
  v_mfma_f32_16x16x32_bf16 v[152:155], v[216:219], v[136:139], v[152:155]
  ds_read_b64_tr_b16 v[208:209], v6 offset:128
  s_waitcnt lgkmcnt(5)
  v_mfma_f32_16x16x32_bf16 v[164:167], v[220:223], v[140:143], v[164:167]
  ds_read_b64_tr_b16 v[210:211], v6 offset:3712
  buffer_load_dwordx4 a[68:71], v8, s[36:39], s57 offen offset:1024
  v_mfma_f32_16x16x32_bf16 v[160:163], v[220:223], v[136:139], v[160:163]
  ds_read_b64_tr_b16 v[212:213], v6 offset:160
  s_waitcnt lgkmcnt(5)
  v_mfma_f32_16x16x32_bf16 v[172:175], v[200:203], v[140:143], v[172:175]
  ds_read_b64_tr_b16 v[214:215], v6 offset:3744
  ds_read_b64_tr_b16 v[216:217], v6 offset:7296
  v_mfma_f32_16x16x32_bf16 v[168:171], v[200:203], v[136:139], v[168:171]
  ds_read_b64_tr_b16 v[218:219], v6 offset:10880
  s_waitcnt lgkmcnt(6)
  v_mfma_f32_16x16x32_bf16 v[196:199], v[204:207], v[140:143], v[196:199]
  ds_read_b64_tr_b16 v[220:221], v6 offset:7328
  ds_read_b64_tr_b16 v[222:223], v6 offset:10912
  v_mfma_f32_16x16x32_bf16 v[192:195], v[204:207], v[136:139], v[192:195]
  ds_read_b64_tr_b16 v[200:201], v6 offset:14464
  v_pk_mul_f32 v[224:225], v[144:145], v[144:145]
  v_pk_mul_f32 v[226:227], v[146:147], v[146:147]
  v_pk_mul_f32 v[228:229], v[152:153], v[152:153]
  v_pk_mul_f32 v[230:231], v[154:155], v[154:155]
  v_pk_fma_f32 v[224:225], v[224:225], v[240:241], v[240:241] op_sel:[0,1,0] op_sel_hi:[1,1,0]
  v_pk_fma_f32 v[226:227], v[226:227], v[240:241], v[240:241] op_sel:[0,1,0] op_sel_hi:[1,1,0]
  v_pk_fma_f32 v[228:229], v[228:229], v[240:241], v[240:241] op_sel:[0,1,0] op_sel_hi:[1,1,0]
  v_pk_fma_f32 v[230:231], v[230:231], v[240:241], v[240:241] op_sel:[0,1,0] op_sel_hi:[1,1,0]
  v_pk_mul_f32 v[224:225], v[224:225], v[144:145]
  v_pk_mul_f32 v[226:227], v[226:227], v[146:147]
  buffer_load_dwordx4 a[72:75], v8, s[36:39], s57 offen offset:2048
  buffer_load_dwordx4 a[76:79], v8, s[36:39], s57 offen offset:3072
  v_pk_mul_f32 v[228:229], v[228:229], v[152:153]
  v_pk_mul_f32 v[230:231], v[230:231], v[154:155]
  v_exp_f32 v224, v224
  v_exp_f32 v225, v225
  v_exp_f32 v226, v226
  v_exp_f32 v227, v227
  v_exp_f32 v228, v228
  v_exp_f32 v229, v229
  v_exp_f32 v230, v230
  v_exp_f32 v231, v231
  v_pk_add_f32 v[224:225], v[224:225], v[242:243] op_sel:[0,0] op_sel_hi:[1,0]
  v_pk_add_f32 v[226:227], v[226:227], v[242:243] op_sel:[0,0] op_sel_hi:[1,0]
  v_pk_add_f32 v[228:229], v[228:229], v[242:243] op_sel:[0,0] op_sel_hi:[1,0]
  v_pk_add_f32 v[230:231], v[230:231], v[242:243] op_sel:[0,0] op_sel_hi:[1,0]
  v_rcp_f32 v224, v224
  v_rcp_f32 v225, v225
  v_rcp_f32 v226, v226
  v_rcp_f32 v227, v227
  v_rcp_f32 v228, v228
  v_rcp_f32 v229, v229
  v_rcp_f32 v230, v230
  v_rcp_f32 v231, v231
  v_pk_mul_f32 v[224:225], v[224:225], v[144:145]
  v_pk_mul_f32 v[226:227], v[226:227], v[146:147]
  v_pk_mul_f32 v[228:229], v[228:229], v[152:153]
  v_pk_mul_f32 v[230:231], v[230:231], v[154:155]
  v_cvt_pk_bf16_f32 v144, v224, v225
  v_cvt_pk_bf16_f32 v145, v226, v227
  v_cvt_pk_bf16_f32 v146, v228, v229
  v_cvt_pk_bf16_f32 v147, v230, v231
  buffer_store_dwordx4 v[144:147], v14, s[20:23], s64 offen offset:0 sc1
  v_pk_mul_f32 v[224:225], v[148:149], v[148:149]
  v_pk_mul_f32 v[226:227], v[150:151], v[150:151]
  v_pk_mul_f32 v[228:229], v[156:157], v[156:157]
  v_pk_mul_f32 v[230:231], v[158:159], v[158:159]
  s_add_u32 s57, s25, s95
  buffer_load_dwordx4 a[80:83], v8, s[36:39], s57 offen offset:0
  buffer_load_dwordx4 a[84:87], v8, s[36:39], s57 offen offset:1024
  v_pk_fma_f32 v[224:225], v[224:225], v[240:241], v[240:241] op_sel:[0,1,0] op_sel_hi:[1,1,0]
  v_pk_fma_f32 v[226:227], v[226:227], v[240:241], v[240:241] op_sel:[0,1,0] op_sel_hi:[1,1,0]
  v_pk_fma_f32 v[228:229], v[228:229], v[240:241], v[240:241] op_sel:[0,1,0] op_sel_hi:[1,1,0]
  v_pk_fma_f32 v[230:231], v[230:231], v[240:241], v[240:241] op_sel:[0,1,0] op_sel_hi:[1,1,0]
  v_pk_mul_f32 v[224:225], v[224:225], v[148:149]
  v_pk_mul_f32 v[226:227], v[226:227], v[150:151]
  v_pk_mul_f32 v[228:229], v[228:229], v[156:157]
  v_pk_mul_f32 v[230:231], v[230:231], v[158:159]
  v_exp_f32 v224, v224
  v_exp_f32 v225, v225
  v_exp_f32 v226, v226
  v_exp_f32 v227, v227
  v_exp_f32 v228, v228
  v_exp_f32 v229, v229
  v_exp_f32 v230, v230
  v_exp_f32 v231, v231
  v_pk_add_f32 v[224:225], v[224:225], v[242:243] op_sel:[0,0] op_sel_hi:[1,0]
  v_pk_add_f32 v[226:227], v[226:227], v[242:243] op_sel:[0,0] op_sel_hi:[1,0]
  v_pk_add_f32 v[228:229], v[228:229], v[242:243] op_sel:[0,0] op_sel_hi:[1,0]
  v_pk_add_f32 v[230:231], v[230:231], v[242:243] op_sel:[0,0] op_sel_hi:[1,0]
  v_rcp_f32 v224, v224
  v_rcp_f32 v225, v225
  v_rcp_f32 v226, v226
  v_rcp_f32 v227, v227
  v_rcp_f32 v228, v228
  v_rcp_f32 v229, v229
  v_rcp_f32 v230, v230
  v_rcp_f32 v231, v231
  v_pk_mul_f32 v[224:225], v[224:225], v[148:149]
  v_pk_mul_f32 v[226:227], v[226:227], v[150:151]
  v_pk_mul_f32 v[228:229], v[228:229], v[156:157]
  v_pk_mul_f32 v[230:231], v[230:231], v[158:159]
  v_cvt_pk_bf16_f32 v148, v224, v225
  v_cvt_pk_bf16_f32 v149, v226, v227
  v_cvt_pk_bf16_f32 v150, v228, v229
  v_cvt_pk_bf16_f32 v151, v230, v231
  buffer_store_dwordx4 v[148:151], v14, s[20:23], s64 offen offset:1024 sc1
  v_pk_mul_f32 v[224:225], v[160:161], v[160:161]
  v_pk_mul_f32 v[226:227], v[162:163], v[162:163]
  v_pk_mul_f32 v[228:229], v[168:169], v[168:169]
  v_pk_mul_f32 v[230:231], v[170:171], v[170:171]
  v_pk_fma_f32 v[224:225], v[224:225], v[240:241], v[240:241] op_sel:[0,1,0] op_sel_hi:[1,1,0]
  v_pk_fma_f32 v[226:227], v[226:227], v[240:241], v[240:241] op_sel:[0,1,0] op_sel_hi:[1,1,0]
  v_pk_fma_f32 v[228:229], v[228:229], v[240:241], v[240:241] op_sel:[0,1,0] op_sel_hi:[1,1,0]
  v_pk_fma_f32 v[230:231], v[230:231], v[240:241], v[240:241] op_sel:[0,1,0] op_sel_hi:[1,1,0]
  v_pk_mul_f32 v[224:225], v[224:225], v[160:161]
  v_pk_mul_f32 v[226:227], v[226:227], v[162:163]
  buffer_load_dwordx4 a[88:91], v8, s[36:39], s57 offen offset:2048
  buffer_load_dwordx4 a[92:95], v8, s[36:39], s57 offen offset:3072
  v_pk_mul_f32 v[228:229], v[228:229], v[168:169]
  v_pk_mul_f32 v[230:231], v[230:231], v[170:171]
  v_exp_f32 v224, v224
  v_exp_f32 v225, v225
  v_exp_f32 v226, v226
  v_exp_f32 v227, v227
  v_exp_f32 v228, v228
  v_exp_f32 v229, v229
  v_exp_f32 v230, v230
  v_exp_f32 v231, v231
  v_pk_add_f32 v[224:225], v[224:225], v[242:243] op_sel:[0,0] op_sel_hi:[1,0]
  v_pk_add_f32 v[226:227], v[226:227], v[242:243] op_sel:[0,0] op_sel_hi:[1,0]
  v_pk_add_f32 v[228:229], v[228:229], v[242:243] op_sel:[0,0] op_sel_hi:[1,0]
  v_pk_add_f32 v[230:231], v[230:231], v[242:243] op_sel:[0,0] op_sel_hi:[1,0]
  v_rcp_f32 v224, v224
  s_waitcnt lgkmcnt(3)
  s_waitcnt vmcnt(25)
  ds_write_b128 v250, a[0:3] offset:0
  s_waitcnt vmcnt(24)
  ds_write_b128 v250, a[4:7] offset:128
  s_waitcnt vmcnt(23)
  ds_write_b128 v251, a[8:11] offset:256
  s_waitcnt vmcnt(22)
  ds_write_b128 v251, a[12:15] offset:384
  ds_read_b64_tr_b16 a[0:1], v252 offset:0
  ds_read_b64_tr_b16 a[2:3], v252 offset:2048
  ds_read_b64_tr_b16 a[4:5], v253 offset:0
  ds_read_b64_tr_b16 a[6:7], v253 offset:2048
  ds_read_b64_tr_b16 a[8:9], v254 offset:0
  ds_read_b64_tr_b16 a[10:11], v254 offset:2048
  ds_read_b64_tr_b16 a[12:13], v255 offset:0
  ds_read_b64_tr_b16 a[14:15], v255 offset:2048
  v_rcp_f32 v225, v225
  v_rcp_f32 v226, v226
  v_rcp_f32 v227, v227
  v_rcp_f32 v228, v228
  v_rcp_f32 v229, v229
  v_rcp_f32 v230, v230
  v_rcp_f32 v231, v231
  v_pk_mul_f32 v[224:225], v[224:225], v[160:161]
  v_pk_mul_f32 v[226:227], v[226:227], v[162:163]
  v_pk_mul_f32 v[228:229], v[228:229], v[168:169]
  v_pk_mul_f32 v[230:231], v[230:231], v[170:171]
  v_cvt_pk_bf16_f32 v160, v224, v225
  v_cvt_pk_bf16_f32 v161, v226, v227
  v_cvt_pk_bf16_f32 v162, v228, v229
  v_cvt_pk_bf16_f32 v163, v230, v231
  buffer_store_dwordx4 v[160:163], v0, s[20:23], s64 offen offset:0 sc1
  v_pk_mul_f32 v[224:225], v[164:165], v[164:165]
  v_pk_mul_f32 v[226:227], v[166:167], v[166:167]
  v_pk_mul_f32 v[228:229], v[172:173], v[172:173]
  v_pk_mul_f32 v[230:231], v[174:175], v[174:175]
  s_add_u32 s57, s26, s95
  buffer_load_dwordx4 a[96:99], v8, s[36:39], s57 offen offset:0
  buffer_load_dwordx4 a[100:103], v8, s[36:39], s57 offen offset:1024
  v_pk_fma_f32 v[224:225], v[224:225], v[240:241], v[240:241] op_sel:[0,1,0] op_sel_hi:[1,1,0]
  v_pk_fma_f32 v[226:227], v[226:227], v[240:241], v[240:241] op_sel:[0,1,0] op_sel_hi:[1,1,0]
  v_pk_fma_f32 v[228:229], v[228:229], v[240:241], v[240:241] op_sel:[0,1,0] op_sel_hi:[1,1,0]
  v_pk_fma_f32 v[230:231], v[230:231], v[240:241], v[240:241] op_sel:[0,1,0] op_sel_hi:[1,1,0]
  v_pk_mul_f32 v[224:225], v[224:225], v[164:165]
  v_pk_mul_f32 v[226:227], v[226:227], v[166:167]
  v_pk_mul_f32 v[228:229], v[228:229], v[172:173]
  v_pk_mul_f32 v[230:231], v[230:231], v[174:175]
  v_exp_f32 v224, v224
  v_exp_f32 v225, v225
  v_exp_f32 v226, v226
  v_exp_f32 v227, v227
  v_exp_f32 v228, v228
  v_exp_f32 v229, v229
  v_exp_f32 v230, v230
  v_exp_f32 v231, v231
  v_pk_add_f32 v[224:225], v[224:225], v[242:243] op_sel:[0,0] op_sel_hi:[1,0]
  v_pk_add_f32 v[226:227], v[226:227], v[242:243] op_sel:[0,0] op_sel_hi:[1,0]
  v_pk_add_f32 v[228:229], v[228:229], v[242:243] op_sel:[0,0] op_sel_hi:[1,0]
  v_pk_add_f32 v[230:231], v[230:231], v[242:243] op_sel:[0,0] op_sel_hi:[1,0]
  v_rcp_f32 v224, v224
  v_rcp_f32 v225, v225
  v_rcp_f32 v226, v226
  v_rcp_f32 v227, v227
  v_rcp_f32 v228, v228
  v_rcp_f32 v229, v229
  v_rcp_f32 v230, v230
  v_rcp_f32 v231, v231
  v_pk_mul_f32 v[224:225], v[224:225], v[164:165]
  v_pk_mul_f32 v[226:227], v[226:227], v[166:167]
  v_pk_mul_f32 v[228:229], v[228:229], v[172:173]
  v_pk_mul_f32 v[230:231], v[230:231], v[174:175]
  v_cvt_pk_bf16_f32 v164, v224, v225
  v_cvt_pk_bf16_f32 v165, v226, v227
  v_cvt_pk_bf16_f32 v166, v228, v229
  v_cvt_pk_bf16_f32 v167, v230, v231
  buffer_store_dwordx4 v[164:167], v0, s[20:23], s64 offen offset:1024 sc1
  v_pk_mul_f32 v[224:225], v[192:193], v[192:193]
  v_pk_mul_f32 v[226:227], v[194:195], v[194:195]
  v_pk_mul_f32 v[228:229], v[196:197], v[196:197]
  v_pk_mul_f32 v[230:231], v[198:199], v[198:199]
  v_pk_fma_f32 v[224:225], v[224:225], v[240:241], v[240:241] op_sel:[0,1,0] op_sel_hi:[1,1,0]
  v_pk_fma_f32 v[226:227], v[226:227], v[240:241], v[240:241] op_sel:[0,1,0] op_sel_hi:[1,1,0]
  v_pk_fma_f32 v[228:229], v[228:229], v[240:241], v[240:241] op_sel:[0,1,0] op_sel_hi:[1,1,0]
  v_pk_fma_f32 v[230:231], v[230:231], v[240:241], v[240:241] op_sel:[0,1,0] op_sel_hi:[1,1,0]
  v_pk_mul_f32 v[224:225], v[224:225], v[192:193]
  v_pk_mul_f32 v[226:227], v[226:227], v[194:195]
  v_pk_mul_f32 v[228:229], v[228:229], v[196:197]
  v_pk_mul_f32 v[230:231], v[230:231], v[198:199]
  v_exp_f32 v224, v224
  v_exp_f32 v225, v225
  v_exp_f32 v226, v226
  v_exp_f32 v227, v227
  v_exp_f32 v228, v228
  v_exp_f32 v229, v229
  v_exp_f32 v230, v230
  v_exp_f32 v231, v231
  v_pk_add_f32 v[224:225], v[224:225], v[242:243] op_sel:[0,0] op_sel_hi:[1,0]
  v_pk_add_f32 v[226:227], v[226:227], v[242:243] op_sel:[0,0] op_sel_hi:[1,0]
  v_pk_add_f32 v[228:229], v[228:229], v[242:243] op_sel:[0,0] op_sel_hi:[1,0]
  v_pk_add_f32 v[230:231], v[230:231], v[242:243] op_sel:[0,0] op_sel_hi:[1,0]
  v_rcp_f32 v224, v224
  v_rcp_f32 v225, v225
  v_rcp_f32 v226, v226
  v_rcp_f32 v227, v227
  v_rcp_f32 v228, v228
  v_rcp_f32 v229, v229
  s_waitcnt vmcnt(6)
  v_mov_b32 v5, 1
  s_mov_b64 exec, 1
  buffer_store_dword v5, v4, s[20:23], s65 offen sc1
  s_mov_b64 exec, -1
  v_rcp_f32 v230, v230
  v_rcp_f32 v231, v231
  v_pk_mul_f32 v[224:225], v[224:225], v[192:193]
  v_pk_mul_f32 v[226:227], v[226:227], v[194:195]
  v_pk_mul_f32 v[228:229], v[228:229], v[196:197]
  v_pk_mul_f32 v[230:231], v[230:231], v[198:199]
  v_cvt_pk_bf16_f32 v192, v224, v225
  v_cvt_pk_bf16_f32 v193, v226, v227
  v_cvt_pk_bf16_f32 v194, v228, v229
  v_cvt_pk_bf16_f32 v195, v230, v231
  buffer_store_dwordx4 v[192:195], v244, s[20:23], s64 offen offset:0 sc1
  v_mfma_f32_16x16x32_bf16 v[180:183], v[208:211], v[20:23], v[176:179]
  buffer_load_dwordx4 a[104:107], v8, s[36:39], s57 offen offset:2048
  ds_read_b64_tr_b16 v[202:203], v6 offset:18048
  v_mfma_f32_16x16x32_bf16 v[176:179], v[208:211], v[16:19], v[176:179]
  ds_read_b64_tr_b16 v[204:205], v6 offset:14496
  ds_read_b64_tr_b16 v[206:207], v6 offset:18080
  v_mfma_f32_16x16x32_bf16 v[188:191], v[212:215], v[20:23], v[184:187]
  ds_read_b64_tr_b16 v[208:209], v6 offset:21632
  ds_read_b64_tr_b16 v[210:211], v6 offset:25216
  v_mfma_f32_16x16x32_bf16 v[184:187], v[212:215], v[16:19], v[184:187]
  ds_read_b64_tr_b16 v[212:213], v6 offset:21664
  ds_read_b64_tr_b16 v[214:215], v6 offset:25248
  v_mfma_f32_16x16x32_bf16 v[180:183], v[216:219], v[28:31], v[180:183]
  buffer_load_dwordx4 a[108:111], v8, s[36:39], s57 offen offset:3072
  v_mfma_f32_16x16x32_bf16 v[176:179], v[216:219], v[24:27], v[176:179]
  ds_read_b64_tr_b16 v[216:217], v6 offset:28800
  s_waitcnt lgkmcnt(7)
  v_mfma_f32_16x16x32_bf16 v[188:191], v[220:223], v[28:31], v[188:191]
  ds_read_b64_tr_b16 v[218:219], v6 offset:32384
  v_mfma_f32_16x16x32_bf16 v[184:187], v[220:223], v[24:27], v[184:187]
  ds_read_b64_tr_b16 v[220:221], v6 offset:28832
  ds_read_b64_tr_b16 v[222:223], v6 offset:32416
  v_mfma_f32_16x16x32_bf16 v[180:183], v[200:203], v[36:39], v[180:183]
  s_add_u32 s57, s27, s95
  buffer_load_dwordx4 a[112:115], v8, s[36:39], s57 offen offset:0
  v_mfma_f32_16x16x32_bf16 v[176:179], v[200:203], v[32:35], v[176:179]
  ds_read_b64_tr_b16 v[200:201], v6 offset:35968
  s_waitcnt lgkmcnt(5)
  v_mfma_f32_16x16x32_bf16 v[188:191], v[204:207], v[36:39], v[188:191]
  ds_write_b128 v250, a[16:19] offset:17408
  v_mfma_f32_16x16x32_bf16 v[184:187], v[204:207], v[32:35], v[184:187]
  ds_write_b128 v250, a[20:23] offset:17536
  v_mfma_f32_16x16x32_bf16 v[180:183], v[208:211], v[44:47], v[180:183]
  ds_write_b128 v251, a[24:27] offset:17664
  v_mfma_f32_16x16x32_bf16 v[176:179], v[208:211], v[40:43], v[176:179]
  ds_read_b64_tr_b16 v[202:203], v6 offset:39552
  ds_write_b128 v251, a[28:31] offset:17792
  v_mfma_f32_16x16x32_bf16 v[188:191], v[212:215], v[44:47], v[188:191]
  ds_read_b64_tr_b16 a[16:17], v252 offset:17408
  ds_read_b64_tr_b16 a[18:19], v252 offset:19456
  v_mfma_f32_16x16x32_bf16 v[184:187], v[212:215], v[40:43], v[184:187]
  ds_read_b64_tr_b16 v[204:205], v6 offset:36000
  s_waitcnt lgkmcnt(9)
  v_mfma_f32_16x16x32_bf16 v[180:183], v[216:219], v[52:55], v[180:183]
  ds_read_b64_tr_b16 v[206:207], v6 offset:39584
  ds_read_b64_tr_b16 a[20:21], v253 offset:17408
  v_mfma_f32_16x16x32_bf16 v[176:179], v[216:219], v[48:51], v[176:179]
  ds_read_b64_tr_b16 v[208:209], v6 offset:43136
  ds_read_b64_tr_b16 v[210:211], v6 offset:46720
  v_mfma_f32_16x16x32_bf16 v[188:191], v[220:223], v[52:55], v[188:191]
  ds_read_b64_tr_b16 a[22:23], v253 offset:19456
  ds_read_b64_tr_b16 a[24:25], v254 offset:17408
  v_mfma_f32_16x16x32_bf16 v[184:187], v[220:223], v[48:51], v[184:187]
  ds_read_b64_tr_b16 v[212:213], v6 offset:43168
  s_waitcnt lgkmcnt(11)
  v_mfma_f32_16x16x32_bf16 v[180:183], v[200:203], v[60:63], v[180:183]
  ds_read_b64_tr_b16 v[214:215], v6 offset:46752
  ds_read_b64_tr_b16 a[26:27], v254 offset:19456
  v_mfma_f32_16x16x32_bf16 v[176:179], v[200:203], v[56:59], v[176:179]
  ds_read_b64_tr_b16 v[216:217], v6 offset:50304
  s_waitcnt lgkmcnt(9)
  v_mfma_f32_16x16x32_bf16 v[188:191], v[204:207], v[60:63], v[188:191]
  ds_read_b64_tr_b16 v[218:219], v6 offset:53888
  ds_read_b64_tr_b16 a[28:29], v255 offset:17408
  v_mfma_f32_16x16x32_bf16 v[184:187], v[204:207], v[56:59], v[184:187]
  ds_read_b64_tr_b16 v[220:221], v6 offset:50336
  s_waitcnt lgkmcnt(9)
  v_mfma_f32_16x16x32_bf16 v[180:183], v[208:211], v[68:71], v[180:183]
  ds_read_b64_tr_b16 v[222:223], v6 offset:53920
  ds_read_b64_tr_b16 a[30:31], v255 offset:19456
  v_mfma_f32_16x16x32_bf16 v[176:179], v[208:211], v[64:67], v[176:179]
  ds_read_b64_tr_b16 v[200:201], v7 offset:128
  s_waitcnt lgkmcnt(8)
  v_mfma_f32_16x16x32_bf16 v[188:191], v[212:215], v[68:71], v[188:191]
  ds_read_b64_tr_b16 v[202:203], v7 offset:3712
  buffer_load_dwordx4 a[116:119], v8, s[36:39], s57 offen offset:1024
  v_mfma_f32_16x16x32_bf16 v[184:187], v[212:215], v[64:67], v[184:187]
  ds_read_b64_tr_b16 v[204:205], v7 offset:160
  s_waitcnt lgkmcnt(7)
  v_mfma_f32_16x16x32_bf16 v[180:183], v[216:219], v[76:79], v[180:183]
  ds_read_b64_tr_b16 v[206:207], v7 offset:3744
  buffer_load_dwordx4 a[120:123], v8, s[36:39], s57 offen offset:2048
  v_mfma_f32_16x16x32_bf16 v[176:179], v[216:219], v[72:75], v[176:179]
  ds_read_b64_tr_b16 v[208:209], v7 offset:7296
  s_waitcnt lgkmcnt(6)
  s_waitcnt vmcnt(5)
  v_mov_b32 v5, 3
  s_mov_b64 exec, 1
  buffer_store_dword v5, v4, s[20:23], s65 offen sc1
  s_mov_b64 exec, -1
  v_mfma_f32_16x16x32_bf16 v[188:191], v[220:223], v[76:79], v[188:191]
  ds_read_b64_tr_b16 v[210:211], v7 offset:10880
  buffer_load_dwordx4 a[124:127], v8, s[36:39], s57 offen offset:3072
  v_mfma_f32_16x16x32_bf16 v[184:187], v[220:223], v[72:75], v[184:187]
  ds_read_b64_tr_b16 v[212:213], v7 offset:7328
  s_waitcnt lgkmcnt(5)
  v_mfma_f32_16x16x32_bf16 v[180:183], v[200:203], v[84:87], v[180:183]
  ds_read_b64_tr_b16 v[214:215], v7 offset:10912
  s_min_u32 s57, s24, s25
  v_mfma_f32_16x16x32_bf16 v[176:179], v[200:203], v[80:83], v[176:179]
  ds_read_b64_tr_b16 v[216:217], v7 offset:14464
  s_waitcnt lgkmcnt(5)
  v_mfma_f32_16x16x32_bf16 v[188:191], v[204:207], v[84:87], v[188:191]
  ds_read_b64_tr_b16 v[218:219], v7 offset:18048
  buffer_load_dwordx4 a[192:195], v9, s[36:39], s57 offen offset:0
  v_mfma_f32_16x16x32_bf16 v[184:187], v[204:207], v[80:83], v[184:187]
  ds_read_b64_tr_b16 v[220:221], v7 offset:14496
  s_waitcnt lgkmcnt(5)
  v_mfma_f32_16x16x32_bf16 v[180:183], v[208:211], v[92:95], v[180:183]
  ds_read_b64_tr_b16 v[222:223], v7 offset:18080
  buffer_load_dwordx4 a[196:199], v9, s[36:39], s57 offen offset:1024
  v_mfma_f32_16x16x32_bf16 v[176:179], v[208:211], v[88:91], v[176:179]
  ds_read_b64_tr_b16 v[200:201], v7 offset:21632
  s_waitcnt lgkmcnt(5)
  v_mfma_f32_16x16x32_bf16 v[188:191], v[212:215], v[92:95], v[188:191]
  ds_read_b64_tr_b16 v[202:203], v7 offset:25216
  buffer_load_dwordx4 a[200:203], v9, s[36:39], s57 offen offset:2048
  v_mfma_f32_16x16x32_bf16 v[184:187], v[212:215], v[88:91], v[184:187]
  ds_read_b64_tr_b16 v[204:205], v7 offset:21664
  s_waitcnt lgkmcnt(5)
  buffer_load_dword v13, v15, s[20:23], s17 offen sc1
  v_mfma_f32_16x16x32_bf16 v[180:183], v[216:219], v[100:103], v[180:183]
  ds_read_b64_tr_b16 v[206:207], v7 offset:25248
  ds_write_b128 v250, a[32:35] offset:0
  v_mfma_f32_16x16x32_bf16 v[176:179], v[216:219], v[96:99], v[176:179]
  ds_read_b64_tr_b16 v[208:209], v7 offset:28800
  s_waitcnt lgkmcnt(6)
  v_mfma_f32_16x16x32_bf16 v[188:191], v[220:223], v[100:103], v[188:191]
  ds_read_b64_tr_b16 v[210:211], v7 offset:32384
  ds_write_b128 v250, a[36:39] offset:128
  v_mfma_f32_16x16x32_bf16 v[184:187], v[220:223], v[96:99], v[184:187]
  ds_read_b64_tr_b16 v[212:213], v7 offset:28832
  s_waitcnt lgkmcnt(7)
  v_mfma_f32_16x16x32_bf16 v[180:183], v[200:203], v[108:111], v[180:183]
  ds_read_b64_tr_b16 v[214:215], v7 offset:32416
  ds_write_b128 v251, a[40:43] offset:256
  v_mfma_f32_16x16x32_bf16 v[176:179], v[200:203], v[104:107], v[176:179]
  ds_read_b64_tr_b16 v[216:217], v7 offset:35968
  s_waitcnt lgkmcnt(8)
  v_mfma_f32_16x16x32_bf16 v[188:191], v[204:207], v[108:111], v[188:191]
  ds_read_b64_tr_b16 v[218:219], v7 offset:39552
  ds_write_b128 v251, a[44:47] offset:384
  v_mfma_f32_16x16x32_bf16 v[184:187], v[204:207], v[104:107], v[184:187]
  ds_read_b64_tr_b16 v[220:221], v7 offset:36000
  s_waitcnt lgkmcnt(8)
  v_mfma_f32_16x16x32_bf16 v[180:183], v[208:211], v[116:119], v[180:183]
  ds_read_b64_tr_b16 v[222:223], v7 offset:39584
  ds_read_b64_tr_b16 a[32:33], v252 offset:0
  v_mfma_f32_16x16x32_bf16 v[176:179], v[208:211], v[112:115], v[176:179]
  ds_read_b64_tr_b16 v[200:201], v7 offset:43136
  s_waitcnt lgkmcnt(8)
  buffer_load_dword v248, v247, s[20:23], s66 offen sc1
  v_mfma_f32_16x16x32_bf16 v[188:191], v[212:215], v[116:119], v[188:191]
  ds_read_b64_tr_b16 v[202:203], v7 offset:46720
  ds_read_b64_tr_b16 a[34:35], v252 offset:2048
  v_mfma_f32_16x16x32_bf16 v[184:187], v[212:215], v[112:115], v[184:187]
  ds_read_b64_tr_b16 v[204:205], v7 offset:43168
  s_waitcnt lgkmcnt(8)
  v_mfma_f32_16x16x32_bf16 v[180:183], v[216:219], v[124:127], v[180:183]
  ds_read_b64_tr_b16 v[206:207], v7 offset:46752
  ds_read_b64_tr_b16 a[36:37], v253 offset:0
  v_mfma_f32_16x16x32_bf16 v[176:179], v[216:219], v[120:123], v[176:179]
  ds_read_b64_tr_b16 v[208:209], v7 offset:50304
  s_waitcnt lgkmcnt(8)
  v_mfma_f32_16x16x32_bf16 v[188:191], v[220:223], v[124:127], v[188:191]
  ds_read_b64_tr_b16 v[210:211], v7 offset:53888
  ds_read_b64_tr_b16 a[38:39], v253 offset:2048
  v_mfma_f32_16x16x32_bf16 v[184:187], v[220:223], v[120:123], v[184:187]
  ds_read_b64_tr_b16 v[212:213], v7 offset:50336
  s_waitcnt lgkmcnt(8)
  v_mfma_f32_16x16x32_bf16 v[180:183], v[200:203], v[132:135], v[180:183]
  ds_read_b64_tr_b16 v[214:215], v7 offset:53920
  ds_read_b64_tr_b16 a[40:41], v254 offset:0
  v_mfma_f32_16x16x32_bf16 v[176:179], v[200:203], v[128:131], v[176:179]
  ds_read_b64_tr_b16 a[42:43], v254 offset:2048
  s_waitcnt lgkmcnt(8)
  v_mfma_f32_16x16x32_bf16 v[188:191], v[204:207], v[132:135], v[188:191]
  ds_read_b64_tr_b16 a[44:45], v255 offset:0
  ds_read_b64_tr_b16 a[46:47], v255 offset:2048
  v_mfma_f32_16x16x32_bf16 v[184:187], v[204:207], v[128:131], v[184:187]
  buffer_load_dwordx4 a[204:207], v9, s[36:39], s57 offen offset:3072
  s_waitcnt lgkmcnt(7)
  v_mfma_f32_16x16x32_bf16 v[180:183], v[208:211], v[140:143], v[180:183]
  s_min_u32 s57, s26, s27
  buffer_load_dwordx4 a[208:211], v9, s[36:39], s57 offen offset:0
  v_mfma_f32_16x16x32_bf16 v[176:179], v[208:211], v[136:139], v[176:179]
  buffer_load_dwordx4 a[212:215], v9, s[36:39], s57 offen offset:1024
  s_waitcnt lgkmcnt(4)
  v_mfma_f32_16x16x32_bf16 v[188:191], v[212:215], v[140:143], v[188:191]
  v_mfma_f32_16x16x32_bf16 v[184:187], v[212:215], v[136:139], v[184:187]
  s_waitcnt vmcnt(4)
  v_cmp_gt_u32 vcc, 1, v13
  s_nop 4
  s_cbranch_vccz s_g2p1_ok
  s_mov_b32 s69, 0
s_g2p1:
  buffer_load_dword v13, v15, s[20:23], s17 offen offset:0 sc1
  s_add_u32 s69, s69, 1
  s_waitcnt vmcnt(0)
  v_cmp_gt_u32 vcc, 1, v13
  s_cmp_ge_u32 s69, 4000
  s_cbranch_scc1 s_g2p1_out
  s_nop 3
  s_cbranch_vccnz s_g2p1
s_g2p1_out:
s_g2p1_ok:
  v_pk_mul_f32 v[224:225], v[176:177], v[176:177]
  s_waitcnt vmcnt(3)
  v_cmp_gt_u32 vcc, 1, v248
  s_nop 4
  s_cbranch_vccz s_al4_ok
  s_mov_b32 s69, 0
s_al4:
  buffer_load_dword v248, v247, s[20:23], s66 offen offset:0 sc1
  s_add_u32 s69, s69, 1
  s_waitcnt vmcnt(0)
  v_cmp_gt_u32 vcc, 1, v248
  s_cmp_ge_u32 s69, 4000
  s_cbranch_scc1 s_al4_out
  s_nop 3
  s_cbranch_vccnz s_al4
s_al4_out:
s_al4_ok:
  buffer_load_dwordx4 a[224:227], v14, s[20:23], s8 offen offset:0 sc1
  v_pk_mul_f32 v[226:227], v[178:179], v[178:179]
  v_pk_mul_f32 v[228:229], v[184:185], v[184:185]
  buffer_load_dwordx4 a[228:231], v14, s[20:23], s8 offen offset:1024 sc1
  v_pk_mul_f32 v[230:231], v[186:187], v[186:187]
  v_pk_fma_f32 v[224:225], v[224:225], v[240:241], v[240:241] op_sel:[0,1,0] op_sel_hi:[1,1,0]
  buffer_load_dwordx4 a[232:235], v14, s[20:23], s12 offen offset:0 sc1
  v_pk_fma_f32 v[226:227], v[226:227], v[240:241], v[240:241] op_sel:[0,1,0] op_sel_hi:[1,1,0]
  v_pk_fma_f32 v[228:229], v[228:229], v[240:241], v[240:241] op_sel:[0,1,0] op_sel_hi:[1,1,0]
  buffer_load_dwordx4 a[236:239], v14, s[20:23], s12 offen offset:1024 sc1
  v_pk_fma_f32 v[230:231], v[230:231], v[240:241], v[240:241] op_sel:[0,1,0] op_sel_hi:[1,1,0]
  v_pk_mul_f32 v[224:225], v[224:225], v[176:177]
  buffer_load_dwordx4 a[240:243], v14, s[20:23], s9 offen offset:0 sc1
  v_pk_mul_f32 v[226:227], v[226:227], v[178:179]
  v_pk_mul_f32 v[228:229], v[228:229], v[184:185]
  buffer_load_dwordx4 a[244:247], v14, s[20:23], s9 offen offset:1024 sc1
  v_pk_mul_f32 v[230:231], v[230:231], v[186:187]
  v_exp_f32 v224, v224
  buffer_load_dwordx4 a[248:251], v14, s[20:23], s13 offen offset:0 sc1
  v_exp_f32 v225, v225
  v_exp_f32 v226, v226
  buffer_load_dwordx4 a[252:255], v14, s[20:23], s13 offen offset:1024 sc1
  v_exp_f32 v227, v227
  v_exp_f32 v228, v228
  buffer_load_dwordx4 v[144:147], v14, s[20:23], s10 offen offset:0 sc1
  v_exp_f32 v229, v229
  v_exp_f32 v230, v230
  buffer_load_dwordx4 v[148:151], v14, s[20:23], s10 offen offset:1024 sc1
  v_exp_f32 v231, v231
  v_pk_add_f32 v[224:225], v[224:225], v[242:243] op_sel:[0,0] op_sel_hi:[1,0]
  buffer_load_dwordx4 v[152:155], v14, s[20:23], s14 offen offset:0 sc1
  v_pk_add_f32 v[226:227], v[226:227], v[242:243] op_sel:[0,0] op_sel_hi:[1,0]
  v_pk_add_f32 v[228:229], v[228:229], v[242:243] op_sel:[0,0] op_sel_hi:[1,0]
  buffer_load_dwordx4 v[156:159], v14, s[20:23], s14 offen offset:1024 sc1
  v_pk_add_f32 v[230:231], v[230:231], v[242:243] op_sel:[0,0] op_sel_hi:[1,0]
  v_rcp_f32 v224, v224
  buffer_load_dwordx4 v[160:163], v14, s[20:23], s11 offen offset:0 sc1
  v_rcp_f32 v225, v225
  v_rcp_f32 v226, v226
  buffer_load_dwordx4 v[164:167], v14, s[20:23], s11 offen offset:1024 sc1
  v_rcp_f32 v227, v227
  v_rcp_f32 v228, v228
  buffer_load_dwordx4 v[168:171], v14, s[20:23], s15 offen offset:0 sc1
  v_rcp_f32 v229, v229
  buffer_load_dword v13, v15, s[20:23], s17 offen sc1
  v_rcp_f32 v230, v230
  buffer_load_dwordx4 v[172:175], v14, s[20:23], s15 offen offset:1024 sc1
  v_rcp_f32 v231, v231
  v_pk_mul_f32 v[224:225], v[224:225], v[176:177]
  v_pk_mul_f32 v[226:227], v[226:227], v[178:179]
  v_pk_mul_f32 v[228:229], v[228:229], v[184:185]
  v_pk_mul_f32 v[230:231], v[230:231], v[186:187]
  v_cvt_pk_bf16_f32 v176, v224, v225
  v_cvt_pk_bf16_f32 v177, v226, v227
  v_cvt_pk_bf16_f32 v178, v228, v229
  v_cvt_pk_bf16_f32 v179, v230, v231
  buffer_store_dwordx4 v[176:179], v245, s[20:23], s64 offen offset:0 sc1
  v_pk_mul_f32 v[224:225], v[180:181], v[180:181]
  v_pk_mul_f32 v[226:227], v[182:183], v[182:183]
  v_pk_mul_f32 v[228:229], v[188:189], v[188:189]
  v_pk_mul_f32 v[230:231], v[190:191], v[190:191]
  v_pk_fma_f32 v[224:225], v[224:225], v[240:241], v[240:241] op_sel:[0,1,0] op_sel_hi:[1,1,0]
  v_pk_fma_f32 v[226:227], v[226:227], v[240:241], v[240:241] op_sel:[0,1,0] op_sel_hi:[1,1,0]
  v_pk_fma_f32 v[228:229], v[228:229], v[240:241], v[240:241] op_sel:[0,1,0] op_sel_hi:[1,1,0]
  v_pk_fma_f32 v[230:231], v[230:231], v[240:241], v[240:241] op_sel:[0,1,0] op_sel_hi:[1,1,0]
  v_pk_mul_f32 v[224:225], v[224:225], v[180:181]
  v_pk_mul_f32 v[226:227], v[226:227], v[182:183]
  v_pk_mul_f32 v[228:229], v[228:229], v[188:189]
  v_pk_mul_f32 v[230:231], v[230:231], v[190:191]
  v_exp_f32 v224, v224
  v_exp_f32 v225, v225
  v_exp_f32 v226, v226
  v_exp_f32 v227, v227
  v_exp_f32 v228, v228
  v_exp_f32 v229, v229
  v_exp_f32 v230, v230
  v_exp_f32 v231, v231
  v_pk_add_f32 v[224:225], v[224:225], v[242:243] op_sel:[0,0] op_sel_hi:[1,0]
  v_pk_add_f32 v[226:227], v[226:227], v[242:243] op_sel:[0,0] op_sel_hi:[1,0]
  v_pk_add_f32 v[228:229], v[228:229], v[242:243] op_sel:[0,0] op_sel_hi:[1,0]
  v_pk_add_f32 v[230:231], v[230:231], v[242:243] op_sel:[0,0] op_sel_hi:[1,0]
  v_rcp_f32 v224, v224
  v_rcp_f32 v225, v225
  v_rcp_f32 v226, v226
  v_rcp_f32 v227, v227
  v_rcp_f32 v228, v228
  v_rcp_f32 v229, v229
  v_rcp_f32 v230, v230
  v_rcp_f32 v231, v231
  v_pk_mul_f32 v[224:225], v[224:225], v[180:181]
  v_pk_mul_f32 v[226:227], v[226:227], v[182:183]
  v_pk_mul_f32 v[228:229], v[228:229], v[188:189]
  v_pk_mul_f32 v[230:231], v[230:231], v[190:191]
  v_cvt_pk_bf16_f32 v180, v224, v225
  v_cvt_pk_bf16_f32 v181, v226, v227
  v_cvt_pk_bf16_f32 v182, v228, v229
  v_cvt_pk_bf16_f32 v183, v230, v231
  buffer_store_dwordx4 v[180:183], v245, s[20:23], s64 offen offset:1024 sc1
  s_waitcnt vmcnt(18)
  v_mfma_f32_16x16x32_bf16 v[80:83], a[0:3], a[224:227], 0
  buffer_load_dwordx4 a[216:219], v9, s[36:39], s57 offen offset:2048
  s_and_b32 s18, s5, 7
  v_mfma_f32_16x16x32_bf16 v[84:87], a[4:7], a[224:227], 0
  ds_write_b128 v250, a[48:51] offset:17408
  v_mfma_f32_16x16x32_bf16 v[88:91], a[8:11], a[224:227], 0
  s_lshl_b32 s18, s18, 2
  s_add_u32 s18, s18, s3
  v_mfma_f32_16x16x32_bf16 v[92:95], a[12:15], a[224:227], 0
  ds_write_b128 v250, a[52:55] offset:17536
  s_waitcnt vmcnt(18)
  v_mfma_f32_16x16x32_bf16 v[96:99], a[0:3], a[228:231], 0
  buffer_load_dwordx4 a[220:223], v9, s[36:39], s57 offen offset:3072
  s_lshl_b32 s19, s18, 8
  v_mfma_f32_16x16x32_bf16 v[100:103], a[4:7], a[228:231], 0
  ds_write_b128 v251, a[56:59] offset:17664
  v_mfma_f32_16x16x32_bf16 v[104:107], a[8:11], a[228:231], 0
  s_add_u32 s57, s24, s96
  buffer_load_dwordx4 a[128:131], v8, s[36:39], s57 offen offset:0
  v_mfma_f32_16x16x32_bf16 v[108:111], a[12:15], a[228:231], 0
  ds_write_b128 v251, a[60:63] offset:17792
  s_waitcnt vmcnt(19)
  v_mfma_f32_16x16x32_bf16 v[112:115], a[0:3], a[232:235], 0
  ds_read_b64_tr_b16 a[48:49], v252 offset:17408
  s_lshl_b32 s60, s16, 15
  v_mfma_f32_16x16x32_bf16 v[116:119], a[4:7], a[232:235], 0
  ds_read_b64_tr_b16 a[50:51], v252 offset:19456
  buffer_load_dwordx4 a[132:135], v8, s[36:39], s57 offen offset:1024
  v_mfma_f32_16x16x32_bf16 v[120:123], a[8:11], a[232:235], 0
  ds_read_b64_tr_b16 a[52:53], v253 offset:17408
  s_add_u32 s19, s19, s60
  v_mfma_f32_16x16x32_bf16 v[124:127], a[12:15], a[232:235], 0
  ds_read_b64_tr_b16 a[54:55], v253 offset:19456
  s_waitcnt vmcnt(19)
  v_mfma_f32_16x16x32_bf16 v[128:131], a[0:3], a[236:239], 0
  ds_read_b64_tr_b16 a[56:57], v254 offset:17408
  buffer_load_dwordx4 a[136:139], v8, s[36:39], s57 offen offset:2048
  v_mfma_f32_16x16x32_bf16 v[132:135], a[4:7], a[236:239], 0
  ds_read_b64_tr_b16 a[58:59], v254 offset:19456
  s_add_u32 s19, s19, 2097152
  v_mfma_f32_16x16x32_bf16 v[136:139], a[8:11], a[236:239], 0
  ds_read_b64_tr_b16 a[60:61], v255 offset:17408
  buffer_load_dwordx4 a[140:143], v8, s[36:39], s57 offen offset:3072
  v_mfma_f32_16x16x32_bf16 v[140:143], a[12:15], a[236:239], 0
  ds_read_b64_tr_b16 a[62:63], v255 offset:19456
  ds_write_b128 v250, a[64:67] offset:0
  ds_write_b128 v250, a[68:71] offset:128
  ds_write_b128 v251, a[72:75] offset:256
  ds_write_b128 v251, a[76:79] offset:384
  ds_read_b64_tr_b16 a[64:65], v252 offset:0
  ds_read_b64_tr_b16 a[66:67], v252 offset:2048
  ds_read_b64_tr_b16 a[68:69], v253 offset:0
  ds_read_b64_tr_b16 a[70:71], v253 offset:2048
  ds_read_b64_tr_b16 a[72:73], v254 offset:0
  ds_read_b64_tr_b16 a[74:75], v254 offset:2048
  ds_read_b64_tr_b16 a[76:77], v255 offset:0
  ds_read_b64_tr_b16 a[78:79], v255 offset:2048
  s_add_u32 s63, s19, 32768
  s_lshl_b32 s18, s18, 5
  v_lshrrev_b32 v11, 4, v1
  v_lshlrev_b32 v11, 3, v11
  v_and_b32 v12, 15, v1
  v_lshl_add_u32 v10, v12, 11, v11
  s_add_u32 s60, s60, s18
  s_add_u32 s61, s60, 32768
  s_add_u32 s62, s3, 1
  s_and_b32 s62, s62, 3
  s_mul_i32 s62, s62, 6144
  v_add_u32 v6, s62, v2
  s_add_u32 s62, s3, 2
  s_and_b32 s62, s62, 3
  s_mul_i32 s62, s62, 6144
  v_add_u32 v7, s62, v2
  s_add_u32 s62, s3, 3
  s_and_b32 s62, s62, 3
  s_mul_i32 s62, s62, 6144
  v_add_u32 v14, s62, v2
  s_mul_i32 s62, s3, 6144
  v_add_u32 v12, s62, v2
  s_waitcnt vmcnt(9)
  v_cmp_gt_u32 vcc, 3, v13
  s_nop 4
  s_cbranch_vccz s_g2p3_ok
  s_mov_b32 s69, 0
s_g2p3:
  buffer_load_dword v13, v15, s[20:23], s17 offen offset:0 sc1
  s_add_u32 s69, s69, 1
  s_waitcnt vmcnt(0)
  v_cmp_gt_u32 vcc, 3, v13
  s_cmp_ge_u32 s69, 4000
  s_cbranch_scc1 s_g2p3_out
  s_nop 3
  s_cbranch_vccnz s_g2p3
s_g2p3_out:
s_g2p3_ok:
  v_mfma_f32_16x16x32_bf16 v[80:83], a[16:19], a[240:243], v[80:83]
  v_mfma_f32_16x16x32_bf16 v[84:87], a[20:23], a[240:243], v[84:87]
  ds_write_b128 v250, a[80:83] offset:17408
  v_mfma_f32_16x16x32_bf16 v[88:91], a[24:27], a[240:243], v[88:91]
  buffer_load_dwordx4 v[16:19], v0, s[20:23], s8 offen offset:0 sc1
  v_mfma_f32_16x16x32_bf16 v[92:95], a[28:31], a[240:243], v[92:95]
  ds_write_b128 v250, a[84:87] offset:17536
  v_mfma_f32_16x16x32_bf16 v[96:99], a[16:19], a[244:247], v[96:99]
  buffer_load_dwordx4 v[20:23], v0, s[20:23], s8 offen offset:1024 sc1
  v_mfma_f32_16x16x32_bf16 v[100:103], a[20:23], a[244:247], v[100:103]
  ds_write_b128 v251, a[88:91] offset:17664
  v_mfma_f32_16x16x32_bf16 v[104:107], a[24:27], a[244:247], v[104:107]
  v_mfma_f32_16x16x32_bf16 v[108:111], a[28:31], a[244:247], v[108:111]
  ds_write_b128 v251, a[92:95] offset:17792
  v_mfma_f32_16x16x32_bf16 v[112:115], a[16:19], a[248:251], v[112:115]
  ds_read_b64_tr_b16 a[80:81], v252 offset:17408
  buffer_load_dwordx4 v[24:27], v0, s[20:23], s12 offen offset:0 sc1
  v_mfma_f32_16x16x32_bf16 v[116:119], a[20:23], a[248:251], v[116:119]
  ds_read_b64_tr_b16 a[82:83], v252 offset:19456
  v_mfma_f32_16x16x32_bf16 v[120:123], a[24:27], a[248:251], v[120:123]
  ds_read_b64_tr_b16 a[84:85], v253 offset:17408
  buffer_load_dwordx4 v[28:31], v0, s[20:23], s12 offen offset:1024 sc1
  v_mfma_f32_16x16x32_bf16 v[124:127], a[28:31], a[248:251], v[124:127]
  ds_read_b64_tr_b16 a[86:87], v253 offset:19456
  v_mfma_f32_16x16x32_bf16 v[128:131], a[16:19], a[252:255], v[128:131]
  ds_read_b64_tr_b16 a[88:89], v254 offset:17408
  v_mfma_f32_16x16x32_bf16 v[132:135], a[20:23], a[252:255], v[132:135]
  ds_read_b64_tr_b16 a[90:91], v254 offset:19456
  buffer_load_dwordx4 v[32:35], v0, s[20:23], s9 offen offset:0 sc1
  v_mfma_f32_16x16x32_bf16 v[136:139], a[24:27], a[252:255], v[136:139]
  ds_read_b64_tr_b16 a[92:93], v255 offset:17408
  v_mfma_f32_16x16x32_bf16 v[140:143], a[28:31], a[252:255], v[140:143]
  ds_read_b64_tr_b16 a[94:95], v255 offset:19456
  s_waitcnt vmcnt(11)
  v_mov_b32 v5, 4
  s_mov_b64 exec, 1
  buffer_store_dword v5, v4, s[20:23], s65 offen sc1
  s_mov_b64 exec, -1
  s_waitcnt lgkmcnt(15)
  v_mfma_f32_16x16x32_bf16 v[80:83], a[32:35], v[144:147], v[80:83]
  buffer_load_dwordx4 v[36:39], v0, s[20:23], s9 offen offset:1024 sc1
  v_mfma_f32_16x16x32_bf16 v[84:87], a[36:39], v[144:147], v[84:87]
  ds_write_b128 v250, a[96:99] offset:0
  v_mfma_f32_16x16x32_bf16 v[88:91], a[40:43], v[144:147], v[88:91]
  buffer_load_dwordx4 v[40:43], v0, s[20:23], s13 offen offset:0 sc1
  v_mfma_f32_16x16x32_bf16 v[92:95], a[44:47], v[144:147], v[92:95]
  ds_write_b128 v250, a[100:103] offset:128
  v_mfma_f32_16x16x32_bf16 v[96:99], a[32:35], v[148:151], v[96:99]
  v_mfma_f32_16x16x32_bf16 v[100:103], a[36:39], v[148:151], v[100:103]
  ds_write_b128 v251, a[104:107] offset:256
  v_mfma_f32_16x16x32_bf16 v[104:107], a[40:43], v[148:151], v[104:107]
  buffer_load_dwordx4 v[44:47], v0, s[20:23], s13 offen offset:1024 sc1
  v_mfma_f32_16x16x32_bf16 v[108:111], a[44:47], v[148:151], v[108:111]
  ds_write_b128 v251, a[108:111] offset:384
  v_mfma_f32_16x16x32_bf16 v[112:115], a[32:35], v[152:155], v[112:115]
  ds_read_b64_tr_b16 a[96:97], v252 offset:0
  s_add_u32 s57, s25, s96
  v_mfma_f32_16x16x32_bf16 v[116:119], a[36:39], v[152:155], v[116:119]
  ds_read_b64_tr_b16 a[98:99], v252 offset:2048
  buffer_load_dwordx4 a[144:147], v8, s[36:39], s57 offen offset:0
  v_mfma_f32_16x16x32_bf16 v[120:123], a[40:43], v[152:155], v[120:123]
  ds_read_b64_tr_b16 a[100:101], v253 offset:0
  buffer_load_dwordx4 v[48:51], v0, s[20:23], s10 offen offset:0 sc1
  v_mfma_f32_16x16x32_bf16 v[124:127], a[44:47], v[152:155], v[124:127]
  ds_read_b64_tr_b16 a[102:103], v253 offset:2048
  v_mfma_f32_16x16x32_bf16 v[128:131], a[32:35], v[156:159], v[128:131]
  ds_read_b64_tr_b16 a[104:105], v254 offset:0
  v_mfma_f32_16x16x32_bf16 v[132:135], a[36:39], v[156:159], v[132:135]
  ds_read_b64_tr_b16 a[106:107], v254 offset:2048
  buffer_load_dwordx4 a[148:151], v8, s[36:39], s57 offen offset:1024
  v_mfma_f32_16x16x32_bf16 v[136:139], a[40:43], v[156:159], v[136:139]
  ds_read_b64_tr_b16 a[108:109], v255 offset:0
  v_mfma_f32_16x16x32_bf16 v[140:143], a[44:47], v[156:159], v[140:143]
  ds_read_b64_tr_b16 a[110:111], v255 offset:2048
  s_barrier
  v_mfma_f32_16x16x32_bf16 v[80:83], a[48:51], v[160:163], v[80:83]
  buffer_load_dwordx4 v[52:55], v0, s[20:23], s10 offen offset:1024 sc1
  v_mfma_f32_16x16x32_bf16 v[84:87], a[52:55], v[160:163], v[84:87]
  ds_write_b128 v250, a[112:115] offset:17408
  v_mfma_f32_16x16x32_bf16 v[88:91], a[56:59], v[160:163], v[88:91]
  v_mfma_f32_16x16x32_bf16 v[92:95], a[60:63], v[160:163], v[92:95]
  ds_write_b128 v250, a[116:119] offset:17536
  v_mfma_f32_16x16x32_bf16 v[96:99], a[48:51], v[164:167], v[96:99]
  buffer_load_dwordx4 a[152:155], v8, s[36:39], s57 offen offset:2048
  v_mfma_f32_16x16x32_bf16 v[100:103], a[52:55], v[164:167], v[100:103]
  ds_write_b128 v251, a[120:123] offset:17664
  v_mfma_f32_16x16x32_bf16 v[104:107], a[56:59], v[164:167], v[104:107]
  buffer_load_dwordx4 v[56:59], v0, s[20:23], s14 offen offset:0 sc1
  v_mfma_f32_16x16x32_bf16 v[108:111], a[60:63], v[164:167], v[108:111]
  ds_write_b128 v251, a[124:127] offset:17792
  v_mfma_f32_16x16x32_bf16 v[112:115], a[48:51], v[168:171], v[112:115]
  ds_read_b64_tr_b16 a[112:113], v252 offset:17408
  buffer_load_dwordx4 a[156:159], v8, s[36:39], s57 offen offset:3072
  v_mfma_f32_16x16x32_bf16 v[116:119], a[52:55], v[168:171], v[116:119]
  ds_read_b64_tr_b16 a[114:115], v252 offset:19456
  v_mfma_f32_16x16x32_bf16 v[120:123], a[56:59], v[168:171], v[120:123]
  ds_read_b64_tr_b16 a[116:117], v253 offset:17408
  v_mfma_f32_16x16x32_bf16 v[124:127], a[60:63], v[168:171], v[124:127]
  ds_read_b64_tr_b16 a[118:119], v253 offset:19456
  v_mfma_f32_16x16x32_bf16 v[128:131], a[48:51], v[172:175], v[128:131]
  ds_read_b64_tr_b16 a[120:121], v254 offset:17408
  buffer_load_dwordx4 v[60:63], v0, s[20:23], s14 offen offset:1024 sc1
  v_mfma_f32_16x16x32_bf16 v[132:135], a[52:55], v[172:175], v[132:135]
  ds_read_b64_tr_b16 a[122:123], v254 offset:19456
  v_mfma_f32_16x16x32_bf16 v[136:139], a[56:59], v[172:175], v[136:139]
  ds_read_b64_tr_b16 a[124:125], v255 offset:17408
  s_add_u32 s57, s26, s96
  v_mfma_f32_16x16x32_bf16 v[140:143], a[60:63], v[172:175], v[140:143]
  ds_read_b64_tr_b16 a[126:127], v255 offset:19456
  s_waitcnt lgkmcnt(15)
  s_waitcnt vmcnt(16)
  v_mfma_f32_16x16x32_bf16 v[80:83], a[64:67], v[16:19], v[80:83]
  buffer_load_dwordx4 a[160:163], v8, s[36:39], s57 offen offset:0
  v_mfma_f32_16x16x32_bf16 v[84:87], a[68:71], v[16:19], v[84:87]
  ds_write_b128 v250, a[192:195] offset:0
  v_mfma_f32_16x16x32_bf16 v[88:91], a[72:75], v[16:19], v[88:91]
  buffer_load_dwordx4 v[64:67], v0, s[20:23], s11 offen offset:0 sc1
  v_mfma_f32_16x16x32_bf16 v[92:95], a[76:79], v[16:19], v[92:95]
  ds_write_b128 v250, a[196:199] offset:128
  s_waitcnt vmcnt(17)
  v_mfma_f32_16x16x32_bf16 v[96:99], a[64:67], v[20:23], v[96:99]
  buffer_load_dwordx4 a[164:167], v8, s[36:39], s57 offen offset:1024
  v_mfma_f32_16x16x32_bf16 v[100:103], a[68:71], v[20:23], v[100:103]
  ds_write_b128 v251, a[200:203] offset:256
  v_mfma_f32_16x16x32_bf16 v[104:107], a[72:75], v[20:23], v[104:107]
  buffer_load_dwordx4 v[68:71], v0, s[20:23], s11 offen offset:1024 sc1
  v_mfma_f32_16x16x32_bf16 v[108:111], a[76:79], v[20:23], v[108:111]
  ds_write_b128 v251, a[204:207] offset:384
  s_waitcnt vmcnt(18)
  v_mfma_f32_16x16x32_bf16 v[112:115], a[64:67], v[24:27], v[112:115]
  ds_read_b64_tr_b16 a[192:193], v252 offset:0
  v_mfma_f32_16x16x32_bf16 v[116:119], a[68:71], v[24:27], v[116:119]
  ds_read_b64_tr_b16 a[194:195], v252 offset:2048
  buffer_load_dwordx4 a[168:171], v8, s[36:39], s57 offen offset:2048
  v_mfma_f32_16x16x32_bf16 v[120:123], a[72:75], v[24:27], v[120:123]
  ds_read_b64_tr_b16 a[196:197], v253 offset:0
  v_mfma_f32_16x16x32_bf16 v[124:127], a[76:79], v[24:27], v[124:127]
  ds_read_b64_tr_b16 a[198:199], v253 offset:2048
  s_waitcnt vmcnt(18)
  v_mfma_f32_16x16x32_bf16 v[128:131], a[64:67], v[28:31], v[128:131]
  ds_read_b64_tr_b16 a[200:201], v254 offset:0
  buffer_load_dwordx4 v[72:75], v0, s[20:23], s15 offen offset:0 sc1
  v_mfma_f32_16x16x32_bf16 v[132:135], a[68:71], v[28:31], v[132:135]
  ds_read_b64_tr_b16 a[202:203], v254 offset:2048
  v_mfma_f32_16x16x32_bf16 v[136:139], a[72:75], v[28:31], v[136:139]
  ds_read_b64_tr_b16 a[204:205], v255 offset:0
  v_mfma_f32_16x16x32_bf16 v[140:143], a[76:79], v[28:31], v[140:143]
  ds_read_b64_tr_b16 a[206:207], v255 offset:2048
  buffer_load_dword v13, v15, s[20:23], s17 offen sc1
  s_waitcnt vmcnt(19)
  v_mfma_f32_16x16x32_bf16 v[80:83], a[80:83], v[32:35], v[80:83]
  buffer_load_dwordx4 a[172:175], v8, s[36:39], s57 offen offset:3072
  v_mfma_f32_16x16x32_bf16 v[84:87], a[84:87], v[32:35], v[84:87]
  ds_write_b128 v250, a[208:211] offset:17408
  v_mfma_f32_16x16x32_bf16 v[88:91], a[88:91], v[32:35], v[88:91]
  buffer_load_dwordx4 v[76:79], v0, s[20:23], s15 offen offset:1024 sc1
  v_mfma_f32_16x16x32_bf16 v[92:95], a[92:95], v[32:35], v[92:95]
  ds_write_b128 v250, a[212:215] offset:17536
  s_waitcnt vmcnt(19)
  v_mfma_f32_16x16x32_bf16 v[96:99], a[80:83], v[36:39], v[96:99]
  s_add_u32 s57, s27, s96
  buffer_load_dwordx4 a[176:179], v8, s[36:39], s57 offen offset:0
  v_mfma_f32_16x16x32_bf16 v[100:103], a[84:87], v[36:39], v[100:103]
  ds_write_b128 v251, a[216:219] offset:17664
  v_mfma_f32_16x16x32_bf16 v[104:107], a[88:91], v[36:39], v[104:107]
  v_mfma_f32_16x16x32_bf16 v[108:111], a[92:95], v[36:39], v[108:111]
  ds_write_b128 v251, a[220:223] offset:17792
  s_waitcnt vmcnt(19)
  v_mfma_f32_16x16x32_bf16 v[112:115], a[80:83], v[40:43], v[112:115]
  ds_read_b64_tr_b16 a[208:209], v252 offset:17408
  buffer_load_dwordx4 v[192:195], v244, s[20:23], s8 offen offset:0 sc1
  v_mfma_f32_16x16x32_bf16 v[116:119], a[84:87], v[40:43], v[116:119]
  ds_read_b64_tr_b16 a[210:211], v252 offset:19456
  v_mfma_f32_16x16x32_bf16 v[120:123], a[88:91], v[40:43], v[120:123]
  ds_read_b64_tr_b16 a[212:213], v253 offset:17408
  buffer_load_dwordx4 v[196:199], v244, s[20:23], s9 offen offset:0 sc1
  v_mfma_f32_16x16x32_bf16 v[124:127], a[92:95], v[40:43], v[124:127]
  ds_read_b64_tr_b16 a[214:215], v253 offset:19456
  s_waitcnt vmcnt(20)
  v_mfma_f32_16x16x32_bf16 v[128:131], a[80:83], v[44:47], v[128:131]
  ds_read_b64_tr_b16 a[216:217], v254 offset:17408
  v_mfma_f32_16x16x32_bf16 v[132:135], a[84:87], v[44:47], v[132:135]
  ds_read_b64_tr_b16 a[218:219], v254 offset:19456
  buffer_load_dwordx4 a[180:183], v8, s[36:39], s57 offen offset:1024
  v_mfma_f32_16x16x32_bf16 v[136:139], a[88:91], v[44:47], v[136:139]
  ds_read_b64_tr_b16 a[220:221], v255 offset:17408
  v_mfma_f32_16x16x32_bf16 v[140:143], a[92:95], v[44:47], v[140:143]
  ds_read_b64_tr_b16 a[222:223], v255 offset:19456
  s_waitcnt lgkmcnt(15)
  s_waitcnt vmcnt(19)
  v_mfma_f32_16x16x32_bf16 v[80:83], a[96:99], v[48:51], v[80:83]
  buffer_load_dwordx4 a[184:187], v8, s[36:39], s57 offen offset:2048
  v_mfma_f32_16x16x32_bf16 v[84:87], a[100:103], v[48:51], v[84:87]
  ds_write_b128 v250, a[128:131] offset:0
  v_mfma_f32_16x16x32_bf16 v[88:91], a[104:107], v[48:51], v[88:91]
  buffer_load_dwordx4 v[200:203], v244, s[20:23], s12 offen offset:0 sc1
  v_mfma_f32_16x16x32_bf16 v[92:95], a[108:111], v[48:51], v[92:95]
  ds_write_b128 v250, a[132:135] offset:128
  s_waitcnt vmcnt(19)
  v_mfma_f32_16x16x32_bf16 v[96:99], a[96:99], v[52:55], v[96:99]
  v_mfma_f32_16x16x32_bf16 v[100:103], a[100:103], v[52:55], v[100:103]
  ds_write_b128 v251, a[136:139] offset:256
  v_mfma_f32_16x16x32_bf16 v[104:107], a[104:107], v[52:55], v[104:107]
  buffer_load_dwordx4 v[204:207], v244, s[20:23], s13 offen offset:0 sc1
  v_mfma_f32_16x16x32_bf16 v[108:111], a[108:111], v[52:55], v[108:111]
  ds_write_b128 v251, a[140:143] offset:384
  s_waitcnt vmcnt(18)
  v_mfma_f32_16x16x32_bf16 v[112:115], a[96:99], v[56:59], v[112:115]
  ds_read_b64_tr_b16 a[128:129], v252 offset:0
  buffer_load_dwordx4 a[188:191], v8, s[36:39], s57 offen offset:3072
  v_mfma_f32_16x16x32_bf16 v[116:119], a[100:103], v[56:59], v[116:119]
  ds_read_b64_tr_b16 a[130:131], v252 offset:2048
  v_mfma_f32_16x16x32_bf16 v[120:123], a[104:107], v[56:59], v[120:123]
  ds_read_b64_tr_b16 a[132:133], v253 offset:0
  v_mfma_f32_16x16x32_bf16 v[124:127], a[108:111], v[56:59], v[124:127]
  ds_read_b64_tr_b16 a[134:135], v253 offset:2048
  s_waitcnt vmcnt(17)
  v_mfma_f32_16x16x32_bf16 v[128:131], a[96:99], v[60:63], v[128:131]
  ds_read_b64_tr_b16 a[136:137], v254 offset:0
  buffer_load_dwordx4 v[208:211], v244, s[20:23], s10 offen offset:0 sc1
  v_mfma_f32_16x16x32_bf16 v[132:135], a[100:103], v[60:63], v[132:135]
  ds_read_b64_tr_b16 a[138:139], v254 offset:2048
  v_mfma_f32_16x16x32_bf16 v[136:139], a[104:107], v[60:63], v[136:139]
  ds_read_b64_tr_b16 a[140:141], v255 offset:0
  buffer_load_dwordx4 v[212:215], v244, s[20:23], s11 offen offset:0 sc1
  v_mfma_f32_16x16x32_bf16 v[140:143], a[108:111], v[60:63], v[140:143]
  ds_read_b64_tr_b16 a[142:143], v255 offset:2048
  s_waitcnt vmcnt(12)
  v_cmp_gt_u32 vcc, 4, v13
  s_nop 4
  s_cbranch_vccz s_g2p4_ok
  s_mov_b32 s69, 0
s_g2p4:
  buffer_load_dword v13, v15, s[20:23], s17 offen offset:0 sc1
  s_add_u32 s69, s69, 1
  s_waitcnt vmcnt(0)
  v_cmp_gt_u32 vcc, 4, v13
  s_cmp_ge_u32 s69, 4000
  s_cbranch_scc1 s_g2p4_out
  s_nop 3
  s_cbranch_vccnz s_g2p4
s_g2p4_out:
s_g2p4_ok:
  v_mfma_f32_16x16x32_bf16 v[80:83], a[112:115], v[64:67], v[80:83]
  buffer_load_dwordx4 v[216:219], v244, s[20:23], s14 offen offset:0 sc1
  v_mfma_f32_16x16x32_bf16 v[84:87], a[116:119], v[64:67], v[84:87]
  ds_write_b128 v250, a[144:147] offset:17408
  v_mfma_f32_16x16x32_bf16 v[88:91], a[120:123], v[64:67], v[88:91]
  v_mfma_f32_16x16x32_bf16 v[92:95], a[124:127], v[64:67], v[92:95]
  ds_write_b128 v250, a[148:151] offset:17536
  v_mfma_f32_16x16x32_bf16 v[96:99], a[112:115], v[68:71], v[96:99]
  buffer_load_dwordx4 v[220:223], v244, s[20:23], s15 offen offset:0 sc1
  v_mfma_f32_16x16x32_bf16 v[100:103], a[116:119], v[68:71], v[100:103]
  ds_write_b128 v251, a[152:155] offset:17664
  v_mfma_f32_16x16x32_bf16 v[104:107], a[120:123], v[68:71], v[104:107]
  buffer_load_dwordx4 v[224:227], v3, s[20:23], s19 offen sc1
  v_mfma_f32_16x16x32_bf16 v[108:111], a[124:127], v[68:71], v[108:111]
  ds_write_b128 v251, a[156:159] offset:17792
  v_mfma_f32_16x16x32_bf16 v[112:115], a[112:115], v[72:75], v[112:115]
  ds_read_b64_tr_b16 a[144:145], v252 offset:17408
  v_mfma_f32_16x16x32_bf16 v[116:119], a[116:119], v[72:75], v[116:119]
  ds_read_b64_tr_b16 a[146:147], v252 offset:19456
  buffer_load_dwordx4 v[228:231], v3, s[20:23], s63 offen sc1
  v_mfma_f32_16x16x32_bf16 v[120:123], a[120:123], v[72:75], v[120:123]
  ds_read_b64_tr_b16 a[148:149], v253 offset:17408
  v_mfma_f32_16x16x32_bf16 v[124:127], a[124:127], v[72:75], v[124:127]
  ds_read_b64_tr_b16 a[150:151], v253 offset:19456
  s_waitcnt vmcnt(14)
  v_mfma_f32_16x16x32_bf16 v[128:131], a[112:115], v[76:79], v[128:131]
  ds_read_b64_tr_b16 a[152:153], v254 offset:17408
  buffer_load_dwordx2 v[232:233], v11, s[44:47], s18 offen
  v_mfma_f32_16x16x32_bf16 v[132:135], a[116:119], v[76:79], v[132:135]
  ds_read_b64_tr_b16 a[154:155], v254 offset:19456
  v_mfma_f32_16x16x32_bf16 v[136:139], a[120:123], v[76:79], v[136:139]
  ds_read_b64_tr_b16 a[156:157], v255 offset:17408
  buffer_load_dwordx4 a[224:227], v245, s[20:23], s8 offen offset:0 sc1
  v_mfma_f32_16x16x32_bf16 v[140:143], a[124:127], v[76:79], v[140:143]
  ds_read_b64_tr_b16 a[158:159], v255 offset:19456
  s_waitcnt lgkmcnt(15)
  s_waitcnt vmcnt(13)
  v_swap_b32 v194, v196
  v_swap_b32 v195, v197
  s_nop 1
  v_mfma_f32_16x16x32_bf16 v[80:83], a[192:195], v[192:195], v[80:83]
  v_mfma_f32_16x16x32_bf16 v[84:87], a[196:199], v[192:195], v[84:87]
  ds_write_b128 v250, a[160:163] offset:0
  v_mfma_f32_16x16x32_bf16 v[88:91], a[200:203], v[192:195], v[88:91]
  buffer_load_dwordx4 a[240:243], v245, s[20:23], s9 offen offset:0 sc1
  v_mfma_f32_16x16x32_bf16 v[92:95], a[204:207], v[192:195], v[92:95]
  ds_write_b128 v250, a[164:167] offset:128
  v_mfma_f32_16x16x32_bf16 v[96:99], a[192:195], v[196:199], v[96:99]
  buffer_load_dwordx4 v[144:147], v245, s[20:23], s10 offen offset:0 sc1
  v_mfma_f32_16x16x32_bf16 v[100:103], a[196:199], v[196:199], v[100:103]
  ds_write_b128 v251, a[168:171] offset:256
  v_mfma_f32_16x16x32_bf16 v[104:107], a[200:203], v[196:199], v[104:107]
  v_mfma_f32_16x16x32_bf16 v[108:111], a[204:207], v[196:199], v[108:111]
  ds_write_b128 v251, a[172:175] offset:384
  s_waitcnt vmcnt(11)
  v_swap_b32 v202, v204
  v_swap_b32 v203, v205
  s_nop 1
  v_mfma_f32_16x16x32_bf16 v[112:115], a[192:195], v[200:203], v[112:115]
  ds_read_b64_tr_b16 a[160:161], v252 offset:0
  buffer_load_dwordx4 v[160:163], v245, s[20:23], s11 offen offset:0 sc1
  v_mfma_f32_16x16x32_bf16 v[116:119], a[196:199], v[200:203], v[116:119]
  ds_read_b64_tr_b16 a[162:163], v252 offset:2048
  v_mfma_f32_16x16x32_bf16 v[120:123], a[200:203], v[200:203], v[120:123]
  ds_read_b64_tr_b16 a[164:165], v253 offset:0
  buffer_load_dwordx4 a[228:231], v245, s[20:23], s8 offen offset:1024 sc1
  v_mfma_f32_16x16x32_bf16 v[124:127], a[204:207], v[200:203], v[124:127]
  ds_read_b64_tr_b16 a[166:167], v253 offset:2048
  v_mfma_f32_16x16x32_bf16 v[128:131], a[192:195], v[204:207], v[128:131]
  ds_read_b64_tr_b16 a[168:169], v254 offset:0
  buffer_load_dwordx4 a[244:247], v245, s[20:23], s9 offen offset:1024 sc1
  v_mfma_f32_16x16x32_bf16 v[132:135], a[196:199], v[204:207], v[132:135]
  ds_read_b64_tr_b16 a[170:171], v254 offset:2048
  v_mfma_f32_16x16x32_bf16 v[136:139], a[200:203], v[204:207], v[136:139]
  ds_read_b64_tr_b16 a[172:173], v255 offset:0
  v_mfma_f32_16x16x32_bf16 v[140:143], a[204:207], v[204:207], v[140:143]
  ds_read_b64_tr_b16 a[174:175], v255 offset:2048
  s_waitcnt vmcnt(11)
  v_swap_b32 v210, v212
  v_swap_b32 v211, v213
  s_nop 1
  v_mfma_f32_16x16x32_bf16 v[80:83], a[208:211], v[208:211], v[80:83]
  buffer_load_dwordx4 v[148:151], v245, s[20:23], s10 offen offset:1024 sc1
  v_mfma_f32_16x16x32_bf16 v[84:87], a[212:215], v[208:211], v[84:87]
  ds_write_b128 v250, a[176:179] offset:17408
  v_mfma_f32_16x16x32_bf16 v[88:91], a[216:219], v[208:211], v[88:91]
  buffer_load_dwordx4 v[164:167], v245, s[20:23], s11 offen offset:1024 sc1
  v_mfma_f32_16x16x32_bf16 v[92:95], a[220:223], v[208:211], v[92:95]
  ds_write_b128 v250, a[180:183] offset:17536
  v_mfma_f32_16x16x32_bf16 v[96:99], a[208:211], v[212:215], v[96:99]
  v_mfma_f32_16x16x32_bf16 v[100:103], a[212:215], v[212:215], v[100:103]
  ds_write_b128 v251, a[184:187] offset:17664
  v_mfma_f32_16x16x32_bf16 v[104:107], a[216:219], v[212:215], v[104:107]
  buffer_load_dwordx4 a[232:235], v245, s[20:23], s12 offen offset:0 sc1
  v_mfma_f32_16x16x32_bf16 v[108:111], a[220:223], v[212:215], v[108:111]
  ds_write_b128 v251, a[188:191] offset:17792
  s_waitcnt vmcnt(12)
  v_swap_b32 v218, v220
  v_swap_b32 v219, v221
  s_nop 1
  v_mfma_f32_16x16x32_bf16 v[112:115], a[208:211], v[216:219], v[112:115]
  ds_read_b64_tr_b16 a[176:177], v252 offset:17408
  buffer_load_dwordx4 a[248:251], v245, s[20:23], s13 offen offset:0 sc1
  v_mfma_f32_16x16x32_bf16 v[116:119], a[212:215], v[216:219], v[116:119]
  ds_read_b64_tr_b16 a[178:179], v252 offset:19456
  v_mfma_f32_16x16x32_bf16 v[120:123], a[216:219], v[216:219], v[120:123]
  ds_read_b64_tr_b16 a[180:181], v253 offset:17408
  v_mfma_f32_16x16x32_bf16 v[124:127], a[220:223], v[216:219], v[124:127]
  ds_read_b64_tr_b16 a[182:183], v253 offset:19456
  v_mfma_f32_16x16x32_bf16 v[128:131], a[208:211], v[220:223], v[128:131]
  ds_read_b64_tr_b16 a[184:185], v254 offset:17408
  buffer_load_dwordx4 v[152:155], v245, s[20:23], s14 offen offset:0 sc1
  v_mfma_f32_16x16x32_bf16 v[132:135], a[212:215], v[220:223], v[132:135]
  ds_read_b64_tr_b16 a[186:187], v254 offset:19456
  buffer_load_dwordx4 v[168:171], v245, s[20:23], s15 offen offset:0 sc1
  v_mfma_f32_16x16x32_bf16 v[136:139], a[216:219], v[220:223], v[136:139]
  ds_read_b64_tr_b16 a[188:189], v255 offset:17408
  v_mfma_f32_16x16x32_bf16 v[140:143], a[220:223], v[220:223], v[140:143]
  ds_read_b64_tr_b16 a[190:191], v255 offset:19456
  s_waitcnt lgkmcnt(15)
  s_waitcnt vmcnt(11)
  v_mfma_f32_16x16x32_bf16 v[80:83], a[128:131], a[224:227], v[80:83]
  buffer_load_dwordx4 a[236:239], v245, s[20:23], s12 offen offset:1024 sc1
  v_lshlrev_b32 v16, 16, v232
  v_and_b32 v17, s6, v232
  v_mfma_f32_16x16x32_bf16 v[84:87], a[132:135], a[224:227], v[84:87]
  v_lshlrev_b32 v18, 16, v233
  v_and_b32 v19, s6, v233
  v_lshlrev_b32 v20, 16, v224
  v_mfma_f32_16x16x32_bf16 v[88:91], a[136:139], a[224:227], v[88:91]
  v_and_b32 v21, s6, v224
  v_lshlrev_b32 v22, 16, v225
  v_and_b32 v23, s6, v225
  v_mfma_f32_16x16x32_bf16 v[92:95], a[140:143], a[224:227], v[92:95]
  buffer_load_dwordx4 a[252:255], v245, s[20:23], s13 offen offset:1024 sc1
  v_lshlrev_b32 v24, 16, v226
  s_waitcnt vmcnt(12)
  v_mfma_f32_16x16x32_bf16 v[80:83], a[144:147], a[240:243], v[80:83]
  v_and_b32 v25, s6, v226
  v_lshlrev_b32 v26, 16, v227
  v_and_b32 v27, s6, v227
  v_mfma_f32_16x16x32_bf16 v[84:87], a[148:151], a[240:243], v[84:87]
  v_lshlrev_b32 v28, 16, v228
  v_and_b32 v29, s6, v228
  v_lshlrev_b32 v30, 16, v229
  v_mfma_f32_16x16x32_bf16 v[88:91], a[152:155], a[240:243], v[88:91]
  buffer_load_dwordx4 v[156:159], v245, s[20:23], s14 offen offset:1024 sc1
  v_and_b32 v31, s6, v229
  v_lshlrev_b32 v32, 16, v230
  v_mfma_f32_16x16x32_bf16 v[92:95], a[156:159], a[240:243], v[92:95]
  v_and_b32 v33, s6, v230
  v_lshlrev_b32 v34, 16, v231
  s_waitcnt lgkmcnt(12)
  s_waitcnt vmcnt(12)
  v_mfma_f32_16x16x32_bf16 v[80:83], a[160:163], v[144:147], v[80:83]
  v_and_b32 v35, s6, v231
  v_mfma_f32_16x16x32_bf16 v[84:87], a[164:167], v[144:147], v[84:87]
  buffer_load_dwordx4 v[172:175], v245, s[20:23], s15 offen offset:1024 sc1
  v_mfma_f32_16x16x32_bf16 v[88:91], a[168:171], v[144:147], v[88:91]
  v_mfma_f32_16x16x32_bf16 v[92:95], a[172:175], v[144:147], v[92:95]
  s_waitcnt lgkmcnt(0)
  s_waitcnt vmcnt(12)
  v_mfma_f32_16x16x32_bf16 v[80:83], a[176:179], v[160:163], v[80:83]
  v_mfma_f32_16x16x32_bf16 v[84:87], a[180:183], v[160:163], v[84:87]
  v_mfma_f32_16x16x32_bf16 v[88:91], a[184:187], v[160:163], v[88:91]
  v_mfma_f32_16x16x32_bf16 v[92:95], a[188:191], v[160:163], v[92:95]
  s_waitcnt vmcnt(11)
  v_mfma_f32_16x16x32_bf16 v[96:99], a[128:131], a[228:231], v[96:99]
  v_mfma_f32_16x16x32_bf16 v[100:103], a[132:135], a[228:231], v[100:103]
  s_nop 2
  ds_write_b128 v6, v[84:87] offset:0
  v_mfma_f32_16x16x32_bf16 v[104:107], a[136:139], a[228:231], v[104:107]
  ds_write_b128 v7, v[88:91] offset:2048
  v_mfma_f32_16x16x32_bf16 v[108:111], a[140:143], a[228:231], v[108:111]
  ds_write_b128 v14, v[92:95] offset:4096
  s_waitcnt vmcnt(10)
  v_mfma_f32_16x16x32_bf16 v[96:99], a[144:147], a[244:247], v[96:99]
  v_mfma_f32_16x16x32_bf16 v[100:103], a[148:151], a[244:247], v[100:103]
  v_mfma_f32_16x16x32_bf16 v[104:107], a[152:155], a[244:247], v[104:107]
  v_mfma_f32_16x16x32_bf16 v[108:111], a[156:159], a[244:247], v[108:111]
  s_waitcnt vmcnt(9)
  v_mfma_f32_16x16x32_bf16 v[96:99], a[160:163], v[148:151], v[96:99]
  v_mfma_f32_16x16x32_bf16 v[100:103], a[164:167], v[148:151], v[100:103]
  v_mfma_f32_16x16x32_bf16 v[104:107], a[168:171], v[148:151], v[104:107]
  v_mfma_f32_16x16x32_bf16 v[108:111], a[172:175], v[148:151], v[108:111]
  s_waitcnt vmcnt(8)
  v_mfma_f32_16x16x32_bf16 v[96:99], a[176:179], v[164:167], v[96:99]
  s_waitcnt lgkmcnt(0)
  s_barrier
  ds_read_b128 v[56:59], v12 offset:0
  v_mfma_f32_16x16x32_bf16 v[100:103], a[180:183], v[164:167], v[100:103]
  ds_read_b128 v[60:63], v12 offset:2048
  ds_read_b128 v[64:67], v12 offset:4096
  v_mfma_f32_16x16x32_bf16 v[104:107], a[184:187], v[164:167], v[104:107]
  v_mfma_f32_16x16x32_bf16 v[108:111], a[188:191], v[164:167], v[108:111]
  s_waitcnt vmcnt(7)
  v_mfma_f32_16x16x32_bf16 v[112:115], a[128:131], a[232:235], v[112:115]
  v_mfma_f32_16x16x32_bf16 v[116:119], a[132:135], a[232:235], v[116:119]
  s_nop 0
  ds_write_b128 v6, v[100:103] offset:1024
  v_mfma_f32_16x16x32_bf16 v[120:123], a[136:139], a[232:235], v[120:123]
  s_nop 0
  ds_write_b128 v7, v[104:107] offset:3072
  v_mfma_f32_16x16x32_bf16 v[124:127], a[140:143], a[232:235], v[124:127]
  ds_write_b128 v14, v[108:111] offset:5120
  s_waitcnt vmcnt(6)
  v_mfma_f32_16x16x32_bf16 v[112:115], a[144:147], a[248:251], v[112:115]
  s_waitcnt lgkmcnt(5)
  v_add_f32 v80, v80, v56
  v_add_f32 v81, v81, v57
  v_mfma_f32_16x16x32_bf16 v[116:119], a[148:151], a[248:251], v[116:119]
  v_add_f32 v82, v82, v58
  v_add_f32 v83, v83, v59
  v_mfma_f32_16x16x32_bf16 v[120:123], a[152:155], a[248:251], v[120:123]
  s_waitcnt lgkmcnt(4)
  v_add_f32 v80, v80, v60
  v_add_f32 v81, v81, v61
  v_mfma_f32_16x16x32_bf16 v[124:127], a[156:159], a[248:251], v[124:127]
  v_add_f32 v82, v82, v62
  v_add_f32 v83, v83, v63
  s_waitcnt vmcnt(5)
  v_mfma_f32_16x16x32_bf16 v[112:115], a[160:163], v[152:155], v[112:115]
  s_waitcnt lgkmcnt(3)
  v_add_f32 v80, v80, v64
  v_add_f32 v81, v81, v65
  v_mfma_f32_16x16x32_bf16 v[116:119], a[164:167], v[152:155], v[116:119]
  v_add_f32 v82, v82, v66
  v_add_f32 v83, v83, v67
  v_cvt_pk_bf16_f32 v80, v80, v81
  v_mfma_f32_16x16x32_bf16 v[120:123], a[168:171], v[152:155], v[120:123]
  v_cvt_pk_bf16_f32 v82, v82, v83
  v_and_b32 v81, s6, v80
  v_and_b32 v83, s6, v82
  v_mfma_f32_16x16x32_bf16 v[124:127], a[172:175], v[152:155], v[124:127]
  v_lshlrev_b32 v80, 16, v80
  v_lshlrev_b32 v82, 16, v82
  s_waitcnt vmcnt(4)
  v_mfma_f32_16x16x32_bf16 v[112:115], a[176:179], v[168:171], v[112:115]
  v_add_f32 v80, v80, v16
  v_add_f32 v81, v81, v17
  v_add_f32 v82, v82, v18
  v_mfma_f32_16x16x32_bf16 v[116:119], a[180:183], v[168:171], v[116:119]
  v_add_f32 v83, v83, v19
  v_cvt_pk_bf16_f32 v80, v80, v81
  v_cvt_pk_bf16_f32 v82, v82, v83
  v_mfma_f32_16x16x32_bf16 v[120:123], a[184:187], v[168:171], v[120:123]
  v_and_b32 v81, s6, v80
  v_and_b32 v83, s6, v82
  v_lshlrev_b32 v80, 16, v80
  v_mfma_f32_16x16x32_bf16 v[124:127], a[188:191], v[168:171], v[124:127]
  v_lshlrev_b32 v82, 16, v82
  v_add_f32 v80, v80, v20
  v_add_f32 v81, v81, v21
  v_add_f32 v82, v82, v22
  v_add_f32 v83, v83, v23
  v_cvt_pk_bf16_f32 v80, v80, v81
  v_cvt_pk_bf16_f32 v81, v82, v83
  buffer_store_dwordx2 v[80:81], v10, s[48:51], s60 offen offset:0
  s_waitcnt lgkmcnt(0)
  s_barrier
  ds_read_b128 v[68:71], v12 offset:1024
  ds_read_b128 v[72:75], v12 offset:3072
  ds_read_b128 v[76:79], v12 offset:5120
  s_waitcnt vmcnt(4)
  v_mfma_f32_16x16x32_bf16 v[128:131], a[128:131], a[236:239], v[128:131]
  v_mfma_f32_16x16x32_bf16 v[132:135], a[132:135], a[236:239], v[132:135]
  ds_write_b128 v6, v[116:119] offset:24576
  v_mfma_f32_16x16x32_bf16 v[136:139], a[136:139], a[236:239], v[136:139]
  ds_write_b128 v7, v[120:123] offset:26624
  v_mfma_f32_16x16x32_bf16 v[140:143], a[140:143], a[236:239], v[140:143]
  ds_write_b128 v14, v[124:127] offset:28672
  s_waitcnt vmcnt(3)
  v_mfma_f32_16x16x32_bf16 v[128:131], a[144:147], a[252:255], v[128:131]
  s_waitcnt lgkmcnt(5)
  v_add_f32 v96, v96, v68
  v_add_f32 v97, v97, v69
  v_mfma_f32_16x16x32_bf16 v[132:135], a[148:151], a[252:255], v[132:135]
  v_add_f32 v98, v98, v70
  v_add_f32 v99, v99, v71
  v_mfma_f32_16x16x32_bf16 v[136:139], a[152:155], a[252:255], v[136:139]
  s_waitcnt lgkmcnt(4)
  v_add_f32 v96, v96, v72
  v_add_f32 v97, v97, v73
  v_mfma_f32_16x16x32_bf16 v[140:143], a[156:159], a[252:255], v[140:143]
  v_add_f32 v98, v98, v74
  v_add_f32 v99, v99, v75
  s_waitcnt vmcnt(2)
  v_mfma_f32_16x16x32_bf16 v[128:131], a[160:163], v[156:159], v[128:131]
  s_waitcnt lgkmcnt(3)
  v_add_f32 v96, v96, v76
  v_add_f32 v97, v97, v77
  v_mfma_f32_16x16x32_bf16 v[132:135], a[164:167], v[156:159], v[132:135]
  v_add_f32 v98, v98, v78
  v_add_f32 v99, v99, v79
  v_cvt_pk_bf16_f32 v96, v96, v97
  v_mfma_f32_16x16x32_bf16 v[136:139], a[168:171], v[156:159], v[136:139]
  v_cvt_pk_bf16_f32 v98, v98, v99
  v_and_b32 v97, s6, v96
  v_and_b32 v99, s6, v98
  v_mfma_f32_16x16x32_bf16 v[140:143], a[172:175], v[156:159], v[140:143]
  v_lshlrev_b32 v96, 16, v96
  v_lshlrev_b32 v98, 16, v98
  s_waitcnt vmcnt(1)
  v_mfma_f32_16x16x32_bf16 v[128:131], a[176:179], v[172:175], v[128:131]
  v_add_f32 v96, v96, v16
  v_add_f32 v97, v97, v17
  v_add_f32 v98, v98, v18
  v_mfma_f32_16x16x32_bf16 v[132:135], a[180:183], v[172:175], v[132:135]
  v_add_f32 v99, v99, v19
  v_cvt_pk_bf16_f32 v96, v96, v97
  v_cvt_pk_bf16_f32 v98, v98, v99
  v_mfma_f32_16x16x32_bf16 v[136:139], a[184:187], v[172:175], v[136:139]
  v_and_b32 v97, s6, v96
  v_and_b32 v99, s6, v98
  v_lshlrev_b32 v96, 16, v96
  v_mfma_f32_16x16x32_bf16 v[140:143], a[188:191], v[172:175], v[140:143]
  v_lshlrev_b32 v98, 16, v98
  v_add_f32 v96, v96, v24
  v_add_f32 v97, v97, v25
  v_add_f32 v98, v98, v26
  v_add_f32 v99, v99, v27
  v_cvt_pk_bf16_f32 v96, v96, v97
  v_cvt_pk_bf16_f32 v97, v98, v99
  buffer_store_dwordx2 v[96:97], v10, s[48:51], s60 offen offset:1024
  s_waitcnt lgkmcnt(0)
  s_barrier
  ds_read_b128 v[56:59], v12 offset:24576
  ds_read_b128 v[60:63], v12 offset:26624
  ds_read_b128 v[64:67], v12 offset:28672
  s_waitcnt lgkmcnt(2)
  v_pk_add_f32 v[112:113], v[112:113], v[56:57]
  v_pk_add_f32 v[114:115], v[114:115], v[58:59]
  s_waitcnt lgkmcnt(1)
  v_pk_add_f32 v[112:113], v[112:113], v[60:61]
  v_pk_add_f32 v[114:115], v[114:115], v[62:63]
  ds_write_b128 v6, v[132:135] offset:25600
  ds_write_b128 v7, v[136:139] offset:27648
  ds_write_b128 v14, v[140:143] offset:29696
  s_waitcnt lgkmcnt(3)
  v_pk_add_f32 v[112:113], v[112:113], v[64:65]
  v_pk_add_f32 v[114:115], v[114:115], v[66:67]
  v_cvt_pk_bf16_f32 v112, v112, v113
  v_cvt_pk_bf16_f32 v114, v114, v115
  v_and_b32 v113, s6, v112
  v_and_b32 v115, s6, v114
  v_lshlrev_b32 v112, 16, v112
  v_lshlrev_b32 v114, 16, v114
  v_pk_add_f32 v[112:113], v[112:113], v[16:17]
  v_pk_add_f32 v[114:115], v[114:115], v[18:19]
  v_cvt_pk_bf16_f32 v112, v112, v113
  v_cvt_pk_bf16_f32 v114, v114, v115
  v_and_b32 v113, s6, v112
  v_and_b32 v115, s6, v114
  v_lshlrev_b32 v112, 16, v112
  v_lshlrev_b32 v114, 16, v114
  v_pk_add_f32 v[112:113], v[112:113], v[28:29]
  v_pk_add_f32 v[114:115], v[114:115], v[30:31]
  v_cvt_pk_bf16_f32 v112, v112, v113
  v_cvt_pk_bf16_f32 v113, v114, v115
  buffer_store_dwordx2 v[112:113], v10, s[48:51], s61 offen offset:0
  s_waitcnt lgkmcnt(0)
  s_barrier
  ds_read_b128 v[68:71], v12 offset:25600
  ds_read_b128 v[72:75], v12 offset:27648
  ds_read_b128 v[76:79], v12 offset:29696
  s_waitcnt lgkmcnt(2)
  v_pk_add_f32 v[128:129], v[128:129], v[68:69]
  v_pk_add_f32 v[130:131], v[130:131], v[70:71]
  s_waitcnt lgkmcnt(1)
  v_pk_add_f32 v[128:129], v[128:129], v[72:73]
  v_pk_add_f32 v[130:131], v[130:131], v[74:75]
  s_waitcnt lgkmcnt(0)
  v_pk_add_f32 v[128:129], v[128:129], v[76:77]
  v_pk_add_f32 v[130:131], v[130:131], v[78:79]
  v_cvt_pk_bf16_f32 v128, v128, v129
  v_cvt_pk_bf16_f32 v130, v130, v131
  v_and_b32 v129, s6, v128
  v_and_b32 v131, s6, v130
  v_lshlrev_b32 v128, 16, v128
  v_lshlrev_b32 v130, 16, v130
  v_pk_add_f32 v[128:129], v[128:129], v[16:17]
  v_pk_add_f32 v[130:131], v[130:131], v[18:19]
  v_cvt_pk_bf16_f32 v128, v128, v129
  v_cvt_pk_bf16_f32 v130, v130, v131
  v_and_b32 v129, s6, v128
  v_and_b32 v131, s6, v130
  v_lshlrev_b32 v128, 16, v128
  v_lshlrev_b32 v130, 16, v130
  v_pk_add_f32 v[128:129], v[128:129], v[32:33]
  v_pk_add_f32 v[130:131], v[130:131], v[34:35]
  v_cvt_pk_bf16_f32 v128, v128, v129
  v_cvt_pk_bf16_f32 v129, v130, v131
  buffer_store_dwordx2 v[128:129], v10, s[48:51], s61 offen offset:1024
  s_endpgm
.section .rodata,"a"
.p2align 6
.amdhsa_kernel sequential_preLN__ssm_conv_h3__mixer_channel_mlp__prompt_kernel
  .amdhsa_next_free_vgpr 512
  .amdhsa_next_free_sgpr 102
  .amdhsa_accum_offset 256
  .amdhsa_group_segment_fixed_size 0
  .amdhsa_kernarg_size 112
  .amdhsa_user_sgpr_count 2
  .amdhsa_user_sgpr_kernarg_segment_ptr 1
  .amdhsa_system_sgpr_workgroup_id_x 1
.end_amdhsa_kernel
```
